```python
import torch

def _softmax(x, axis=-1):
    return torch.softmax(x, dim=axis)

def _gelu(x):
    return torch.nn.functional.gelu(x, approximate='tanh')

def _silu(x):
    return torch.nn.functional.silu(x)

def _sigmoid(x):
    return torch.sigmoid(x)

def _layernorm(x, axis=-1, eps=1e-05):
    m = x.mean(dim=axis, keepdim=True)
    v = x.var(dim=axis, keepdim=True, unbiased=False)
    return (x - m) / torch.sqrt(v + eps)

def _scatter_add(tgt, idx, src, axis=0):
    return tgt.clone().index_add_(axis, idx, src)

def _segment_sum(src, seg, n):
    out = torch.zeros((n,) + src.shape[1:], dtype=src.dtype)
    return out.index_add_(0, seg, src)

def _pad(x, pw):
    flat = tuple((v for pair in reversed(pw) for v in pair))
    return torch.nn.functional.pad(x, flat)
kernel_name = 'parallel_sum__linear_kernel_hedgehog__mixer_gmlp__prompt'

def setup_inputs():

    _w = lambda a: (lambda t: t.to(torch.bfloat16) if t.is_floating_point() else t)(torch.as_tensor(a))

    def _A_setup():
        B, S, D, H = (1, 2048, 448, 16)
        Dh = D // H
        return {'x': _w((lambda *s: torch.randn(*s, dtype=torch.bfloat16) * 0.05)(B, S, D)), 'wqkv': _w((lambda *s: torch.randn(*s, dtype=torch.bfloat16) * 0.8)(D, 3 * D)), 'w_phi': _w((lambda *s: torch.randn(*s, dtype=torch.bfloat16) * 0.8)(H, Dh, Dh) * Dh ** (-0.5)), 'wo': _w((lambda *s: torch.randn(*s, dtype=torch.bfloat16) * 0.1)(D, D))}
    _A_in = _A_setup()

    def _B_setup():
        B, S, D, F = (1, 2048, 448, 1792)
        Fh = F // 2
        return {'x': _w((lambda *s: torch.randn(*s, dtype=torch.bfloat16) * 0.05)(B, S, D)), 'w_in': _w((lambda *s: torch.randn(*s, dtype=torch.bfloat16) * 0.4)(D, 2 * Fh)), 'w_sp': _w(0.01 * (lambda *s: torch.randn(*s, dtype=torch.bfloat16) * 0.4)(S, S)), 'b_sp': _w(1.0 + 0.01 * (lambda *s: torch.randn(*s, dtype=torch.bfloat16) * 0.05)(S)), 'w_out': _w((lambda *s: torch.randn(*s, dtype=torch.bfloat16) * 0.05)(Fh, D))}
    _B_in = _B_setup()
    return {'A_x': _A_in['x'], 'A_wqkv': _A_in['wqkv'], 'A_w_phi': _A_in['w_phi'], 'A_wo': _A_in['wo'], 'B_x': _B_in['x'], 'B_w_in': _B_in['w_in'], 'B_w_sp': _B_in['w_sp'], 'B_b_sp': _B_in['b_sp'], 'B_w_out': _B_in['w_out']}

def reference(A_x, A_wqkv, A_w_phi, A_wo, B_x, B_w_in, B_w_sp, B_b_sp, B_w_out):

    def _A_ref(x, wqkv, w_phi, wo):
        B, S, D = x.shape
        H = 16
        Dh = D // H
        qkv = (lambda x, *d: x.permute(*d))((x @ wqkv).reshape(B, S, 3, H, Dh), 2, 0, 3, 1, 4)
        q, k, v = (qkv[0], qkv[1], qkv[2])
        pq = torch.einsum('bhsd,hdf->bhsf', q, w_phi)
        pk = torch.einsum('bhsd,hdf->bhsf', k, w_phi)
        phi_q = torch.concatenate([_softmax(pq, axis=-1), _softmax(-pq, axis=-1)], axis=-1)
        phi_k = torch.concatenate([_softmax(pk, axis=-1), _softmax(-pk, axis=-1)], axis=-1)
        kv = torch.einsum('bhsf,bhsd->bhfd', phi_k, v)
        z = torch.einsum('bhsf->bhf', phi_k)
        num = torch.einsum('bhqf,bhfd->bhqd', phi_q, kv)
        den = torch.einsum('bhqf,bhf->bhq', phi_q, z)[..., None] + 1e-06
        o = num / den
        return (lambda x, *d: x.permute(*d))(o, 0, 2, 1, 3).reshape(B, S, D) @ wo

    def _B_ref(x, w_in, w_sp, b_sp, w_out):
        B, S, D = x.shape
        F = w_in.shape[-1]
        Fh = F // 2
        z = _gelu(torch.einsum('bsd,df->bsf', x, w_in))
        z1 = z[..., :Fh].clone()
        z2 = _layernorm(z[..., Fh:], axis=-1)
        g = torch.einsum('ts,bsf->btf', w_sp, z2) + b_sp[None, :, None]
        return torch.einsum('bsf,fd->bsd', z1 * g, w_out)
    x = A_x
    xn = _layernorm(x, axis=-1)
    return x + _A_ref(xn, A_wqkv, A_w_phi, A_wo) + _B_ref(xn, B_w_in, B_w_sp, B_b_sp, B_w_out)
```

```asm
; @launch kernel=k1_proj_kernel grid=(224,1,1) block=(512,1,1) lds=157696
; @launch kernel=k2_mix_kernel grid=(240,1,1) block=(512,1,1) lds=139264
; @launch kernel=k3_out_kernel grid=(224,1,1) block=(512,1,1) lds=123904
.amdgcn_target "amdgcn-amd-amdhsa--gfx950"
.text
.p2align 8
.globl k1_proj_kernel
.type k1_proj_kernel,@function
k1_proj_kernel:
    s_cmp_ge_u32 s2, 224
    s_cbranch_scc1 k1_end_x
    s_load_dwordx4 s[24:27], s[0:1], 0
    s_load_dwordx2 s[28:29], s[0:1], 16
    s_load_dwordx2 s[30:31], s[0:1], 40
    s_load_dwordx2 s[32:33], s[0:1], 88
    s_load_dwordx2 s[54:55], s[0:1], 48
    s_and_b32 s20, s2, 7
    s_lshl_b32 s20, s20, 1
    s_lshr_b32 s21, s2, 3
    s_and_b32 s34, s21, 1
    s_add_u32 s20, s20, s34
    s_lshr_b32 s21, s2, 4
    v_and_b32 v1, 63, v0
    v_lshrrev_b32 v2, 6, v0
    v_lshlrev_b32 v3, 4, v0
    v_readfirstlane_b32 s23, v2
    s_mul_i32 s34, s23, 896
    v_add_u32 v4, s34, v1
    v_add_u32 v5, 0, v4
    v_mul_u32_u24 v6, 18725, v5
    v_lshrrev_b32 v6, 20, v6
    v_lshrrev_b32 v8, 1, v6
    v_and_b32 v8, 7, v8
    v_mul_u32_u24 v7, 56, v6
    v_sub_u32 v7, v5, v7
    v_xor_b32 v8, v8, v7
    v_and_b32 v8, 7, v8
    v_sub_u32 v5, v5, v7
    v_and_b32 v7, 56, v7
    v_add3_u32 v5, v5, v7, v8
    v_lshlrev_b32 v84, 4, v5
    v_add_u32 v5, 64, v4
    v_mul_u32_u24 v6, 18725, v5
    v_lshrrev_b32 v6, 20, v6
    v_lshrrev_b32 v8, 1, v6
    v_and_b32 v8, 7, v8
    v_mul_u32_u24 v7, 56, v6
    v_sub_u32 v7, v5, v7
    v_xor_b32 v8, v8, v7
    v_and_b32 v8, 7, v8
    v_sub_u32 v5, v5, v7
    v_and_b32 v7, 56, v7
    v_add3_u32 v5, v5, v7, v8
    v_lshlrev_b32 v85, 4, v5
    v_add_u32 v5, 128, v4
    v_mul_u32_u24 v6, 18725, v5
    v_lshrrev_b32 v6, 20, v6
    v_lshrrev_b32 v8, 1, v6
    v_and_b32 v8, 7, v8
    v_mul_u32_u24 v7, 56, v6
    v_sub_u32 v7, v5, v7
    v_xor_b32 v8, v8, v7
    v_and_b32 v8, 7, v8
    v_sub_u32 v5, v5, v7
    v_and_b32 v7, 56, v7
    v_add3_u32 v5, v5, v7, v8
    v_lshlrev_b32 v86, 4, v5
    v_add_u32 v5, 192, v4
    v_mul_u32_u24 v6, 18725, v5
    v_lshrrev_b32 v6, 20, v6
    v_lshrrev_b32 v8, 1, v6
    v_and_b32 v8, 7, v8
    v_mul_u32_u24 v7, 56, v6
    v_sub_u32 v7, v5, v7
    v_xor_b32 v8, v8, v7
    v_and_b32 v8, 7, v8
    v_sub_u32 v5, v5, v7
    v_and_b32 v7, 56, v7
    v_add3_u32 v5, v5, v7, v8
    v_lshlrev_b32 v87, 4, v5
    v_add_u32 v5, 256, v4
    v_mul_u32_u24 v6, 18725, v5
    v_lshrrev_b32 v6, 20, v6
    v_lshrrev_b32 v8, 1, v6
    v_and_b32 v8, 7, v8
    v_mul_u32_u24 v7, 56, v6
    v_sub_u32 v7, v5, v7
    v_xor_b32 v8, v8, v7
    v_and_b32 v8, 7, v8
    v_sub_u32 v5, v5, v7
    v_and_b32 v7, 56, v7
    v_add3_u32 v5, v5, v7, v8
    v_lshlrev_b32 v88, 4, v5
    v_add_u32 v5, 320, v4
    v_mul_u32_u24 v6, 18725, v5
    v_lshrrev_b32 v6, 20, v6
    v_lshrrev_b32 v8, 1, v6
    v_and_b32 v8, 7, v8
    v_mul_u32_u24 v7, 56, v6
    v_sub_u32 v7, v5, v7
    v_xor_b32 v8, v8, v7
    v_and_b32 v8, 7, v8
    v_sub_u32 v5, v5, v7
    v_and_b32 v7, 56, v7
    v_add3_u32 v5, v5, v7, v8
    v_lshlrev_b32 v89, 4, v5
    v_add_u32 v5, 384, v4
    v_mul_u32_u24 v6, 18725, v5
    v_lshrrev_b32 v6, 20, v6
    v_lshrrev_b32 v8, 1, v6
    v_and_b32 v8, 7, v8
    v_mul_u32_u24 v7, 56, v6
    v_sub_u32 v7, v5, v7
    v_xor_b32 v8, v8, v7
    v_and_b32 v8, 7, v8
    v_sub_u32 v5, v5, v7
    v_and_b32 v7, 56, v7
    v_add3_u32 v5, v5, v7, v8
    v_lshlrev_b32 v90, 4, v5
    v_add_u32 v5, 448, v4
    v_mul_u32_u24 v6, 18725, v5
    v_lshrrev_b32 v6, 20, v6
    v_lshrrev_b32 v8, 1, v6
    v_and_b32 v8, 7, v8
    v_mul_u32_u24 v7, 56, v6
    v_sub_u32 v7, v5, v7
    v_xor_b32 v8, v8, v7
    v_and_b32 v8, 7, v8
    v_sub_u32 v5, v5, v7
    v_and_b32 v7, 56, v7
    v_add3_u32 v5, v5, v7, v8
    v_lshlrev_b32 v91, 4, v5
    v_add_u32 v5, 512, v4
    v_mul_u32_u24 v6, 18725, v5
    v_lshrrev_b32 v6, 20, v6
    v_lshrrev_b32 v8, 1, v6
    v_and_b32 v8, 7, v8
    v_mul_u32_u24 v7, 56, v6
    v_sub_u32 v7, v5, v7
    v_xor_b32 v8, v8, v7
    v_and_b32 v8, 7, v8
    v_sub_u32 v5, v5, v7
    v_and_b32 v7, 56, v7
    v_add3_u32 v5, v5, v7, v8
    v_lshlrev_b32 v92, 4, v5
    v_add_u32 v5, 576, v4
    v_mul_u32_u24 v6, 18725, v5
    v_lshrrev_b32 v6, 20, v6
    v_lshrrev_b32 v8, 1, v6
    v_and_b32 v8, 7, v8
    v_mul_u32_u24 v7, 56, v6
    v_sub_u32 v7, v5, v7
    v_xor_b32 v8, v8, v7
    v_and_b32 v8, 7, v8
    v_sub_u32 v5, v5, v7
    v_and_b32 v7, 56, v7
    v_add3_u32 v5, v5, v7, v8
    v_lshlrev_b32 v93, 4, v5
    v_add_u32 v5, 640, v4
    v_mul_u32_u24 v6, 18725, v5
    v_lshrrev_b32 v6, 20, v6
    v_lshrrev_b32 v8, 1, v6
    v_and_b32 v8, 7, v8
    v_mul_u32_u24 v7, 56, v6
    v_sub_u32 v7, v5, v7
    v_xor_b32 v8, v8, v7
    v_and_b32 v8, 7, v8
    v_sub_u32 v5, v5, v7
    v_and_b32 v7, 56, v7
    v_add3_u32 v5, v5, v7, v8
    v_lshlrev_b32 v94, 4, v5
    v_add_u32 v5, 704, v4
    v_mul_u32_u24 v6, 18725, v5
    v_lshrrev_b32 v6, 20, v6
    v_lshrrev_b32 v8, 1, v6
    v_and_b32 v8, 7, v8
    v_mul_u32_u24 v7, 56, v6
    v_sub_u32 v7, v5, v7
    v_xor_b32 v8, v8, v7
    v_and_b32 v8, 7, v8
    v_sub_u32 v5, v5, v7
    v_and_b32 v7, 56, v7
    v_add3_u32 v5, v5, v7, v8
    v_lshlrev_b32 v95, 4, v5
    v_add_u32 v5, 768, v4
    v_mul_u32_u24 v6, 18725, v5
    v_lshrrev_b32 v6, 20, v6
    v_lshrrev_b32 v8, 1, v6
    v_and_b32 v8, 7, v8
    v_mul_u32_u24 v7, 56, v6
    v_sub_u32 v7, v5, v7
    v_xor_b32 v8, v8, v7
    v_and_b32 v8, 7, v8
    v_sub_u32 v5, v5, v7
    v_and_b32 v7, 56, v7
    v_add3_u32 v5, v5, v7, v8
    v_lshlrev_b32 v96, 4, v5
    v_add_u32 v5, 832, v4
    v_mul_u32_u24 v6, 18725, v5
    v_lshrrev_b32 v6, 20, v6
    v_lshrrev_b32 v8, 1, v6
    v_and_b32 v8, 7, v8
    v_mul_u32_u24 v7, 56, v6
    v_sub_u32 v7, v5, v7
    v_xor_b32 v8, v8, v7
    v_and_b32 v8, 7, v8
    v_sub_u32 v5, v5, v7
    v_and_b32 v7, 56, v7
    v_add3_u32 v5, v5, v7, v8
    v_lshlrev_b32 v97, 4, v5
    s_mul_i32 s38, s20, 114688
    s_mul_i32 s35, s23, 14336
    s_waitcnt lgkmcnt(0)
    s_mov_b32 s4, s24
    s_and_b32 s5, s25, 0xffff
    s_mov_b32 s6, 1835008
    s_mov_b32 s7, 0x00020000
    s_add_u32 m0, s35, 0
    s_nop 0
    buffer_load_dwordx4 v84, s[4:7], s38 offen lds
    s_add_u32 m0, s35, 1024
    s_nop 0
    buffer_load_dwordx4 v85, s[4:7], s38 offen lds
    s_add_u32 m0, s35, 2048
    s_nop 0
    buffer_load_dwordx4 v86, s[4:7], s38 offen lds
    s_add_u32 m0, s35, 3072
    s_nop 0
    buffer_load_dwordx4 v87, s[4:7], s38 offen lds
    s_add_u32 m0, s35, 4096
    s_nop 0
    buffer_load_dwordx4 v88, s[4:7], s38 offen lds
    s_add_u32 m0, s35, 5120
    s_nop 0
    buffer_load_dwordx4 v89, s[4:7], s38 offen lds
    s_add_u32 m0, s35, 6144
    s_nop 0
    buffer_load_dwordx4 v90, s[4:7], s38 offen lds
    s_add_u32 m0, s35, 7168
    s_nop 0
    buffer_load_dwordx4 v91, s[4:7], s38 offen lds
    s_add_u32 m0, s35, 8192
    s_nop 0
    buffer_load_dwordx4 v92, s[4:7], s38 offen lds
    s_add_u32 m0, s35, 9216
    s_nop 0
    buffer_load_dwordx4 v93, s[4:7], s38 offen lds
    s_add_u32 m0, s35, 10240
    s_nop 0
    buffer_load_dwordx4 v94, s[4:7], s38 offen lds
    s_add_u32 m0, s35, 11264
    s_nop 0
    buffer_load_dwordx4 v95, s[4:7], s38 offen lds
    s_add_u32 m0, s35, 12288
    s_nop 0
    buffer_load_dwordx4 v96, s[4:7], s38 offen lds
    s_add_u32 m0, s35, 13312
    s_nop 0
    buffer_load_dwordx4 v97, s[4:7], s38 offen lds
    s_mov_b32 s12, s28
    s_and_b32 s13, s29, 0xffff
    s_mov_b32 s14, 25088
    s_mov_b32 s15, 0x00020000
    s_mov_b32 s16, s32
    s_and_b32 s17, s33, 0xffff
    s_mov_b32 s18, 268435456
    s_mov_b32 s19, 0x00020000
    s_cmp_lt_u32 s21, 6
    s_mov_b32 s22, 2688
    s_cselect_b32 s22, s22, 3584
    s_cselect_b32 s34, s26, s30
    s_cselect_b32 s35, s27, s31
    s_mov_b32 s36, 1204224
    s_cselect_b32 s36, s36, 1605632
    s_cselect_b32 s37, 0, 6
    s_sub_u32 s37, s21, s37
    s_mul_i32 s37, s37, 448
    s_add_u32 s8, s34, s37
    s_addc_u32 s9, s35, 0
    s_and_b32 s9, s9, 0xffff
    s_sub_u32 s10, s36, s37
    s_mov_b32 s11, 0x00020000
    s_lshl_b32 s34, s23, 7
    v_add_u32 v4, s34, v1
    v_add_u32 v5, 0, v4
    v_mul_u32_u24 v6, 2341, v5
    v_lshrrev_b32 v6, 16, v6
    v_mul_u32_u24 v7, 28, v6
    v_sub_u32 v7, v5, v7
    v_lshlrev_b32 v7, 4, v7
    v_mul_lo_u32 v10, v6, s22
    v_add_u32 v10, v10, v7
    v_add_u32 v5, 64, v4
    v_mul_u32_u24 v6, 2341, v5
    v_lshrrev_b32 v6, 16, v6
    v_mul_u32_u24 v7, 28, v6
    v_sub_u32 v7, v5, v7
    v_lshlrev_b32 v7, 4, v7
    v_mul_lo_u32 v11, v6, s22
    v_add_u32 v11, v11, v7
    s_lshl_b32 s48, s23, 11
    s_add_u32 s48, s48, 114688
    s_cmp_eq_u32 s23, 7
    s_cbranch_scc1 k1w_1
    s_mul_i32 s38, s22, 0
    s_add_u32 m0, s48, 0
    s_nop 0
    buffer_load_dwordx4 v10, s[8:11], s38 offen lds
    s_add_u32 m0, s48, 1024
    s_nop 0
    buffer_load_dwordx4 v11, s[8:11], s38 offen lds
k1w_1:
    s_cmp_eq_u32 s23, 7
    s_cbranch_scc1 k1w_2
    s_mul_i32 s38, s22, 32
    s_add_u32 m0, s48, 14336
    s_nop 0
    buffer_load_dwordx4 v10, s[8:11], s38 offen lds
    s_add_u32 m0, s48, 15360
    s_nop 0
    buffer_load_dwordx4 v11, s[8:11], s38 offen lds
k1w_2:
    s_and_b32 s39, s21, 1
    s_mul_i32 s40, s39, 12544
    v_add_u32 v4, 8192, v3
    buffer_load_dwordx4 v[140:143], v3, s[12:15], s40 offen
    v_mov_b32 v5, 1073741824
    v_cmp_gt_u32 vcc, 272, v0
    s_nop 1
    v_cndmask_b32 v4, v5, v4, vcc
    buffer_load_dwordx4 v[144:147], v4, s[12:15], s40 offen
    v_bfe_u32 v4, v1, 4, 1
    v_lshrrev_b32 v5, 5, v1
    v_bfe_u32 v6, v1, 2, 2
    v_and_b32 v7, 3, v1
    v_lshl_add_u32 v6, v5, 3, v6
    v_mul_u32_u24 v12, 448, v6
    v_lshl_add_u32 v7, v4, 2, v7
    v_lshl_add_u32 v12, v7, 3, v12
    v_add_u32 v12, 114688, v12
    v_and_b32 v4, 31, v1
    v_lshrrev_b32 v5, 5, v1
    v_bfe_u32 v6, v4, 1, 3
    v_add_u32 v7, 0, v5
    v_xor_b32 v7, v7, v6
    v_mul_u32_u24 v13, 896, v4
    v_lshl_add_u32 v13, v7, 4, v13
    v_add_u32 v7, 2, v5
    v_xor_b32 v7, v7, v6
    v_mul_u32_u24 v14, 896, v4
    v_lshl_add_u32 v14, v7, 4, v14
    v_add_u32 v7, 4, v5
    v_xor_b32 v7, v7, v6
    v_mul_u32_u24 v15, 896, v4
    v_lshl_add_u32 v15, v7, 4, v15
    v_add_u32 v7, 6, v5
    v_xor_b32 v7, v7, v6
    v_mul_u32_u24 v16, 896, v4
    v_lshl_add_u32 v16, v7, 4, v16
    s_waitcnt vmcnt(0)
    v_add_u32 v4, 143360, v3
    ds_write_b128 v4, v[140:143]
    v_cmp_gt_u32 vcc, 320, v0
    s_and_saveexec_b64 s[50:51], vcc
    ds_write_b128 v4, v[144:147] offset:8192
    s_mov_b64 exec, -1
    v_lshrrev_b32 v4, 2, v0
    v_and_b32 v5, 3, v0
    v_mul_u32_u24 v6, 896, v4
    v_mul_u32_u24 v5, 224, v5
    v_add_u32 v6, v6, v5
    ds_read_b128 v[20:23], v6 offset:0
    ds_read_b128 v[24:27], v6 offset:16
    ds_read_b128 v[28:31], v6 offset:32
    ds_read_b128 v[32:35], v6 offset:48
    ds_read_b128 v[36:39], v6 offset:64
    ds_read_b128 v[40:43], v6 offset:80
    ds_read_b128 v[44:47], v6 offset:96
    ds_read_b128 v[48:51], v6 offset:112
    ds_read_b128 v[52:55], v6 offset:128
    ds_read_b128 v[56:59], v6 offset:144
    ds_read_b128 v[60:63], v6 offset:160
    ds_read_b128 v[64:67], v6 offset:176
    ds_read_b128 v[68:71], v6 offset:192
    ds_read_b128 v[72:75], v6 offset:208
    s_waitcnt lgkmcnt(13)
    v_lshlrev_b32 v84, 16, v20
    v_and_b32 v85, 0xffff0000, v20
    v_pk_mul_f32 v[150:151], v[84:85], v[84:85]
    v_mov_b32 v148, v84
    v_mov_b32 v149, v85
    v_lshlrev_b32 v86, 16, v21
    v_and_b32 v87, 0xffff0000, v21
    v_pk_fma_f32 v[150:151], v[86:87], v[86:87], v[150:151]
    v_pk_add_f32 v[148:149], v[148:149], v[86:87]
    v_lshlrev_b32 v88, 16, v22
    v_and_b32 v89, 0xffff0000, v22
    v_pk_fma_f32 v[150:151], v[88:89], v[88:89], v[150:151]
    v_pk_add_f32 v[148:149], v[148:149], v[88:89]
    v_lshlrev_b32 v90, 16, v23
    v_and_b32 v91, 0xffff0000, v23
    v_pk_fma_f32 v[150:151], v[90:91], v[90:91], v[150:151]
    v_pk_add_f32 v[148:149], v[148:149], v[90:91]
    s_waitcnt lgkmcnt(12)
    v_lshlrev_b32 v92, 16, v24
    v_and_b32 v93, 0xffff0000, v24
    v_pk_fma_f32 v[150:151], v[92:93], v[92:93], v[150:151]
    v_pk_add_f32 v[148:149], v[148:149], v[92:93]
    v_lshlrev_b32 v94, 16, v25
    v_and_b32 v95, 0xffff0000, v25
    v_pk_fma_f32 v[150:151], v[94:95], v[94:95], v[150:151]
    v_pk_add_f32 v[148:149], v[148:149], v[94:95]
    v_lshlrev_b32 v96, 16, v26
    v_and_b32 v97, 0xffff0000, v26
    v_pk_fma_f32 v[150:151], v[96:97], v[96:97], v[150:151]
    v_pk_add_f32 v[148:149], v[148:149], v[96:97]
    v_lshlrev_b32 v98, 16, v27
    v_and_b32 v99, 0xffff0000, v27
    v_pk_fma_f32 v[150:151], v[98:99], v[98:99], v[150:151]
    v_pk_add_f32 v[148:149], v[148:149], v[98:99]
    s_waitcnt lgkmcnt(11)
    v_lshlrev_b32 v100, 16, v28
    v_and_b32 v101, 0xffff0000, v28
    v_pk_fma_f32 v[150:151], v[100:101], v[100:101], v[150:151]
    v_pk_add_f32 v[148:149], v[148:149], v[100:101]
    v_lshlrev_b32 v102, 16, v29
    v_and_b32 v103, 0xffff0000, v29
    v_pk_fma_f32 v[150:151], v[102:103], v[102:103], v[150:151]
    v_pk_add_f32 v[148:149], v[148:149], v[102:103]
    v_lshlrev_b32 v104, 16, v30
    v_and_b32 v105, 0xffff0000, v30
    v_pk_fma_f32 v[150:151], v[104:105], v[104:105], v[150:151]
    v_pk_add_f32 v[148:149], v[148:149], v[104:105]
    v_lshlrev_b32 v106, 16, v31
    v_and_b32 v107, 0xffff0000, v31
    v_pk_fma_f32 v[150:151], v[106:107], v[106:107], v[150:151]
    v_pk_add_f32 v[148:149], v[148:149], v[106:107]
    s_waitcnt lgkmcnt(10)
    v_lshlrev_b32 v108, 16, v32
    v_and_b32 v109, 0xffff0000, v32
    v_pk_fma_f32 v[150:151], v[108:109], v[108:109], v[150:151]
    v_pk_add_f32 v[148:149], v[148:149], v[108:109]
    v_lshlrev_b32 v110, 16, v33
    v_and_b32 v111, 0xffff0000, v33
    v_pk_fma_f32 v[150:151], v[110:111], v[110:111], v[150:151]
    v_pk_add_f32 v[148:149], v[148:149], v[110:111]
    v_lshlrev_b32 v112, 16, v34
    v_and_b32 v113, 0xffff0000, v34
    v_pk_fma_f32 v[150:151], v[112:113], v[112:113], v[150:151]
    v_pk_add_f32 v[148:149], v[148:149], v[112:113]
    v_lshlrev_b32 v114, 16, v35
    v_and_b32 v115, 0xffff0000, v35
    v_pk_fma_f32 v[150:151], v[114:115], v[114:115], v[150:151]
    v_pk_add_f32 v[148:149], v[148:149], v[114:115]
    s_waitcnt lgkmcnt(9)
    v_lshlrev_b32 v116, 16, v36
    v_and_b32 v117, 0xffff0000, v36
    v_pk_fma_f32 v[150:151], v[116:117], v[116:117], v[150:151]
    v_pk_add_f32 v[148:149], v[148:149], v[116:117]
    v_lshlrev_b32 v118, 16, v37
    v_and_b32 v119, 0xffff0000, v37
    v_pk_fma_f32 v[150:151], v[118:119], v[118:119], v[150:151]
    v_pk_add_f32 v[148:149], v[148:149], v[118:119]
    v_lshlrev_b32 v120, 16, v38
    v_and_b32 v121, 0xffff0000, v38
    v_pk_fma_f32 v[150:151], v[120:121], v[120:121], v[150:151]
    v_pk_add_f32 v[148:149], v[148:149], v[120:121]
    v_lshlrev_b32 v122, 16, v39
    v_and_b32 v123, 0xffff0000, v39
    v_pk_fma_f32 v[150:151], v[122:123], v[122:123], v[150:151]
    v_pk_add_f32 v[148:149], v[148:149], v[122:123]
    s_waitcnt lgkmcnt(8)
    v_lshlrev_b32 v164, 16, v40
    v_and_b32 v165, 0xffff0000, v40
    v_pk_fma_f32 v[150:151], v[164:165], v[164:165], v[150:151]
    v_pk_add_f32 v[148:149], v[148:149], v[164:165]
    v_lshlrev_b32 v166, 16, v41
    v_and_b32 v167, 0xffff0000, v41
    v_pk_fma_f32 v[150:151], v[166:167], v[166:167], v[150:151]
    v_pk_add_f32 v[148:149], v[148:149], v[166:167]
    v_lshlrev_b32 v168, 16, v42
    v_and_b32 v169, 0xffff0000, v42
    v_pk_fma_f32 v[150:151], v[168:169], v[168:169], v[150:151]
    v_pk_add_f32 v[148:149], v[148:149], v[168:169]
    v_lshlrev_b32 v170, 16, v43
    v_and_b32 v171, 0xffff0000, v43
    v_pk_fma_f32 v[150:151], v[170:171], v[170:171], v[150:151]
    v_pk_add_f32 v[148:149], v[148:149], v[170:171]
    s_waitcnt lgkmcnt(7)
    v_lshlrev_b32 v172, 16, v44
    v_and_b32 v173, 0xffff0000, v44
    v_pk_fma_f32 v[150:151], v[172:173], v[172:173], v[150:151]
    v_pk_add_f32 v[148:149], v[148:149], v[172:173]
    v_lshlrev_b32 v174, 16, v45
    v_and_b32 v175, 0xffff0000, v45
    v_pk_fma_f32 v[150:151], v[174:175], v[174:175], v[150:151]
    v_pk_add_f32 v[148:149], v[148:149], v[174:175]
    v_lshlrev_b32 v176, 16, v46
    v_and_b32 v177, 0xffff0000, v46
    v_pk_fma_f32 v[150:151], v[176:177], v[176:177], v[150:151]
    v_pk_add_f32 v[148:149], v[148:149], v[176:177]
    v_lshlrev_b32 v178, 16, v47
    v_and_b32 v179, 0xffff0000, v47
    v_pk_fma_f32 v[150:151], v[178:179], v[178:179], v[150:151]
    v_pk_add_f32 v[148:149], v[148:149], v[178:179]
    s_waitcnt lgkmcnt(6)
    v_lshlrev_b32 v180, 16, v48
    v_and_b32 v181, 0xffff0000, v48
    v_pk_fma_f32 v[150:151], v[180:181], v[180:181], v[150:151]
    v_pk_add_f32 v[148:149], v[148:149], v[180:181]
    v_lshlrev_b32 v182, 16, v49
    v_and_b32 v183, 0xffff0000, v49
    v_pk_fma_f32 v[150:151], v[182:183], v[182:183], v[150:151]
    v_pk_add_f32 v[148:149], v[148:149], v[182:183]
    v_lshlrev_b32 v184, 16, v50
    v_and_b32 v185, 0xffff0000, v50
    v_pk_fma_f32 v[150:151], v[184:185], v[184:185], v[150:151]
    v_pk_add_f32 v[148:149], v[148:149], v[184:185]
    v_lshlrev_b32 v186, 16, v51
    v_and_b32 v187, 0xffff0000, v51
    v_pk_fma_f32 v[150:151], v[186:187], v[186:187], v[150:151]
    v_pk_add_f32 v[148:149], v[148:149], v[186:187]
    s_waitcnt lgkmcnt(5)
    v_lshlrev_b32 v188, 16, v52
    v_and_b32 v189, 0xffff0000, v52
    v_pk_fma_f32 v[150:151], v[188:189], v[188:189], v[150:151]
    v_pk_add_f32 v[148:149], v[148:149], v[188:189]
    v_lshlrev_b32 v190, 16, v53
    v_and_b32 v191, 0xffff0000, v53
    v_pk_fma_f32 v[150:151], v[190:191], v[190:191], v[150:151]
    v_pk_add_f32 v[148:149], v[148:149], v[190:191]
    v_lshlrev_b32 v192, 16, v54
    v_and_b32 v193, 0xffff0000, v54
    v_pk_fma_f32 v[150:151], v[192:193], v[192:193], v[150:151]
    v_pk_add_f32 v[148:149], v[148:149], v[192:193]
    v_lshlrev_b32 v194, 16, v55
    v_and_b32 v195, 0xffff0000, v55
    v_pk_fma_f32 v[150:151], v[194:195], v[194:195], v[150:151]
    v_pk_add_f32 v[148:149], v[148:149], v[194:195]
    s_waitcnt lgkmcnt(4)
    v_lshlrev_b32 v196, 16, v56
    v_and_b32 v197, 0xffff0000, v56
    v_pk_fma_f32 v[150:151], v[196:197], v[196:197], v[150:151]
    v_pk_add_f32 v[148:149], v[148:149], v[196:197]
    v_lshlrev_b32 v198, 16, v57
    v_and_b32 v199, 0xffff0000, v57
    v_pk_fma_f32 v[150:151], v[198:199], v[198:199], v[150:151]
    v_pk_add_f32 v[148:149], v[148:149], v[198:199]
    v_lshlrev_b32 v200, 16, v58
    v_and_b32 v201, 0xffff0000, v58
    v_pk_fma_f32 v[150:151], v[200:201], v[200:201], v[150:151]
    v_pk_add_f32 v[148:149], v[148:149], v[200:201]
    v_lshlrev_b32 v202, 16, v59
    v_and_b32 v203, 0xffff0000, v59
    v_pk_fma_f32 v[150:151], v[202:203], v[202:203], v[150:151]
    v_pk_add_f32 v[148:149], v[148:149], v[202:203]
    s_waitcnt lgkmcnt(3)
    v_lshlrev_b32 v204, 16, v60
    v_and_b32 v205, 0xffff0000, v60
    v_pk_fma_f32 v[150:151], v[204:205], v[204:205], v[150:151]
    v_pk_add_f32 v[148:149], v[148:149], v[204:205]
    v_lshlrev_b32 v206, 16, v61
    v_and_b32 v207, 0xffff0000, v61
    v_pk_fma_f32 v[150:151], v[206:207], v[206:207], v[150:151]
    v_pk_add_f32 v[148:149], v[148:149], v[206:207]
    v_lshlrev_b32 v208, 16, v62
    v_and_b32 v209, 0xffff0000, v62
    v_pk_fma_f32 v[150:151], v[208:209], v[208:209], v[150:151]
    v_pk_add_f32 v[148:149], v[148:149], v[208:209]
    v_lshlrev_b32 v210, 16, v63
    v_and_b32 v211, 0xffff0000, v63
    v_pk_fma_f32 v[150:151], v[210:211], v[210:211], v[150:151]
    v_pk_add_f32 v[148:149], v[148:149], v[210:211]
    s_waitcnt lgkmcnt(2)
    v_lshlrev_b32 v212, 16, v64
    v_and_b32 v213, 0xffff0000, v64
    v_pk_fma_f32 v[150:151], v[212:213], v[212:213], v[150:151]
    v_pk_add_f32 v[148:149], v[148:149], v[212:213]
    v_lshlrev_b32 v214, 16, v65
    v_and_b32 v215, 0xffff0000, v65
    v_pk_fma_f32 v[150:151], v[214:215], v[214:215], v[150:151]
    v_pk_add_f32 v[148:149], v[148:149], v[214:215]
    v_lshlrev_b32 v216, 16, v66
    v_and_b32 v217, 0xffff0000, v66
    v_pk_fma_f32 v[150:151], v[216:217], v[216:217], v[150:151]
    v_pk_add_f32 v[148:149], v[148:149], v[216:217]
    v_lshlrev_b32 v218, 16, v67
    v_and_b32 v219, 0xffff0000, v67
    v_pk_fma_f32 v[150:151], v[218:219], v[218:219], v[150:151]
    v_pk_add_f32 v[148:149], v[148:149], v[218:219]
    s_waitcnt lgkmcnt(1)
    v_lshlrev_b32 v220, 16, v68
    v_and_b32 v221, 0xffff0000, v68
    v_pk_fma_f32 v[150:151], v[220:221], v[220:221], v[150:151]
    v_pk_add_f32 v[148:149], v[148:149], v[220:221]
    v_lshlrev_b32 v222, 16, v69
    v_and_b32 v223, 0xffff0000, v69
    v_pk_fma_f32 v[150:151], v[222:223], v[222:223], v[150:151]
    v_pk_add_f32 v[148:149], v[148:149], v[222:223]
    v_lshlrev_b32 v224, 16, v70
    v_and_b32 v225, 0xffff0000, v70
    v_pk_fma_f32 v[150:151], v[224:225], v[224:225], v[150:151]
    v_pk_add_f32 v[148:149], v[148:149], v[224:225]
    v_lshlrev_b32 v226, 16, v71
    v_and_b32 v227, 0xffff0000, v71
    v_pk_fma_f32 v[150:151], v[226:227], v[226:227], v[150:151]
    v_pk_add_f32 v[148:149], v[148:149], v[226:227]
    s_waitcnt lgkmcnt(0)
    v_lshlrev_b32 v228, 16, v72
    v_and_b32 v229, 0xffff0000, v72
    v_pk_fma_f32 v[150:151], v[228:229], v[228:229], v[150:151]
    v_pk_add_f32 v[148:149], v[148:149], v[228:229]
    v_lshlrev_b32 v230, 16, v73
    v_and_b32 v231, 0xffff0000, v73
    v_pk_fma_f32 v[150:151], v[230:231], v[230:231], v[150:151]
    v_pk_add_f32 v[148:149], v[148:149], v[230:231]
    v_lshlrev_b32 v232, 16, v74
    v_and_b32 v233, 0xffff0000, v74
    v_pk_fma_f32 v[150:151], v[232:233], v[232:233], v[150:151]
    v_pk_add_f32 v[148:149], v[148:149], v[232:233]
    v_lshlrev_b32 v234, 16, v75
    v_and_b32 v235, 0xffff0000, v75
    v_pk_fma_f32 v[150:151], v[234:235], v[234:235], v[150:151]
    v_pk_add_f32 v[148:149], v[148:149], v[234:235]
    v_add_f32 v154, v148, v149
    v_add_f32 v155, v150, v151
    s_nop 1
    v_add_f32_dpp v152, v154, v154 quad_perm:[1,0,3,2] row_mask:0xf bank_mask:0xf
    v_add_f32_dpp v153, v155, v155 quad_perm:[1,0,3,2] row_mask:0xf bank_mask:0xf
    v_mov_b32 v154, v152
    v_mov_b32 v155, v153
    s_nop 1
    v_add_f32_dpp v152, v154, v154 quad_perm:[2,3,0,1] row_mask:0xf bank_mask:0xf
    v_add_f32_dpp v153, v155, v155 quad_perm:[2,3,0,1] row_mask:0xf bank_mask:0xf
    v_mov_b32 v154, v152
    v_mov_b32 v155, v153
    s_nop 1
    v_mul_f32 v154, 991054117, v154
    v_mul_f32 v155, 991054117, v155
    v_fma_f32 v155, -v154, v154, v155
    v_max_f32 v155, 0, v155
    v_cvt_pk_bf16_f32 v154, v154, v154
    v_lshlrev_b32 v154, 16, v154
    v_cvt_pk_bf16_f32 v155, v155, v155
    v_lshlrev_b32 v155, 16, v155
    v_add_f32 v155, 925353388, v155
    v_cvt_pk_bf16_f32 v155, v155, v155
    v_lshlrev_b32 v155, 16, v155
    v_sqrt_f32 v155, v155
    s_nop 0
    v_cvt_pk_bf16_f32 v155, v155, v155
    v_lshlrev_b32 v155, 16, v155
    v_rcp_f32 v155, v155
    s_nop 0
    v_mul_f32 v154, v154, v155
    v_mov_b32 v148, v155
    v_mov_b32 v149, v155
    v_sub_f32 v150, 0, v154
    v_sub_f32 v151, 0, v154
    v_pk_fma_f32 v[84:85], v[84:85], v[148:149], v[150:151]
    v_cvt_pk_bf16_f32 v20, v84, v85
    v_pk_fma_f32 v[86:87], v[86:87], v[148:149], v[150:151]
    v_cvt_pk_bf16_f32 v21, v86, v87
    v_pk_fma_f32 v[88:89], v[88:89], v[148:149], v[150:151]
    v_cvt_pk_bf16_f32 v22, v88, v89
    v_pk_fma_f32 v[90:91], v[90:91], v[148:149], v[150:151]
    v_cvt_pk_bf16_f32 v23, v90, v91
    ds_write_b128 v6, v[20:23] offset:0
    v_pk_fma_f32 v[92:93], v[92:93], v[148:149], v[150:151]
    v_cvt_pk_bf16_f32 v24, v92, v93
    v_pk_fma_f32 v[94:95], v[94:95], v[148:149], v[150:151]
    v_cvt_pk_bf16_f32 v25, v94, v95
    v_pk_fma_f32 v[96:97], v[96:97], v[148:149], v[150:151]
    v_cvt_pk_bf16_f32 v26, v96, v97
    v_pk_fma_f32 v[98:99], v[98:99], v[148:149], v[150:151]
    v_cvt_pk_bf16_f32 v27, v98, v99
    ds_write_b128 v6, v[24:27] offset:16
    v_pk_fma_f32 v[100:101], v[100:101], v[148:149], v[150:151]
    v_cvt_pk_bf16_f32 v28, v100, v101
    v_pk_fma_f32 v[102:103], v[102:103], v[148:149], v[150:151]
    v_cvt_pk_bf16_f32 v29, v102, v103
    v_pk_fma_f32 v[104:105], v[104:105], v[148:149], v[150:151]
    v_cvt_pk_bf16_f32 v30, v104, v105
    v_pk_fma_f32 v[106:107], v[106:107], v[148:149], v[150:151]
    v_cvt_pk_bf16_f32 v31, v106, v107
    ds_write_b128 v6, v[28:31] offset:32
    v_pk_fma_f32 v[108:109], v[108:109], v[148:149], v[150:151]
    v_cvt_pk_bf16_f32 v32, v108, v109
    v_pk_fma_f32 v[110:111], v[110:111], v[148:149], v[150:151]
    v_cvt_pk_bf16_f32 v33, v110, v111
    v_pk_fma_f32 v[112:113], v[112:113], v[148:149], v[150:151]
    v_cvt_pk_bf16_f32 v34, v112, v113
    v_pk_fma_f32 v[114:115], v[114:115], v[148:149], v[150:151]
    v_cvt_pk_bf16_f32 v35, v114, v115
    ds_write_b128 v6, v[32:35] offset:48
    v_pk_fma_f32 v[116:117], v[116:117], v[148:149], v[150:151]
    v_cvt_pk_bf16_f32 v36, v116, v117
    v_pk_fma_f32 v[118:119], v[118:119], v[148:149], v[150:151]
    v_cvt_pk_bf16_f32 v37, v118, v119
    v_pk_fma_f32 v[120:121], v[120:121], v[148:149], v[150:151]
    v_cvt_pk_bf16_f32 v38, v120, v121
    v_pk_fma_f32 v[122:123], v[122:123], v[148:149], v[150:151]
    v_cvt_pk_bf16_f32 v39, v122, v123
    ds_write_b128 v6, v[36:39] offset:64
    v_pk_fma_f32 v[164:165], v[164:165], v[148:149], v[150:151]
    v_cvt_pk_bf16_f32 v40, v164, v165
    v_pk_fma_f32 v[166:167], v[166:167], v[148:149], v[150:151]
    v_cvt_pk_bf16_f32 v41, v166, v167
    v_pk_fma_f32 v[168:169], v[168:169], v[148:149], v[150:151]
    v_cvt_pk_bf16_f32 v42, v168, v169
    v_pk_fma_f32 v[170:171], v[170:171], v[148:149], v[150:151]
    v_cvt_pk_bf16_f32 v43, v170, v171
    ds_write_b128 v6, v[40:43] offset:80
    v_pk_fma_f32 v[172:173], v[172:173], v[148:149], v[150:151]
    v_cvt_pk_bf16_f32 v44, v172, v173
    v_pk_fma_f32 v[174:175], v[174:175], v[148:149], v[150:151]
    v_cvt_pk_bf16_f32 v45, v174, v175
    v_pk_fma_f32 v[176:177], v[176:177], v[148:149], v[150:151]
    v_cvt_pk_bf16_f32 v46, v176, v177
    v_pk_fma_f32 v[178:179], v[178:179], v[148:149], v[150:151]
    v_cvt_pk_bf16_f32 v47, v178, v179
    ds_write_b128 v6, v[44:47] offset:96
    v_pk_fma_f32 v[180:181], v[180:181], v[148:149], v[150:151]
    v_cvt_pk_bf16_f32 v48, v180, v181
    v_pk_fma_f32 v[182:183], v[182:183], v[148:149], v[150:151]
    v_cvt_pk_bf16_f32 v49, v182, v183
    v_pk_fma_f32 v[184:185], v[184:185], v[148:149], v[150:151]
    v_cvt_pk_bf16_f32 v50, v184, v185
    v_pk_fma_f32 v[186:187], v[186:187], v[148:149], v[150:151]
    v_cvt_pk_bf16_f32 v51, v186, v187
    ds_write_b128 v6, v[48:51] offset:112
    v_pk_fma_f32 v[188:189], v[188:189], v[148:149], v[150:151]
    v_cvt_pk_bf16_f32 v52, v188, v189
    v_pk_fma_f32 v[190:191], v[190:191], v[148:149], v[150:151]
    v_cvt_pk_bf16_f32 v53, v190, v191
    v_pk_fma_f32 v[192:193], v[192:193], v[148:149], v[150:151]
    v_cvt_pk_bf16_f32 v54, v192, v193
    v_pk_fma_f32 v[194:195], v[194:195], v[148:149], v[150:151]
    v_cvt_pk_bf16_f32 v55, v194, v195
    ds_write_b128 v6, v[52:55] offset:128
    v_pk_fma_f32 v[196:197], v[196:197], v[148:149], v[150:151]
    v_cvt_pk_bf16_f32 v56, v196, v197
    v_pk_fma_f32 v[198:199], v[198:199], v[148:149], v[150:151]
    v_cvt_pk_bf16_f32 v57, v198, v199
    v_pk_fma_f32 v[200:201], v[200:201], v[148:149], v[150:151]
    v_cvt_pk_bf16_f32 v58, v200, v201
    v_pk_fma_f32 v[202:203], v[202:203], v[148:149], v[150:151]
    v_cvt_pk_bf16_f32 v59, v202, v203
    ds_write_b128 v6, v[56:59] offset:144
    v_pk_fma_f32 v[204:205], v[204:205], v[148:149], v[150:151]
    v_cvt_pk_bf16_f32 v60, v204, v205
    v_pk_fma_f32 v[206:207], v[206:207], v[148:149], v[150:151]
    v_cvt_pk_bf16_f32 v61, v206, v207
    v_pk_fma_f32 v[208:209], v[208:209], v[148:149], v[150:151]
    v_cvt_pk_bf16_f32 v62, v208, v209
    v_pk_fma_f32 v[210:211], v[210:211], v[148:149], v[150:151]
    v_cvt_pk_bf16_f32 v63, v210, v211
    ds_write_b128 v6, v[60:63] offset:160
    v_pk_fma_f32 v[212:213], v[212:213], v[148:149], v[150:151]
    v_cvt_pk_bf16_f32 v64, v212, v213
    v_pk_fma_f32 v[214:215], v[214:215], v[148:149], v[150:151]
    v_cvt_pk_bf16_f32 v65, v214, v215
    v_pk_fma_f32 v[216:217], v[216:217], v[148:149], v[150:151]
    v_cvt_pk_bf16_f32 v66, v216, v217
    v_pk_fma_f32 v[218:219], v[218:219], v[148:149], v[150:151]
    v_cvt_pk_bf16_f32 v67, v218, v219
    ds_write_b128 v6, v[64:67] offset:176
    v_pk_fma_f32 v[220:221], v[220:221], v[148:149], v[150:151]
    v_cvt_pk_bf16_f32 v68, v220, v221
    v_pk_fma_f32 v[222:223], v[222:223], v[148:149], v[150:151]
    v_cvt_pk_bf16_f32 v69, v222, v223
    v_pk_fma_f32 v[224:225], v[224:225], v[148:149], v[150:151]
    v_cvt_pk_bf16_f32 v70, v224, v225
    v_pk_fma_f32 v[226:227], v[226:227], v[148:149], v[150:151]
    v_cvt_pk_bf16_f32 v71, v226, v227
    ds_write_b128 v6, v[68:71] offset:192
    v_pk_fma_f32 v[228:229], v[228:229], v[148:149], v[150:151]
    v_cvt_pk_bf16_f32 v72, v228, v229
    v_pk_fma_f32 v[230:231], v[230:231], v[148:149], v[150:151]
    v_cvt_pk_bf16_f32 v73, v230, v231
    v_pk_fma_f32 v[232:233], v[232:233], v[148:149], v[150:151]
    v_cvt_pk_bf16_f32 v74, v232, v233
    v_pk_fma_f32 v[234:235], v[234:235], v[148:149], v[150:151]
    v_cvt_pk_bf16_f32 v75, v234, v235
    ds_write_b128 v6, v[72:75] offset:208
    v_mov_b32 v20, 0
    v_mov_b32 v21, 0
    v_mov_b32 v22, 0
    v_mov_b32 v23, 0
    v_mov_b32 v24, 0
    v_mov_b32 v25, 0
    v_mov_b32 v26, 0
    v_mov_b32 v27, 0
    v_mov_b32 v28, 0
    v_mov_b32 v29, 0
    v_mov_b32 v30, 0
    v_mov_b32 v31, 0
    v_mov_b32 v32, 0
    v_mov_b32 v33, 0
    v_mov_b32 v34, 0
    v_mov_b32 v35, 0
    v_mov_b32 v36, 0
    v_mov_b32 v37, 0
    v_mov_b32 v38, 0
    v_mov_b32 v39, 0
    v_mov_b32 v40, 0
    v_mov_b32 v41, 0
    v_mov_b32 v42, 0
    v_mov_b32 v43, 0
    v_mov_b32 v44, 0
    v_mov_b32 v45, 0
    v_mov_b32 v46, 0
    v_mov_b32 v47, 0
    v_mov_b32 v48, 0
    v_mov_b32 v49, 0
    v_mov_b32 v50, 0
    v_mov_b32 v51, 0
    v_mov_b32 v52, 0
    v_mov_b32 v53, 0
    v_mov_b32 v54, 0
    v_mov_b32 v55, 0
    v_mov_b32 v56, 0
    v_mov_b32 v57, 0
    v_mov_b32 v58, 0
    v_mov_b32 v59, 0
    v_mov_b32 v60, 0
    v_mov_b32 v61, 0
    v_mov_b32 v62, 0
    v_mov_b32 v63, 0
    v_mov_b32 v64, 0
    v_mov_b32 v65, 0
    v_mov_b32 v66, 0
    v_mov_b32 v67, 0
    v_mov_b32 v68, 0
    v_mov_b32 v69, 0
    v_mov_b32 v70, 0
    v_mov_b32 v71, 0
    v_mov_b32 v72, 0
    v_mov_b32 v73, 0
    v_mov_b32 v74, 0
    v_mov_b32 v75, 0
    v_mov_b32 v76, 0
    v_mov_b32 v77, 0
    v_mov_b32 v78, 0
    v_mov_b32 v79, 0
    v_mov_b32 v80, 0
    v_mov_b32 v81, 0
    v_mov_b32 v82, 0
    v_mov_b32 v83, 0
    s_waitcnt lgkmcnt(0)
    s_barrier
    v_bfe_u32 v156, v1, 4, 1
    v_lshrrev_b32 v157, 5, v1
    v_bfe_u32 v158, v1, 2, 2
    v_and_b32 v159, 3, v1
    v_lshl_add_u32 v158, v157, 2, v158
    v_mul_u32_u24 v160, 56, v158
    v_lshl_add_u32 v159, v156, 2, v159
    v_lshl_add_u32 v160, v159, 3, v160
    s_lshr_b32 s40, s23, 1
    s_mul_i32 s40, s40, 3136
    s_add_u32 s40, s40, 143360
    v_add_u32 v160, s40, v160
    ds_read_b64_tr_b16 v[124:125], v160 offset:0
    ds_read_b64_tr_b16 v[126:127], v160 offset:448
    ds_read_b64_tr_b16 v[128:129], v160 offset:896
    ds_read_b64_tr_b16 v[130:131], v160 offset:1344
    ds_read_b64_tr_b16 v[132:133], v160 offset:1568
    ds_read_b64_tr_b16 v[134:135], v160 offset:2016
    ds_read_b64_tr_b16 v[136:137], v160 offset:2464
    ds_read_b64_tr_b16 v[138:139], v160 offset:2912
    s_waitcnt lgkmcnt(0)
    s_barrier
    s_cmp_ge_u32 s21, 6
    s_cbranch_scc1 k1_zpath
    s_lshr_b32 s40, s23, 1
    s_mul_i32 s40, s40, 112
    s_and_b32 s41, s23, 1
    s_mul_i32 s41, s41, 57344
    v_add_u32 v7, s40, v12
    v_add_u32 v13, s41, v13
    v_add_u32 v14, s41, v14
    v_add_u32 v15, s41, v15
    v_add_u32 v16, s41, v16
    s_cmp_eq_u32 s23, 7
    s_cbranch_scc1 k1w_3
    s_mul_i32 s38, s22, 64
    s_add_u32 m0, s48, 28672
    s_nop 0
    buffer_load_dwordx4 v10, s[8:11], s38 offen lds
    s_add_u32 m0, s48, 29696
    s_nop 0
    buffer_load_dwordx4 v11, s[8:11], s38 offen lds
k1w_3:
    ds_read_b64_tr_b16 v[84:85], v7 offset:0
    ds_read_b64_tr_b16 v[86:87], v7 offset:1792
    ds_read_b64_tr_b16 v[88:89], v7 offset:56
    ds_read_b64_tr_b16 v[90:91], v7 offset:1848
    ds_read_b128 v[92:95], v13 offset:0
    ds_read_b128 v[96:99], v13 offset:28672
    ds_read_b64_tr_b16 v[104:105], v7 offset:7168
    ds_read_b64_tr_b16 v[106:107], v7 offset:8960
    ds_read_b64_tr_b16 v[108:109], v7 offset:7224
    ds_read_b64_tr_b16 v[110:111], v7 offset:9016
    ds_read_b128 v[112:115], v14 offset:0
    ds_read_b128 v[116:119], v14 offset:28672
    s_waitcnt lgkmcnt(6)
    v_mfma_f32_32x32x16_bf16 v[20:35], v[84:87], v[92:95], v[20:35]
    v_mfma_f32_32x32x16_bf16 v[36:51], v[84:87], v[96:99], v[36:51]
    v_mfma_f32_32x32x16_bf16 v[52:67], v[88:91], v[92:95], v[52:67]
    v_mfma_f32_32x32x16_bf16 v[68:83], v[88:91], v[96:99], v[68:83]
    s_waitcnt lgkmcnt(0)
    v_mfma_f32_32x32x16_bf16 v[20:35], v[104:107], v[112:115], v[20:35]
    v_mfma_f32_32x32x16_bf16 v[36:51], v[104:107], v[116:119], v[36:51]
    v_mfma_f32_32x32x16_bf16 v[52:67], v[108:111], v[112:115], v[52:67]
    v_mfma_f32_32x32x16_bf16 v[68:83], v[108:111], v[116:119], v[68:83]
    s_waitcnt vmcnt(2)
    s_barrier
    s_cmp_eq_u32 s23, 7
    s_cbranch_scc1 k1w_4
    s_mul_i32 s38, s22, 96
    s_add_u32 m0, s48, 0
    s_nop 0
    buffer_load_dwordx4 v10, s[8:11], s38 offen lds
    s_add_u32 m0, s48, 1024
    s_nop 0
    buffer_load_dwordx4 v11, s[8:11], s38 offen lds
k1w_4:
    ds_read_b64_tr_b16 v[84:85], v7 offset:14336
    ds_read_b64_tr_b16 v[86:87], v7 offset:16128
    ds_read_b64_tr_b16 v[88:89], v7 offset:14392
    ds_read_b64_tr_b16 v[90:91], v7 offset:16184
    ds_read_b128 v[92:95], v15 offset:0
    ds_read_b128 v[96:99], v15 offset:28672
    ds_read_b64_tr_b16 v[104:105], v7 offset:21504
    ds_read_b64_tr_b16 v[106:107], v7 offset:23296
    ds_read_b64_tr_b16 v[108:109], v7 offset:21560
    ds_read_b64_tr_b16 v[110:111], v7 offset:23352
    ds_read_b128 v[112:115], v16 offset:0
    ds_read_b128 v[116:119], v16 offset:28672
    s_waitcnt lgkmcnt(6)
    v_mfma_f32_32x32x16_bf16 v[20:35], v[84:87], v[92:95], v[20:35]
    v_mfma_f32_32x32x16_bf16 v[36:51], v[84:87], v[96:99], v[36:51]
    v_mfma_f32_32x32x16_bf16 v[52:67], v[88:91], v[92:95], v[52:67]
    v_mfma_f32_32x32x16_bf16 v[68:83], v[88:91], v[96:99], v[68:83]
    s_waitcnt lgkmcnt(0)
    v_mfma_f32_32x32x16_bf16 v[20:35], v[104:107], v[112:115], v[20:35]
    v_mfma_f32_32x32x16_bf16 v[36:51], v[104:107], v[116:119], v[36:51]
    v_mfma_f32_32x32x16_bf16 v[52:67], v[108:111], v[112:115], v[52:67]
    v_mfma_f32_32x32x16_bf16 v[68:83], v[108:111], v[116:119], v[68:83]
    s_waitcnt vmcnt(2)
    s_barrier
    s_cmp_eq_u32 s23, 7
    s_cbranch_scc1 k1w_5
    s_mul_i32 s38, s22, 128
    s_add_u32 m0, s48, 14336
    s_nop 0
    buffer_load_dwordx4 v10, s[8:11], s38 offen lds
    s_add_u32 m0, s48, 15360
    s_nop 0
    buffer_load_dwordx4 v11, s[8:11], s38 offen lds
k1w_5:
    ds_read_b64_tr_b16 v[84:85], v7 offset:28672
    ds_read_b64_tr_b16 v[86:87], v7 offset:30464
    ds_read_b64_tr_b16 v[88:89], v7 offset:28728
    ds_read_b64_tr_b16 v[90:91], v7 offset:30520
    ds_read_b128 v[92:95], v13 offset:128
    ds_read_b128 v[96:99], v13 offset:28800
    ds_read_b64_tr_b16 v[104:105], v7 offset:35840
    ds_read_b64_tr_b16 v[106:107], v7 offset:37632
    ds_read_b64_tr_b16 v[108:109], v7 offset:35896
    ds_read_b64_tr_b16 v[110:111], v7 offset:37688
    ds_read_b128 v[112:115], v14 offset:128
    ds_read_b128 v[116:119], v14 offset:28800
    s_waitcnt lgkmcnt(6)
    v_mfma_f32_32x32x16_bf16 v[20:35], v[84:87], v[92:95], v[20:35]
    v_mfma_f32_32x32x16_bf16 v[36:51], v[84:87], v[96:99], v[36:51]
    v_mfma_f32_32x32x16_bf16 v[52:67], v[88:91], v[92:95], v[52:67]
    v_mfma_f32_32x32x16_bf16 v[68:83], v[88:91], v[96:99], v[68:83]
    s_waitcnt lgkmcnt(0)
    v_mfma_f32_32x32x16_bf16 v[20:35], v[104:107], v[112:115], v[20:35]
    v_mfma_f32_32x32x16_bf16 v[36:51], v[104:107], v[116:119], v[36:51]
    v_mfma_f32_32x32x16_bf16 v[52:67], v[108:111], v[112:115], v[52:67]
    v_mfma_f32_32x32x16_bf16 v[68:83], v[108:111], v[116:119], v[68:83]
    s_waitcnt vmcnt(2)
    s_barrier
    s_cmp_eq_u32 s23, 7
    s_cbranch_scc1 k1w_6
    s_mul_i32 s38, s22, 160
    s_add_u32 m0, s48, 28672
    s_nop 0
    buffer_load_dwordx4 v10, s[8:11], s38 offen lds
    s_add_u32 m0, s48, 29696
    s_nop 0
    buffer_load_dwordx4 v11, s[8:11], s38 offen lds
k1w_6:
    ds_read_b64_tr_b16 v[84:85], v7 offset:0
    ds_read_b64_tr_b16 v[86:87], v7 offset:1792
    ds_read_b64_tr_b16 v[88:89], v7 offset:56
    ds_read_b64_tr_b16 v[90:91], v7 offset:1848
    ds_read_b128 v[92:95], v15 offset:128
    ds_read_b128 v[96:99], v15 offset:28800
    ds_read_b64_tr_b16 v[104:105], v7 offset:7168
    ds_read_b64_tr_b16 v[106:107], v7 offset:8960
    ds_read_b64_tr_b16 v[108:109], v7 offset:7224
    ds_read_b64_tr_b16 v[110:111], v7 offset:9016
    ds_read_b128 v[112:115], v16 offset:128
    ds_read_b128 v[116:119], v16 offset:28800
    s_waitcnt lgkmcnt(6)
    v_mfma_f32_32x32x16_bf16 v[20:35], v[84:87], v[92:95], v[20:35]
    v_mfma_f32_32x32x16_bf16 v[36:51], v[84:87], v[96:99], v[36:51]
    v_mfma_f32_32x32x16_bf16 v[52:67], v[88:91], v[92:95], v[52:67]
    v_mfma_f32_32x32x16_bf16 v[68:83], v[88:91], v[96:99], v[68:83]
    s_waitcnt lgkmcnt(0)
    v_mfma_f32_32x32x16_bf16 v[20:35], v[104:107], v[112:115], v[20:35]
    v_mfma_f32_32x32x16_bf16 v[36:51], v[104:107], v[116:119], v[36:51]
    v_mfma_f32_32x32x16_bf16 v[52:67], v[108:111], v[112:115], v[52:67]
    v_mfma_f32_32x32x16_bf16 v[68:83], v[108:111], v[116:119], v[68:83]
    s_waitcnt vmcnt(2)
    s_barrier
    s_cmp_eq_u32 s23, 7
    s_cbranch_scc1 k1w_7
    s_mul_i32 s38, s22, 192
    s_add_u32 m0, s48, 0
    s_nop 0
    buffer_load_dwordx4 v10, s[8:11], s38 offen lds
    s_add_u32 m0, s48, 1024
    s_nop 0
    buffer_load_dwordx4 v11, s[8:11], s38 offen lds
k1w_7:
    ds_read_b64_tr_b16 v[84:85], v7 offset:14336
    ds_read_b64_tr_b16 v[86:87], v7 offset:16128
    ds_read_b64_tr_b16 v[88:89], v7 offset:14392
    ds_read_b64_tr_b16 v[90:91], v7 offset:16184
    ds_read_b128 v[92:95], v13 offset:256
    ds_read_b128 v[96:99], v13 offset:28928
    ds_read_b64_tr_b16 v[104:105], v7 offset:21504
    ds_read_b64_tr_b16 v[106:107], v7 offset:23296
    ds_read_b64_tr_b16 v[108:109], v7 offset:21560
    ds_read_b64_tr_b16 v[110:111], v7 offset:23352
    ds_read_b128 v[112:115], v14 offset:256
    ds_read_b128 v[116:119], v14 offset:28928
    s_waitcnt lgkmcnt(6)
    v_mfma_f32_32x32x16_bf16 v[20:35], v[84:87], v[92:95], v[20:35]
    v_mfma_f32_32x32x16_bf16 v[36:51], v[84:87], v[96:99], v[36:51]
    v_mfma_f32_32x32x16_bf16 v[52:67], v[88:91], v[92:95], v[52:67]
    v_mfma_f32_32x32x16_bf16 v[68:83], v[88:91], v[96:99], v[68:83]
    s_waitcnt lgkmcnt(0)
    v_mfma_f32_32x32x16_bf16 v[20:35], v[104:107], v[112:115], v[20:35]
    v_mfma_f32_32x32x16_bf16 v[36:51], v[104:107], v[116:119], v[36:51]
    v_mfma_f32_32x32x16_bf16 v[52:67], v[108:111], v[112:115], v[52:67]
    v_mfma_f32_32x32x16_bf16 v[68:83], v[108:111], v[116:119], v[68:83]
    s_waitcnt vmcnt(2)
    s_barrier
    s_cmp_eq_u32 s23, 7
    s_cbranch_scc1 k1w_8
    s_mul_i32 s38, s22, 224
    s_add_u32 m0, s48, 14336
    s_nop 0
    buffer_load_dwordx4 v10, s[8:11], s38 offen lds
    s_add_u32 m0, s48, 15360
    s_nop 0
    buffer_load_dwordx4 v11, s[8:11], s38 offen lds
k1w_8:
    ds_read_b64_tr_b16 v[84:85], v7 offset:28672
    ds_read_b64_tr_b16 v[86:87], v7 offset:30464
    ds_read_b64_tr_b16 v[88:89], v7 offset:28728
    ds_read_b64_tr_b16 v[90:91], v7 offset:30520
    ds_read_b128 v[92:95], v15 offset:256
    ds_read_b128 v[96:99], v15 offset:28928
    ds_read_b64_tr_b16 v[104:105], v7 offset:35840
    ds_read_b64_tr_b16 v[106:107], v7 offset:37632
    ds_read_b64_tr_b16 v[108:109], v7 offset:35896
    ds_read_b64_tr_b16 v[110:111], v7 offset:37688
    ds_read_b128 v[112:115], v16 offset:256
    ds_read_b128 v[116:119], v16 offset:28928
    s_waitcnt lgkmcnt(6)
    v_mfma_f32_32x32x16_bf16 v[20:35], v[84:87], v[92:95], v[20:35]
    v_mfma_f32_32x32x16_bf16 v[36:51], v[84:87], v[96:99], v[36:51]
    v_mfma_f32_32x32x16_bf16 v[52:67], v[88:91], v[92:95], v[52:67]
    v_mfma_f32_32x32x16_bf16 v[68:83], v[88:91], v[96:99], v[68:83]
    s_waitcnt lgkmcnt(0)
    v_mfma_f32_32x32x16_bf16 v[20:35], v[104:107], v[112:115], v[20:35]
    v_mfma_f32_32x32x16_bf16 v[36:51], v[104:107], v[116:119], v[36:51]
    v_mfma_f32_32x32x16_bf16 v[52:67], v[108:111], v[112:115], v[52:67]
    v_mfma_f32_32x32x16_bf16 v[68:83], v[108:111], v[116:119], v[68:83]
    s_waitcnt vmcnt(2)
    s_barrier
    s_cmp_eq_u32 s23, 7
    s_cbranch_scc1 k1w_9
    s_mul_i32 s38, s22, 256
    s_add_u32 m0, s48, 28672
    s_nop 0
    buffer_load_dwordx4 v10, s[8:11], s38 offen lds
    s_add_u32 m0, s48, 29696
    s_nop 0
    buffer_load_dwordx4 v11, s[8:11], s38 offen lds
k1w_9:
    ds_read_b64_tr_b16 v[84:85], v7 offset:0
    ds_read_b64_tr_b16 v[86:87], v7 offset:1792
    ds_read_b64_tr_b16 v[88:89], v7 offset:56
    ds_read_b64_tr_b16 v[90:91], v7 offset:1848
    ds_read_b128 v[92:95], v13 offset:384
    ds_read_b128 v[96:99], v13 offset:29056
    ds_read_b64_tr_b16 v[104:105], v7 offset:7168
    ds_read_b64_tr_b16 v[106:107], v7 offset:8960
    ds_read_b64_tr_b16 v[108:109], v7 offset:7224
    ds_read_b64_tr_b16 v[110:111], v7 offset:9016
    ds_read_b128 v[112:115], v14 offset:384
    ds_read_b128 v[116:119], v14 offset:29056
    s_waitcnt lgkmcnt(6)
    v_mfma_f32_32x32x16_bf16 v[20:35], v[84:87], v[92:95], v[20:35]
    v_mfma_f32_32x32x16_bf16 v[36:51], v[84:87], v[96:99], v[36:51]
    v_mfma_f32_32x32x16_bf16 v[52:67], v[88:91], v[92:95], v[52:67]
    v_mfma_f32_32x32x16_bf16 v[68:83], v[88:91], v[96:99], v[68:83]
    s_waitcnt lgkmcnt(0)
    v_mfma_f32_32x32x16_bf16 v[20:35], v[104:107], v[112:115], v[20:35]
    v_mfma_f32_32x32x16_bf16 v[36:51], v[104:107], v[116:119], v[36:51]
    v_mfma_f32_32x32x16_bf16 v[52:67], v[108:111], v[112:115], v[52:67]
    v_mfma_f32_32x32x16_bf16 v[68:83], v[108:111], v[116:119], v[68:83]
    s_waitcnt vmcnt(2)
    s_barrier
    s_cmp_eq_u32 s23, 7
    s_cbranch_scc1 k1w_10
    s_mul_i32 s38, s22, 288
    s_add_u32 m0, s48, 0
    s_nop 0
    buffer_load_dwordx4 v10, s[8:11], s38 offen lds
    s_add_u32 m0, s48, 1024
    s_nop 0
    buffer_load_dwordx4 v11, s[8:11], s38 offen lds
k1w_10:
    ds_read_b64_tr_b16 v[84:85], v7 offset:14336
    ds_read_b64_tr_b16 v[86:87], v7 offset:16128
    ds_read_b64_tr_b16 v[88:89], v7 offset:14392
    ds_read_b64_tr_b16 v[90:91], v7 offset:16184
    ds_read_b128 v[92:95], v15 offset:384
    ds_read_b128 v[96:99], v15 offset:29056
    ds_read_b64_tr_b16 v[104:105], v7 offset:21504
    ds_read_b64_tr_b16 v[106:107], v7 offset:23296
    ds_read_b64_tr_b16 v[108:109], v7 offset:21560
    ds_read_b64_tr_b16 v[110:111], v7 offset:23352
    ds_read_b128 v[112:115], v16 offset:384
    ds_read_b128 v[116:119], v16 offset:29056
    s_waitcnt lgkmcnt(6)
    v_mfma_f32_32x32x16_bf16 v[20:35], v[84:87], v[92:95], v[20:35]
    v_mfma_f32_32x32x16_bf16 v[36:51], v[84:87], v[96:99], v[36:51]
    v_mfma_f32_32x32x16_bf16 v[52:67], v[88:91], v[92:95], v[52:67]
    v_mfma_f32_32x32x16_bf16 v[68:83], v[88:91], v[96:99], v[68:83]
    s_waitcnt lgkmcnt(0)
    v_mfma_f32_32x32x16_bf16 v[20:35], v[104:107], v[112:115], v[20:35]
    v_mfma_f32_32x32x16_bf16 v[36:51], v[104:107], v[116:119], v[36:51]
    v_mfma_f32_32x32x16_bf16 v[52:67], v[108:111], v[112:115], v[52:67]
    v_mfma_f32_32x32x16_bf16 v[68:83], v[108:111], v[116:119], v[68:83]
    s_waitcnt vmcnt(2)
    s_barrier
    s_cmp_eq_u32 s23, 7
    s_cbranch_scc1 k1w_11
    s_mul_i32 s38, s22, 320
    s_add_u32 m0, s48, 14336
    s_nop 0
    buffer_load_dwordx4 v10, s[8:11], s38 offen lds
    s_add_u32 m0, s48, 15360
    s_nop 0
    buffer_load_dwordx4 v11, s[8:11], s38 offen lds
k1w_11:
    ds_read_b64_tr_b16 v[84:85], v7 offset:28672
    ds_read_b64_tr_b16 v[86:87], v7 offset:30464
    ds_read_b64_tr_b16 v[88:89], v7 offset:28728
    ds_read_b64_tr_b16 v[90:91], v7 offset:30520
    ds_read_b128 v[92:95], v13 offset:512
    ds_read_b128 v[96:99], v13 offset:29184
    ds_read_b64_tr_b16 v[104:105], v7 offset:35840
    ds_read_b64_tr_b16 v[106:107], v7 offset:37632
    ds_read_b64_tr_b16 v[108:109], v7 offset:35896
    ds_read_b64_tr_b16 v[110:111], v7 offset:37688
    ds_read_b128 v[112:115], v14 offset:512
    ds_read_b128 v[116:119], v14 offset:29184
    s_waitcnt lgkmcnt(6)
    v_mfma_f32_32x32x16_bf16 v[20:35], v[84:87], v[92:95], v[20:35]
    v_mfma_f32_32x32x16_bf16 v[36:51], v[84:87], v[96:99], v[36:51]
    v_mfma_f32_32x32x16_bf16 v[52:67], v[88:91], v[92:95], v[52:67]
    v_mfma_f32_32x32x16_bf16 v[68:83], v[88:91], v[96:99], v[68:83]
    s_waitcnt lgkmcnt(0)
    v_mfma_f32_32x32x16_bf16 v[20:35], v[104:107], v[112:115], v[20:35]
    v_mfma_f32_32x32x16_bf16 v[36:51], v[104:107], v[116:119], v[36:51]
    v_mfma_f32_32x32x16_bf16 v[52:67], v[108:111], v[112:115], v[52:67]
    v_mfma_f32_32x32x16_bf16 v[68:83], v[108:111], v[116:119], v[68:83]
    s_waitcnt vmcnt(2)
    s_barrier
    s_cmp_eq_u32 s23, 7
    s_cbranch_scc1 k1w_12
    s_mul_i32 s38, s22, 352
    s_add_u32 m0, s48, 28672
    s_nop 0
    buffer_load_dwordx4 v10, s[8:11], s38 offen lds
    s_add_u32 m0, s48, 29696
    s_nop 0
    buffer_load_dwordx4 v11, s[8:11], s38 offen lds
k1w_12:
    ds_read_b64_tr_b16 v[84:85], v7 offset:0
    ds_read_b64_tr_b16 v[86:87], v7 offset:1792
    ds_read_b64_tr_b16 v[88:89], v7 offset:56
    ds_read_b64_tr_b16 v[90:91], v7 offset:1848
    ds_read_b128 v[92:95], v15 offset:512
    ds_read_b128 v[96:99], v15 offset:29184
    ds_read_b64_tr_b16 v[104:105], v7 offset:7168
    ds_read_b64_tr_b16 v[106:107], v7 offset:8960
    ds_read_b64_tr_b16 v[108:109], v7 offset:7224
    ds_read_b64_tr_b16 v[110:111], v7 offset:9016
    ds_read_b128 v[112:115], v16 offset:512
    ds_read_b128 v[116:119], v16 offset:29184
    s_waitcnt lgkmcnt(6)
    v_mfma_f32_32x32x16_bf16 v[20:35], v[84:87], v[92:95], v[20:35]
    v_mfma_f32_32x32x16_bf16 v[36:51], v[84:87], v[96:99], v[36:51]
    v_mfma_f32_32x32x16_bf16 v[52:67], v[88:91], v[92:95], v[52:67]
    v_mfma_f32_32x32x16_bf16 v[68:83], v[88:91], v[96:99], v[68:83]
    s_waitcnt lgkmcnt(0)
    v_mfma_f32_32x32x16_bf16 v[20:35], v[104:107], v[112:115], v[20:35]
    v_mfma_f32_32x32x16_bf16 v[36:51], v[104:107], v[116:119], v[36:51]
    v_mfma_f32_32x32x16_bf16 v[52:67], v[108:111], v[112:115], v[52:67]
    v_mfma_f32_32x32x16_bf16 v[68:83], v[108:111], v[116:119], v[68:83]
    s_waitcnt vmcnt(2)
    s_barrier
    s_cmp_eq_u32 s23, 7
    s_cbranch_scc1 k1w_13
    s_mul_i32 s38, s22, 384
    s_add_u32 m0, s48, 0
    s_nop 0
    buffer_load_dwordx4 v10, s[8:11], s38 offen lds
    s_add_u32 m0, s48, 1024
    s_nop 0
    buffer_load_dwordx4 v11, s[8:11], s38 offen lds
k1w_13:
    ds_read_b64_tr_b16 v[84:85], v7 offset:14336
    ds_read_b64_tr_b16 v[86:87], v7 offset:16128
    ds_read_b64_tr_b16 v[88:89], v7 offset:14392
    ds_read_b64_tr_b16 v[90:91], v7 offset:16184
    ds_read_b128 v[92:95], v13 offset:640
    ds_read_b128 v[96:99], v13 offset:29312
    ds_read_b64_tr_b16 v[104:105], v7 offset:21504
    ds_read_b64_tr_b16 v[106:107], v7 offset:23296
    ds_read_b64_tr_b16 v[108:109], v7 offset:21560
    ds_read_b64_tr_b16 v[110:111], v7 offset:23352
    ds_read_b128 v[112:115], v14 offset:640
    ds_read_b128 v[116:119], v14 offset:29312
    s_waitcnt lgkmcnt(6)
    v_mfma_f32_32x32x16_bf16 v[20:35], v[84:87], v[92:95], v[20:35]
    v_mfma_f32_32x32x16_bf16 v[36:51], v[84:87], v[96:99], v[36:51]
    v_mfma_f32_32x32x16_bf16 v[52:67], v[88:91], v[92:95], v[52:67]
    v_mfma_f32_32x32x16_bf16 v[68:83], v[88:91], v[96:99], v[68:83]
    s_waitcnt lgkmcnt(0)
    v_mfma_f32_32x32x16_bf16 v[20:35], v[104:107], v[112:115], v[20:35]
    v_mfma_f32_32x32x16_bf16 v[36:51], v[104:107], v[116:119], v[36:51]
    v_mfma_f32_32x32x16_bf16 v[52:67], v[108:111], v[112:115], v[52:67]
    v_mfma_f32_32x32x16_bf16 v[68:83], v[108:111], v[116:119], v[68:83]
    s_waitcnt vmcnt(2)
    s_barrier
    s_cmp_eq_u32 s23, 7
    s_cbranch_scc1 k1w_14
    s_mul_i32 s38, s22, 416
    s_add_u32 m0, s48, 14336
    s_nop 0
    buffer_load_dwordx4 v10, s[8:11], s38 offen lds
    s_add_u32 m0, s48, 15360
    s_nop 0
    buffer_load_dwordx4 v11, s[8:11], s38 offen lds
k1w_14:
    ds_read_b64_tr_b16 v[84:85], v7 offset:28672
    ds_read_b64_tr_b16 v[86:87], v7 offset:30464
    ds_read_b64_tr_b16 v[88:89], v7 offset:28728
    ds_read_b64_tr_b16 v[90:91], v7 offset:30520
    ds_read_b128 v[92:95], v15 offset:640
    ds_read_b128 v[96:99], v15 offset:29312
    ds_read_b64_tr_b16 v[104:105], v7 offset:35840
    ds_read_b64_tr_b16 v[106:107], v7 offset:37632
    ds_read_b64_tr_b16 v[108:109], v7 offset:35896
    ds_read_b64_tr_b16 v[110:111], v7 offset:37688
    ds_read_b128 v[112:115], v16 offset:640
    ds_read_b128 v[116:119], v16 offset:29312
    s_waitcnt lgkmcnt(6)
    v_mfma_f32_32x32x16_bf16 v[20:35], v[84:87], v[92:95], v[20:35]
    v_mfma_f32_32x32x16_bf16 v[36:51], v[84:87], v[96:99], v[36:51]
    v_mfma_f32_32x32x16_bf16 v[52:67], v[88:91], v[92:95], v[52:67]
    v_mfma_f32_32x32x16_bf16 v[68:83], v[88:91], v[96:99], v[68:83]
    s_waitcnt lgkmcnt(0)
    v_mfma_f32_32x32x16_bf16 v[20:35], v[104:107], v[112:115], v[20:35]
    v_mfma_f32_32x32x16_bf16 v[36:51], v[104:107], v[116:119], v[36:51]
    v_mfma_f32_32x32x16_bf16 v[52:67], v[108:111], v[112:115], v[52:67]
    v_mfma_f32_32x32x16_bf16 v[68:83], v[108:111], v[116:119], v[68:83]
    s_waitcnt vmcnt(2)
    s_barrier
    ds_read_b64_tr_b16 v[84:85], v7 offset:0
    ds_read_b64_tr_b16 v[86:87], v7 offset:1792
    ds_read_b64_tr_b16 v[88:89], v7 offset:56
    ds_read_b64_tr_b16 v[90:91], v7 offset:1848
    ds_read_b128 v[92:95], v13 offset:768
    ds_read_b128 v[96:99], v13 offset:29440
    ds_read_b64_tr_b16 v[104:105], v7 offset:7168
    ds_read_b64_tr_b16 v[106:107], v7 offset:8960
    ds_read_b64_tr_b16 v[108:109], v7 offset:7224
    ds_read_b64_tr_b16 v[110:111], v7 offset:9016
    ds_read_b128 v[112:115], v14 offset:768
    ds_read_b128 v[116:119], v14 offset:29440
    s_waitcnt lgkmcnt(6)
    v_mfma_f32_32x32x16_bf16 v[20:35], v[84:87], v[92:95], v[20:35]
    v_mfma_f32_32x32x16_bf16 v[36:51], v[84:87], v[96:99], v[36:51]
    v_mfma_f32_32x32x16_bf16 v[52:67], v[88:91], v[92:95], v[52:67]
    v_mfma_f32_32x32x16_bf16 v[68:83], v[88:91], v[96:99], v[68:83]
    s_waitcnt lgkmcnt(0)
    v_mfma_f32_32x32x16_bf16 v[20:35], v[104:107], v[112:115], v[20:35]
    v_mfma_f32_32x32x16_bf16 v[36:51], v[104:107], v[116:119], v[36:51]
    v_mfma_f32_32x32x16_bf16 v[52:67], v[108:111], v[112:115], v[52:67]
    v_mfma_f32_32x32x16_bf16 v[68:83], v[108:111], v[116:119], v[68:83]
    s_waitcnt vmcnt(0)
    s_barrier
    ds_read_b64_tr_b16 v[84:85], v7 offset:14336
    ds_read_b64_tr_b16 v[86:87], v7 offset:16128
    ds_read_b64_tr_b16 v[88:89], v7 offset:14392
    ds_read_b64_tr_b16 v[90:91], v7 offset:16184
    ds_read_b128 v[92:95], v15 offset:768
    ds_read_b128 v[96:99], v15 offset:29440
    ds_read_b64_tr_b16 v[104:105], v7 offset:21504
    ds_read_b64_tr_b16 v[106:107], v7 offset:23296
    ds_read_b64_tr_b16 v[108:109], v7 offset:21560
    ds_read_b64_tr_b16 v[110:111], v7 offset:23352
    ds_read_b128 v[112:115], v16 offset:768
    ds_read_b128 v[116:119], v16 offset:29440
    s_waitcnt lgkmcnt(6)
    v_mfma_f32_32x32x16_bf16 v[20:35], v[84:87], v[92:95], v[20:35]
    v_mfma_f32_32x32x16_bf16 v[36:51], v[84:87], v[96:99], v[36:51]
    v_mfma_f32_32x32x16_bf16 v[52:67], v[88:91], v[92:95], v[52:67]
    v_mfma_f32_32x32x16_bf16 v[68:83], v[88:91], v[96:99], v[68:83]
    s_waitcnt lgkmcnt(0)
    v_mfma_f32_32x32x16_bf16 v[20:35], v[104:107], v[112:115], v[20:35]
    v_mfma_f32_32x32x16_bf16 v[36:51], v[104:107], v[116:119], v[36:51]
    v_mfma_f32_32x32x16_bf16 v[52:67], v[108:111], v[112:115], v[52:67]
    v_mfma_f32_32x32x16_bf16 v[68:83], v[108:111], v[116:119], v[68:83]
    s_mov_b32 s56, s54
    s_and_b32 s57, s55, 0xffff
    s_mov_b32 s58, 8388608
    s_mov_b32 s59, 0x00020000
    s_and_b32 s38, s2, 7
    s_lshl_b32 s38, s38, 20
    s_lshr_b32 s49, s2, 3
    s_lshl_b32 s49, s49, 13
    s_add_u32 s38, s38, s49
    buffer_load_dwordx4 v[232:235], v3, s[56:59], s38 offen
    s_add_u32 s38, s38, 229376
    buffer_load_dwordx4 v[232:235], v3, s[56:59], s38 offen
    s_add_u32 s38, s38, 229376
    buffer_load_dwordx4 v[232:235], v3, s[56:59], s38 offen
    s_add_u32 s38, s38, 229376
    buffer_load_dwordx4 v[232:235], v3, s[56:59], s38 offen
    s_add_u32 s38, s38, 229376
    buffer_load_dwordx4 v[232:235], v3, s[56:59], s38 offen
    s_add_u32 s38, s38, 229376
    s_barrier
    s_and_b32 s39, s21, 1
    s_lshl_b32 s39, s39, 3
    s_lshr_b32 s40, s23, 1
    s_lshl_b32 s40, s40, 1
    s_add_u32 s39, s39, s40
    s_mov_b32 s42, 0
    s_mov_b32 s43, -1
    v_and_b32 v2, 31, v1
    v_lshrrev_b32 v3, 5, v1
    s_mul_i32 s45, s23, 17408
    v_mul_u32_u24 v4, 272, v2
    v_lshl_add_u32 v4, v3, 3, v4
    v_add_u32 v4, s45, v4
    s_lshl_b32 s40, s20, 7
    s_and_b32 s41, s23, 1
    s_lshl_b32 s41, s41, 6
    s_add_u32 s40, s40, s41
    s_cmp_ge_u32 s21, 4
    s_cbranch_scc1 k1_vpath
    s_mov_b32 s44, 1069066811
    s_mov_b32 s45, 1069066811
    s_mov_b32 s46, 3216550459
    s_mov_b32 s47, 3216550459
    s_mul_i32 s53, s23, 17408
    v_cvt_pk_bf16_f32 v140, v20, v21
    v_cvt_pk_bf16_f32 v141, v22, v23
    v_cvt_pk_bf16_f32 v142, v24, v25
    v_cvt_pk_bf16_f32 v143, v26, v27
    v_cvt_pk_bf16_f32 v144, v28, v29
    v_cvt_pk_bf16_f32 v145, v30, v31
    v_cvt_pk_bf16_f32 v146, v32, v33
    v_cvt_pk_bf16_f32 v147, v34, v35
    v_cndmask_b32 v146, v146, 0, s[42:43]
    v_cndmask_b32 v147, v147, 0, s[42:43]
    s_nop 1
    v_mfma_f32_32x32x16_bf16 v[172:187], v[124:127], v[140:143], 0
    v_mfma_f32_32x32x16_bf16 v[172:187], v[128:131], v[144:147], v[172:187]
    s_nop 11
    v_cvt_pk_bf16_f32 v166, v172, v173
    v_lshlrev_b32 v148, 16, v166
    v_and_b32 v149, 0xffff0000, v166
    v_cvt_pk_bf16_f32 v166, v174, v175
    v_lshlrev_b32 v150, 16, v166
    v_and_b32 v151, 0xffff0000, v166
    v_cvt_pk_bf16_f32 v166, v176, v177
    v_lshlrev_b32 v152, 16, v166
    v_and_b32 v153, 0xffff0000, v166
    v_cvt_pk_bf16_f32 v166, v178, v179
    v_lshlrev_b32 v154, 16, v166
    v_and_b32 v155, 0xffff0000, v166
    v_cvt_pk_bf16_f32 v166, v180, v181
    v_lshlrev_b32 v156, 16, v166
    v_and_b32 v157, 0xffff0000, v166
    v_cvt_pk_bf16_f32 v166, v182, v183
    v_lshlrev_b32 v158, 16, v166
    v_and_b32 v159, 0xffff0000, v166
    v_cvt_pk_bf16_f32 v166, v184, v185
    v_lshlrev_b32 v160, 16, v166
    v_and_b32 v161, 0xffff0000, v166
    v_cvt_pk_bf16_f32 v166, v186, v187
    v_lshlrev_b32 v162, 16, v166
    v_and_b32 v163, 0xffff0000, v166
    v_cndmask_b32 v160, v160, v159, s[42:43]
    v_cndmask_b32 v161, v161, v159, s[42:43]
    v_cndmask_b32 v162, v162, v159, s[42:43]
    v_cndmask_b32 v163, v163, v159, s[42:43]
    v_max3_f32 v164, v148, v149, v150
    v_min3_f32 v165, v148, v149, v150
    v_max3_f32 v164, v164, v151, v152
    v_min3_f32 v165, v165, v151, v152
    v_max3_f32 v164, v164, v153, v154
    v_min3_f32 v165, v165, v153, v154
    v_max3_f32 v164, v164, v155, v156
    v_min3_f32 v165, v165, v155, v156
    v_max3_f32 v164, v164, v157, v158
    v_min3_f32 v165, v165, v157, v158
    v_max3_f32 v164, v164, v159, v160
    v_min3_f32 v165, v165, v159, v160
    v_max3_f32 v164, v164, v161, v162
    v_min3_f32 v165, v165, v161, v162
    v_max_f32 v164, v164, v163
    v_min_f32 v165, v165, v163
    v_mov_b32 v166, v164
    v_mov_b32 v167, v164
    s_nop 1
    v_permlane32_swap_b32 v166, v167
    s_nop 1
    v_max_f32 v164, v166, v167
    v_mov_b32 v166, v165
    v_mov_b32 v167, v165
    s_nop 1
    v_permlane32_swap_b32 v166, v167
    s_nop 1
    v_min_f32 v165, v166, v167
    v_mul_f32 v188, s44, v164
    v_mul_f32 v190, s44, v165
    v_sub_f32 v188, 0, v188
    v_pk_fma_f32 v[100:101], v[148:149], s[44:45], v[188:189] op_sel_hi:[1,1,0]
    v_pk_fma_f32 v[84:85], v[148:149], s[46:47], v[190:191] op_sel_hi:[1,1,0]
    v_pk_fma_f32 v[102:103], v[150:151], s[44:45], v[188:189] op_sel_hi:[1,1,0]
    v_pk_fma_f32 v[86:87], v[150:151], s[46:47], v[190:191] op_sel_hi:[1,1,0]
    v_pk_fma_f32 v[104:105], v[152:153], s[44:45], v[188:189] op_sel_hi:[1,1,0]
    v_pk_fma_f32 v[88:89], v[152:153], s[46:47], v[190:191] op_sel_hi:[1,1,0]
    v_pk_fma_f32 v[106:107], v[154:155], s[44:45], v[188:189] op_sel_hi:[1,1,0]
    v_pk_fma_f32 v[90:91], v[154:155], s[46:47], v[190:191] op_sel_hi:[1,1,0]
    v_pk_fma_f32 v[108:109], v[156:157], s[44:45], v[188:189] op_sel_hi:[1,1,0]
    v_pk_fma_f32 v[92:93], v[156:157], s[46:47], v[190:191] op_sel_hi:[1,1,0]
    v_pk_fma_f32 v[110:111], v[158:159], s[44:45], v[188:189] op_sel_hi:[1,1,0]
    v_pk_fma_f32 v[94:95], v[158:159], s[46:47], v[190:191] op_sel_hi:[1,1,0]
    v_pk_fma_f32 v[112:113], v[160:161], s[44:45], v[188:189] op_sel_hi:[1,1,0]
    v_pk_fma_f32 v[96:97], v[160:161], s[46:47], v[190:191] op_sel_hi:[1,1,0]
    v_pk_fma_f32 v[114:115], v[162:163], s[44:45], v[188:189] op_sel_hi:[1,1,0]
    v_pk_fma_f32 v[98:99], v[162:163], s[46:47], v[190:191] op_sel_hi:[1,1,0]
    v_exp_f32 v100, v100
    v_exp_f32 v84, v84
    v_exp_f32 v101, v101
    v_exp_f32 v85, v85
    v_exp_f32 v102, v102
    v_exp_f32 v86, v86
    v_exp_f32 v103, v103
    v_exp_f32 v87, v87
    v_exp_f32 v104, v104
    v_exp_f32 v88, v88
    v_exp_f32 v105, v105
    v_exp_f32 v89, v89
    v_exp_f32 v106, v106
    v_exp_f32 v90, v90
    v_exp_f32 v107, v107
    v_exp_f32 v91, v91
    v_exp_f32 v108, v108
    v_exp_f32 v92, v92
    v_exp_f32 v109, v109
    v_exp_f32 v93, v93
    v_exp_f32 v110, v110
    v_exp_f32 v94, v94
    v_exp_f32 v111, v111
    v_exp_f32 v95, v95
    v_exp_f32 v112, v112
    v_exp_f32 v96, v96
    v_exp_f32 v113, v113
    v_exp_f32 v97, v97
    v_exp_f32 v114, v114
    v_exp_f32 v98, v98
    v_exp_f32 v115, v115
    v_exp_f32 v99, v99
    s_nop 0
    v_cndmask_b32 v112, v112, 0, s[42:43]
    v_cndmask_b32 v96, v96, 0, s[42:43]
    v_cndmask_b32 v113, v113, 0, s[42:43]
    v_cndmask_b32 v97, v97, 0, s[42:43]
    v_cndmask_b32 v114, v114, 0, s[42:43]
    v_cndmask_b32 v98, v98, 0, s[42:43]
    v_cndmask_b32 v115, v115, 0, s[42:43]
    v_cndmask_b32 v99, v99, 0, s[42:43]
    v_pk_add_f32 v[192:193], v[100:101], v[102:103]
    v_pk_add_f32 v[194:195], v[84:85], v[86:87]
    v_pk_add_f32 v[192:193], v[192:193], v[104:105]
    v_pk_add_f32 v[194:195], v[194:195], v[88:89]
    v_pk_add_f32 v[192:193], v[192:193], v[106:107]
    v_pk_add_f32 v[194:195], v[194:195], v[90:91]
    v_pk_add_f32 v[192:193], v[192:193], v[108:109]
    v_pk_add_f32 v[194:195], v[194:195], v[92:93]
    v_pk_add_f32 v[192:193], v[192:193], v[110:111]
    v_pk_add_f32 v[194:195], v[194:195], v[94:95]
    v_pk_add_f32 v[192:193], v[192:193], v[112:113]
    v_pk_add_f32 v[194:195], v[194:195], v[96:97]
    v_pk_add_f32 v[192:193], v[192:193], v[114:115]
    v_pk_add_f32 v[194:195], v[194:195], v[98:99]
    v_add_f32 v168, v192, v193
    v_add_f32 v169, v194, v195
    v_mov_b32 v166, v168
    v_mov_b32 v167, v168
    s_nop 1
    v_permlane32_swap_b32 v166, v167
    s_nop 1
    v_add_f32 v168, v166, v167
    v_mov_b32 v166, v169
    v_mov_b32 v167, v169
    s_nop 1
    v_permlane32_swap_b32 v166, v167
    s_nop 1
    v_add_f32 v169, v166, v167
    v_rcp_f32 v192, v168
    v_rcp_f32 v194, v169
    s_nop 0
    v_pk_mul_f32 v[100:101], v[100:101], v[192:193] op_sel_hi:[1,0]
    v_pk_mul_f32 v[84:85], v[84:85], v[194:195] op_sel_hi:[1,0]
    v_pk_mul_f32 v[102:103], v[102:103], v[192:193] op_sel_hi:[1,0]
    v_pk_mul_f32 v[86:87], v[86:87], v[194:195] op_sel_hi:[1,0]
    v_pk_mul_f32 v[104:105], v[104:105], v[192:193] op_sel_hi:[1,0]
    v_pk_mul_f32 v[88:89], v[88:89], v[194:195] op_sel_hi:[1,0]
    v_pk_mul_f32 v[106:107], v[106:107], v[192:193] op_sel_hi:[1,0]
    v_pk_mul_f32 v[90:91], v[90:91], v[194:195] op_sel_hi:[1,0]
    v_pk_mul_f32 v[108:109], v[108:109], v[192:193] op_sel_hi:[1,0]
    v_pk_mul_f32 v[92:93], v[92:93], v[194:195] op_sel_hi:[1,0]
    v_pk_mul_f32 v[110:111], v[110:111], v[192:193] op_sel_hi:[1,0]
    v_pk_mul_f32 v[94:95], v[94:95], v[194:195] op_sel_hi:[1,0]
    v_pk_mul_f32 v[112:113], v[112:113], v[192:193] op_sel_hi:[1,0]
    v_pk_mul_f32 v[96:97], v[96:97], v[194:195] op_sel_hi:[1,0]
    v_pk_mul_f32 v[114:115], v[114:115], v[192:193] op_sel_hi:[1,0]
    v_pk_mul_f32 v[98:99], v[98:99], v[194:195] op_sel_hi:[1,0]
    v_cvt_pk_bf16_f32 v100, v100, v101
    v_cvt_pk_bf16_f32 v84, v84, v85
    v_cvt_pk_bf16_f32 v101, v102, v103
    v_cvt_pk_bf16_f32 v85, v86, v87
    v_cvt_pk_bf16_f32 v102, v104, v105
    v_cvt_pk_bf16_f32 v86, v88, v89
    v_cvt_pk_bf16_f32 v103, v106, v107
    v_cvt_pk_bf16_f32 v87, v90, v91
    v_cvt_pk_bf16_f32 v104, v108, v109
    v_cvt_pk_bf16_f32 v88, v92, v93
    v_cvt_pk_bf16_f32 v105, v110, v111
    v_cvt_pk_bf16_f32 v89, v94, v95
    v_cvt_pk_bf16_f32 v106, v112, v113
    v_cvt_pk_bf16_f32 v90, v96, v97
    v_cvt_pk_bf16_f32 v107, v114, v115
    v_cvt_pk_bf16_f32 v91, v98, v99
    ds_write_b64 v4, v[100:101] offset:0
    ds_write_b64 v4, v[84:85] offset:64
    ds_write_b64 v4, v[102:103] offset:16
    ds_write_b64 v4, v[86:87] offset:80
    ds_write_b64 v4, v[104:105] offset:32
    ds_write_b64 v4, v[88:89] offset:96
    ds_write_b64 v4, v[106:107] offset:48
    ds_write_b64 v4, v[90:91] offset:112
    v_cvt_pk_bf16_f32 v140, v36, v37
    v_cvt_pk_bf16_f32 v141, v38, v39
    v_cvt_pk_bf16_f32 v142, v40, v41
    v_cvt_pk_bf16_f32 v143, v42, v43
    v_cvt_pk_bf16_f32 v144, v44, v45
    v_cvt_pk_bf16_f32 v145, v46, v47
    v_cvt_pk_bf16_f32 v146, v48, v49
    v_cvt_pk_bf16_f32 v147, v50, v51
    v_cndmask_b32 v146, v146, 0, s[42:43]
    v_cndmask_b32 v147, v147, 0, s[42:43]
    s_nop 1
    v_mfma_f32_32x32x16_bf16 v[172:187], v[124:127], v[140:143], 0
    v_mfma_f32_32x32x16_bf16 v[172:187], v[128:131], v[144:147], v[172:187]
    s_nop 11
    v_cvt_pk_bf16_f32 v166, v172, v173
    v_lshlrev_b32 v148, 16, v166
    v_and_b32 v149, 0xffff0000, v166
    v_cvt_pk_bf16_f32 v166, v174, v175
    v_lshlrev_b32 v150, 16, v166
    v_and_b32 v151, 0xffff0000, v166
    v_cvt_pk_bf16_f32 v166, v176, v177
    v_lshlrev_b32 v152, 16, v166
    v_and_b32 v153, 0xffff0000, v166
    v_cvt_pk_bf16_f32 v166, v178, v179
    v_lshlrev_b32 v154, 16, v166
    v_and_b32 v155, 0xffff0000, v166
    v_cvt_pk_bf16_f32 v166, v180, v181
    v_lshlrev_b32 v156, 16, v166
    v_and_b32 v157, 0xffff0000, v166
    v_cvt_pk_bf16_f32 v166, v182, v183
    v_lshlrev_b32 v158, 16, v166
    v_and_b32 v159, 0xffff0000, v166
    v_cvt_pk_bf16_f32 v166, v184, v185
    v_lshlrev_b32 v160, 16, v166
    v_and_b32 v161, 0xffff0000, v166
    v_cvt_pk_bf16_f32 v166, v186, v187
    v_lshlrev_b32 v162, 16, v166
    v_and_b32 v163, 0xffff0000, v166
    v_cndmask_b32 v160, v160, v159, s[42:43]
    v_cndmask_b32 v161, v161, v159, s[42:43]
    v_cndmask_b32 v162, v162, v159, s[42:43]
    v_cndmask_b32 v163, v163, v159, s[42:43]
    v_max3_f32 v164, v148, v149, v150
    v_min3_f32 v165, v148, v149, v150
    v_max3_f32 v164, v164, v151, v152
    v_min3_f32 v165, v165, v151, v152
    v_max3_f32 v164, v164, v153, v154
    v_min3_f32 v165, v165, v153, v154
    v_max3_f32 v164, v164, v155, v156
    v_min3_f32 v165, v165, v155, v156
    v_max3_f32 v164, v164, v157, v158
    v_min3_f32 v165, v165, v157, v158
    v_max3_f32 v164, v164, v159, v160
    v_min3_f32 v165, v165, v159, v160
    v_max3_f32 v164, v164, v161, v162
    v_min3_f32 v165, v165, v161, v162
    v_max_f32 v164, v164, v163
    v_min_f32 v165, v165, v163
    v_mov_b32 v166, v164
    v_mov_b32 v167, v164
    s_nop 1
    v_permlane32_swap_b32 v166, v167
    s_nop 1
    v_max_f32 v164, v166, v167
    v_mov_b32 v166, v165
    v_mov_b32 v167, v165
    s_nop 1
    v_permlane32_swap_b32 v166, v167
    s_nop 1
    v_min_f32 v165, v166, v167
    v_mul_f32 v188, s44, v164
    v_mul_f32 v190, s44, v165
    v_sub_f32 v188, 0, v188
    v_pk_fma_f32 v[100:101], v[148:149], s[44:45], v[188:189] op_sel_hi:[1,1,0]
    v_pk_fma_f32 v[84:85], v[148:149], s[46:47], v[190:191] op_sel_hi:[1,1,0]
    v_pk_fma_f32 v[102:103], v[150:151], s[44:45], v[188:189] op_sel_hi:[1,1,0]
    v_pk_fma_f32 v[86:87], v[150:151], s[46:47], v[190:191] op_sel_hi:[1,1,0]
    v_pk_fma_f32 v[104:105], v[152:153], s[44:45], v[188:189] op_sel_hi:[1,1,0]
    v_pk_fma_f32 v[88:89], v[152:153], s[46:47], v[190:191] op_sel_hi:[1,1,0]
    v_pk_fma_f32 v[106:107], v[154:155], s[44:45], v[188:189] op_sel_hi:[1,1,0]
    v_pk_fma_f32 v[90:91], v[154:155], s[46:47], v[190:191] op_sel_hi:[1,1,0]
    v_pk_fma_f32 v[108:109], v[156:157], s[44:45], v[188:189] op_sel_hi:[1,1,0]
    v_pk_fma_f32 v[92:93], v[156:157], s[46:47], v[190:191] op_sel_hi:[1,1,0]
    v_pk_fma_f32 v[110:111], v[158:159], s[44:45], v[188:189] op_sel_hi:[1,1,0]
    v_pk_fma_f32 v[94:95], v[158:159], s[46:47], v[190:191] op_sel_hi:[1,1,0]
    v_pk_fma_f32 v[112:113], v[160:161], s[44:45], v[188:189] op_sel_hi:[1,1,0]
    v_pk_fma_f32 v[96:97], v[160:161], s[46:47], v[190:191] op_sel_hi:[1,1,0]
    v_pk_fma_f32 v[114:115], v[162:163], s[44:45], v[188:189] op_sel_hi:[1,1,0]
    v_pk_fma_f32 v[98:99], v[162:163], s[46:47], v[190:191] op_sel_hi:[1,1,0]
    v_exp_f32 v100, v100
    v_exp_f32 v84, v84
    v_exp_f32 v101, v101
    v_exp_f32 v85, v85
    v_exp_f32 v102, v102
    v_exp_f32 v86, v86
    v_exp_f32 v103, v103
    v_exp_f32 v87, v87
    v_exp_f32 v104, v104
    v_exp_f32 v88, v88
    v_exp_f32 v105, v105
    v_exp_f32 v89, v89
    v_exp_f32 v106, v106
    v_exp_f32 v90, v90
    v_exp_f32 v107, v107
    v_exp_f32 v91, v91
    v_exp_f32 v108, v108
    v_exp_f32 v92, v92
    v_exp_f32 v109, v109
    v_exp_f32 v93, v93
    v_exp_f32 v110, v110
    v_exp_f32 v94, v94
    v_exp_f32 v111, v111
    v_exp_f32 v95, v95
    v_exp_f32 v112, v112
    v_exp_f32 v96, v96
    v_exp_f32 v113, v113
    v_exp_f32 v97, v97
    v_exp_f32 v114, v114
    v_exp_f32 v98, v98
    v_exp_f32 v115, v115
    v_exp_f32 v99, v99
    s_nop 0
    v_cndmask_b32 v112, v112, 0, s[42:43]
    v_cndmask_b32 v96, v96, 0, s[42:43]
    v_cndmask_b32 v113, v113, 0, s[42:43]
    v_cndmask_b32 v97, v97, 0, s[42:43]
    v_cndmask_b32 v114, v114, 0, s[42:43]
    v_cndmask_b32 v98, v98, 0, s[42:43]
    v_cndmask_b32 v115, v115, 0, s[42:43]
    v_cndmask_b32 v99, v99, 0, s[42:43]
    v_pk_add_f32 v[192:193], v[100:101], v[102:103]
    v_pk_add_f32 v[194:195], v[84:85], v[86:87]
    v_pk_add_f32 v[192:193], v[192:193], v[104:105]
    v_pk_add_f32 v[194:195], v[194:195], v[88:89]
    v_pk_add_f32 v[192:193], v[192:193], v[106:107]
    v_pk_add_f32 v[194:195], v[194:195], v[90:91]
    v_pk_add_f32 v[192:193], v[192:193], v[108:109]
    v_pk_add_f32 v[194:195], v[194:195], v[92:93]
    v_pk_add_f32 v[192:193], v[192:193], v[110:111]
    v_pk_add_f32 v[194:195], v[194:195], v[94:95]
    v_pk_add_f32 v[192:193], v[192:193], v[112:113]
    v_pk_add_f32 v[194:195], v[194:195], v[96:97]
    v_pk_add_f32 v[192:193], v[192:193], v[114:115]
    v_pk_add_f32 v[194:195], v[194:195], v[98:99]
    v_add_f32 v168, v192, v193
    v_add_f32 v169, v194, v195
    v_mov_b32 v166, v168
    v_mov_b32 v167, v168
    s_nop 1
    v_permlane32_swap_b32 v166, v167
    s_nop 1
    v_add_f32 v168, v166, v167
    v_mov_b32 v166, v169
    v_mov_b32 v167, v169
    s_nop 1
    v_permlane32_swap_b32 v166, v167
    s_nop 1
    v_add_f32 v169, v166, v167
    v_rcp_f32 v192, v168
    v_rcp_f32 v194, v169
    s_nop 0
    v_pk_mul_f32 v[100:101], v[100:101], v[192:193] op_sel_hi:[1,0]
    v_pk_mul_f32 v[84:85], v[84:85], v[194:195] op_sel_hi:[1,0]
    v_pk_mul_f32 v[102:103], v[102:103], v[192:193] op_sel_hi:[1,0]
    v_pk_mul_f32 v[86:87], v[86:87], v[194:195] op_sel_hi:[1,0]
    v_pk_mul_f32 v[104:105], v[104:105], v[192:193] op_sel_hi:[1,0]
    v_pk_mul_f32 v[88:89], v[88:89], v[194:195] op_sel_hi:[1,0]
    v_pk_mul_f32 v[106:107], v[106:107], v[192:193] op_sel_hi:[1,0]
    v_pk_mul_f32 v[90:91], v[90:91], v[194:195] op_sel_hi:[1,0]
    v_pk_mul_f32 v[108:109], v[108:109], v[192:193] op_sel_hi:[1,0]
    v_pk_mul_f32 v[92:93], v[92:93], v[194:195] op_sel_hi:[1,0]
    v_pk_mul_f32 v[110:111], v[110:111], v[192:193] op_sel_hi:[1,0]
    v_pk_mul_f32 v[94:95], v[94:95], v[194:195] op_sel_hi:[1,0]
    v_pk_mul_f32 v[112:113], v[112:113], v[192:193] op_sel_hi:[1,0]
    v_pk_mul_f32 v[96:97], v[96:97], v[194:195] op_sel_hi:[1,0]
    v_pk_mul_f32 v[114:115], v[114:115], v[192:193] op_sel_hi:[1,0]
    v_pk_mul_f32 v[98:99], v[98:99], v[194:195] op_sel_hi:[1,0]
    v_cvt_pk_bf16_f32 v100, v100, v101
    v_cvt_pk_bf16_f32 v84, v84, v85
    v_cvt_pk_bf16_f32 v101, v102, v103
    v_cvt_pk_bf16_f32 v85, v86, v87
    v_cvt_pk_bf16_f32 v102, v104, v105
    v_cvt_pk_bf16_f32 v86, v88, v89
    v_cvt_pk_bf16_f32 v103, v106, v107
    v_cvt_pk_bf16_f32 v87, v90, v91
    v_cvt_pk_bf16_f32 v104, v108, v109
    v_cvt_pk_bf16_f32 v88, v92, v93
    v_cvt_pk_bf16_f32 v105, v110, v111
    v_cvt_pk_bf16_f32 v89, v94, v95
    v_cvt_pk_bf16_f32 v106, v112, v113
    v_cvt_pk_bf16_f32 v90, v96, v97
    v_cvt_pk_bf16_f32 v107, v114, v115
    v_cvt_pk_bf16_f32 v91, v98, v99
    ds_write_b64 v4, v[100:101] offset:8704
    ds_write_b64 v4, v[84:85] offset:8768
    ds_write_b64 v4, v[102:103] offset:8720
    ds_write_b64 v4, v[86:87] offset:8784
    ds_write_b64 v4, v[104:105] offset:8736
    ds_write_b64 v4, v[88:89] offset:8800
    ds_write_b64 v4, v[106:107] offset:8752
    ds_write_b64 v4, v[90:91] offset:8816
    v_cvt_pk_bf16_f32 v140, v52, v53
    v_cvt_pk_bf16_f32 v141, v54, v55
    v_cvt_pk_bf16_f32 v142, v56, v57
    v_cvt_pk_bf16_f32 v143, v58, v59
    v_cvt_pk_bf16_f32 v144, v60, v61
    v_cvt_pk_bf16_f32 v145, v62, v63
    v_cvt_pk_bf16_f32 v146, v64, v65
    v_cvt_pk_bf16_f32 v147, v66, v67
    v_cndmask_b32 v146, v146, 0, s[42:43]
    v_cndmask_b32 v147, v147, 0, s[42:43]
    s_nop 1
    v_mfma_f32_32x32x16_bf16 v[172:187], v[132:135], v[140:143], 0
    v_mfma_f32_32x32x16_bf16 v[172:187], v[136:139], v[144:147], v[172:187]
    s_nop 11
    v_cvt_pk_bf16_f32 v166, v172, v173
    v_lshlrev_b32 v148, 16, v166
    v_and_b32 v149, 0xffff0000, v166
    v_cvt_pk_bf16_f32 v166, v174, v175
    v_lshlrev_b32 v150, 16, v166
    v_and_b32 v151, 0xffff0000, v166
    v_cvt_pk_bf16_f32 v166, v176, v177
    v_lshlrev_b32 v152, 16, v166
    v_and_b32 v153, 0xffff0000, v166
    v_cvt_pk_bf16_f32 v166, v178, v179
    v_lshlrev_b32 v154, 16, v166
    v_and_b32 v155, 0xffff0000, v166
    v_cvt_pk_bf16_f32 v166, v180, v181
    v_lshlrev_b32 v156, 16, v166
    v_and_b32 v157, 0xffff0000, v166
    v_cvt_pk_bf16_f32 v166, v182, v183
    v_lshlrev_b32 v158, 16, v166
    v_and_b32 v159, 0xffff0000, v166
    v_cvt_pk_bf16_f32 v166, v184, v185
    v_lshlrev_b32 v160, 16, v166
    v_and_b32 v161, 0xffff0000, v166
    v_cvt_pk_bf16_f32 v166, v186, v187
    v_lshlrev_b32 v162, 16, v166
    v_and_b32 v163, 0xffff0000, v166
    v_cndmask_b32 v160, v160, v159, s[42:43]
    v_cndmask_b32 v161, v161, v159, s[42:43]
    v_cndmask_b32 v162, v162, v159, s[42:43]
    v_cndmask_b32 v163, v163, v159, s[42:43]
    v_max3_f32 v164, v148, v149, v150
    v_min3_f32 v165, v148, v149, v150
    v_max3_f32 v164, v164, v151, v152
    v_min3_f32 v165, v165, v151, v152
    v_max3_f32 v164, v164, v153, v154
    v_min3_f32 v165, v165, v153, v154
    v_max3_f32 v164, v164, v155, v156
    v_min3_f32 v165, v165, v155, v156
    v_max3_f32 v164, v164, v157, v158
    v_min3_f32 v165, v165, v157, v158
    v_max3_f32 v164, v164, v159, v160
    v_min3_f32 v165, v165, v159, v160
    v_max3_f32 v164, v164, v161, v162
    v_min3_f32 v165, v165, v161, v162
    v_max_f32 v164, v164, v163
    v_min_f32 v165, v165, v163
    v_mov_b32 v166, v164
    v_mov_b32 v167, v164
    s_nop 1
    v_permlane32_swap_b32 v166, v167
    s_nop 1
    v_max_f32 v164, v166, v167
    v_mov_b32 v166, v165
    v_mov_b32 v167, v165
    s_nop 1
    v_permlane32_swap_b32 v166, v167
    s_nop 1
    v_min_f32 v165, v166, v167
    v_mul_f32 v188, s44, v164
    v_mul_f32 v190, s44, v165
    v_sub_f32 v188, 0, v188
    v_pk_fma_f32 v[100:101], v[148:149], s[44:45], v[188:189] op_sel_hi:[1,1,0]
    v_pk_fma_f32 v[84:85], v[148:149], s[46:47], v[190:191] op_sel_hi:[1,1,0]
    v_pk_fma_f32 v[102:103], v[150:151], s[44:45], v[188:189] op_sel_hi:[1,1,0]
    v_pk_fma_f32 v[86:87], v[150:151], s[46:47], v[190:191] op_sel_hi:[1,1,0]
    v_pk_fma_f32 v[104:105], v[152:153], s[44:45], v[188:189] op_sel_hi:[1,1,0]
    v_pk_fma_f32 v[88:89], v[152:153], s[46:47], v[190:191] op_sel_hi:[1,1,0]
    v_pk_fma_f32 v[106:107], v[154:155], s[44:45], v[188:189] op_sel_hi:[1,1,0]
    v_pk_fma_f32 v[90:91], v[154:155], s[46:47], v[190:191] op_sel_hi:[1,1,0]
    v_pk_fma_f32 v[108:109], v[156:157], s[44:45], v[188:189] op_sel_hi:[1,1,0]
    v_pk_fma_f32 v[92:93], v[156:157], s[46:47], v[190:191] op_sel_hi:[1,1,0]
    v_pk_fma_f32 v[110:111], v[158:159], s[44:45], v[188:189] op_sel_hi:[1,1,0]
    v_pk_fma_f32 v[94:95], v[158:159], s[46:47], v[190:191] op_sel_hi:[1,1,0]
    v_pk_fma_f32 v[112:113], v[160:161], s[44:45], v[188:189] op_sel_hi:[1,1,0]
    v_pk_fma_f32 v[96:97], v[160:161], s[46:47], v[190:191] op_sel_hi:[1,1,0]
    v_pk_fma_f32 v[114:115], v[162:163], s[44:45], v[188:189] op_sel_hi:[1,1,0]
    v_pk_fma_f32 v[98:99], v[162:163], s[46:47], v[190:191] op_sel_hi:[1,1,0]
    v_exp_f32 v100, v100
    v_exp_f32 v84, v84
    v_exp_f32 v101, v101
    v_exp_f32 v85, v85
    v_exp_f32 v102, v102
    v_exp_f32 v86, v86
    v_exp_f32 v103, v103
    v_exp_f32 v87, v87
    v_exp_f32 v104, v104
    v_exp_f32 v88, v88
    v_exp_f32 v105, v105
    v_exp_f32 v89, v89
    v_exp_f32 v106, v106
    v_exp_f32 v90, v90
    v_exp_f32 v107, v107
    v_exp_f32 v91, v91
    v_exp_f32 v108, v108
    v_exp_f32 v92, v92
    v_exp_f32 v109, v109
    v_exp_f32 v93, v93
    v_exp_f32 v110, v110
    v_exp_f32 v94, v94
    v_exp_f32 v111, v111
    v_exp_f32 v95, v95
    v_exp_f32 v112, v112
    v_exp_f32 v96, v96
    v_exp_f32 v113, v113
    v_exp_f32 v97, v97
    v_exp_f32 v114, v114
    v_exp_f32 v98, v98
    v_exp_f32 v115, v115
    v_exp_f32 v99, v99
    s_nop 0
    v_cndmask_b32 v112, v112, 0, s[42:43]
    v_cndmask_b32 v96, v96, 0, s[42:43]
    v_cndmask_b32 v113, v113, 0, s[42:43]
    v_cndmask_b32 v97, v97, 0, s[42:43]
    v_cndmask_b32 v114, v114, 0, s[42:43]
    v_cndmask_b32 v98, v98, 0, s[42:43]
    v_cndmask_b32 v115, v115, 0, s[42:43]
    v_cndmask_b32 v99, v99, 0, s[42:43]
    v_pk_add_f32 v[192:193], v[100:101], v[102:103]
    v_pk_add_f32 v[194:195], v[84:85], v[86:87]
    v_pk_add_f32 v[192:193], v[192:193], v[104:105]
    v_pk_add_f32 v[194:195], v[194:195], v[88:89]
    v_pk_add_f32 v[192:193], v[192:193], v[106:107]
    v_pk_add_f32 v[194:195], v[194:195], v[90:91]
    v_pk_add_f32 v[192:193], v[192:193], v[108:109]
    v_pk_add_f32 v[194:195], v[194:195], v[92:93]
    v_pk_add_f32 v[192:193], v[192:193], v[110:111]
    v_pk_add_f32 v[194:195], v[194:195], v[94:95]
    v_pk_add_f32 v[192:193], v[192:193], v[112:113]
    v_pk_add_f32 v[194:195], v[194:195], v[96:97]
    v_pk_add_f32 v[192:193], v[192:193], v[114:115]
    v_pk_add_f32 v[194:195], v[194:195], v[98:99]
    v_add_f32 v168, v192, v193
    v_add_f32 v169, v194, v195
    v_mov_b32 v166, v168
    v_mov_b32 v167, v168
    s_nop 1
    v_permlane32_swap_b32 v166, v167
    s_nop 1
    v_add_f32 v168, v166, v167
    v_mov_b32 v166, v169
    v_mov_b32 v167, v169
    s_nop 1
    v_permlane32_swap_b32 v166, v167
    s_nop 1
    v_add_f32 v169, v166, v167
    v_rcp_f32 v192, v168
    v_rcp_f32 v194, v169
    s_nop 0
    v_pk_mul_f32 v[100:101], v[100:101], v[192:193] op_sel_hi:[1,0]
    v_pk_mul_f32 v[84:85], v[84:85], v[194:195] op_sel_hi:[1,0]
    v_pk_mul_f32 v[102:103], v[102:103], v[192:193] op_sel_hi:[1,0]
    v_pk_mul_f32 v[86:87], v[86:87], v[194:195] op_sel_hi:[1,0]
    v_pk_mul_f32 v[104:105], v[104:105], v[192:193] op_sel_hi:[1,0]
    v_pk_mul_f32 v[88:89], v[88:89], v[194:195] op_sel_hi:[1,0]
    v_pk_mul_f32 v[106:107], v[106:107], v[192:193] op_sel_hi:[1,0]
    v_pk_mul_f32 v[90:91], v[90:91], v[194:195] op_sel_hi:[1,0]
    v_pk_mul_f32 v[108:109], v[108:109], v[192:193] op_sel_hi:[1,0]
    v_pk_mul_f32 v[92:93], v[92:93], v[194:195] op_sel_hi:[1,0]
    v_pk_mul_f32 v[110:111], v[110:111], v[192:193] op_sel_hi:[1,0]
    v_pk_mul_f32 v[94:95], v[94:95], v[194:195] op_sel_hi:[1,0]
    v_pk_mul_f32 v[112:113], v[112:113], v[192:193] op_sel_hi:[1,0]
    v_pk_mul_f32 v[96:97], v[96:97], v[194:195] op_sel_hi:[1,0]
    v_pk_mul_f32 v[114:115], v[114:115], v[192:193] op_sel_hi:[1,0]
    v_pk_mul_f32 v[98:99], v[98:99], v[194:195] op_sel_hi:[1,0]
    v_cvt_pk_bf16_f32 v100, v100, v101
    v_cvt_pk_bf16_f32 v84, v84, v85
    v_cvt_pk_bf16_f32 v101, v102, v103
    v_cvt_pk_bf16_f32 v85, v86, v87
    v_cvt_pk_bf16_f32 v102, v104, v105
    v_cvt_pk_bf16_f32 v86, v88, v89
    v_cvt_pk_bf16_f32 v103, v106, v107
    v_cvt_pk_bf16_f32 v87, v90, v91
    v_cvt_pk_bf16_f32 v104, v108, v109
    v_cvt_pk_bf16_f32 v88, v92, v93
    v_cvt_pk_bf16_f32 v105, v110, v111
    v_cvt_pk_bf16_f32 v89, v94, v95
    v_cvt_pk_bf16_f32 v106, v112, v113
    v_cvt_pk_bf16_f32 v90, v96, v97
    v_cvt_pk_bf16_f32 v107, v114, v115
    v_cvt_pk_bf16_f32 v91, v98, v99
    ds_write_b64 v4, v[100:101] offset:128
    ds_write_b64 v4, v[84:85] offset:192
    ds_write_b64 v4, v[102:103] offset:144
    ds_write_b64 v4, v[86:87] offset:208
    ds_write_b64 v4, v[104:105] offset:160
    ds_write_b64 v4, v[88:89] offset:224
    ds_write_b64 v4, v[106:107] offset:176
    ds_write_b64 v4, v[90:91] offset:240
    v_cvt_pk_bf16_f32 v140, v68, v69
    v_cvt_pk_bf16_f32 v141, v70, v71
    v_cvt_pk_bf16_f32 v142, v72, v73
    v_cvt_pk_bf16_f32 v143, v74, v75
    v_cvt_pk_bf16_f32 v144, v76, v77
    v_cvt_pk_bf16_f32 v145, v78, v79
    v_cvt_pk_bf16_f32 v146, v80, v81
    v_cvt_pk_bf16_f32 v147, v82, v83
    v_cndmask_b32 v146, v146, 0, s[42:43]
    v_cndmask_b32 v147, v147, 0, s[42:43]
    s_nop 1
    v_mfma_f32_32x32x16_bf16 v[172:187], v[132:135], v[140:143], 0
    v_mfma_f32_32x32x16_bf16 v[172:187], v[136:139], v[144:147], v[172:187]
    s_nop 11
    v_cvt_pk_bf16_f32 v166, v172, v173
    v_lshlrev_b32 v148, 16, v166
    v_and_b32 v149, 0xffff0000, v166
    v_cvt_pk_bf16_f32 v166, v174, v175
    v_lshlrev_b32 v150, 16, v166
    v_and_b32 v151, 0xffff0000, v166
    v_cvt_pk_bf16_f32 v166, v176, v177
    v_lshlrev_b32 v152, 16, v166
    v_and_b32 v153, 0xffff0000, v166
    v_cvt_pk_bf16_f32 v166, v178, v179
    v_lshlrev_b32 v154, 16, v166
    v_and_b32 v155, 0xffff0000, v166
    v_cvt_pk_bf16_f32 v166, v180, v181
    v_lshlrev_b32 v156, 16, v166
    v_and_b32 v157, 0xffff0000, v166
    v_cvt_pk_bf16_f32 v166, v182, v183
    v_lshlrev_b32 v158, 16, v166
    v_and_b32 v159, 0xffff0000, v166
    v_cvt_pk_bf16_f32 v166, v184, v185
    v_lshlrev_b32 v160, 16, v166
    v_and_b32 v161, 0xffff0000, v166
    v_cvt_pk_bf16_f32 v166, v186, v187
    v_lshlrev_b32 v162, 16, v166
    v_and_b32 v163, 0xffff0000, v166
    v_cndmask_b32 v160, v160, v159, s[42:43]
    v_cndmask_b32 v161, v161, v159, s[42:43]
    v_cndmask_b32 v162, v162, v159, s[42:43]
    v_cndmask_b32 v163, v163, v159, s[42:43]
    v_max3_f32 v164, v148, v149, v150
    v_min3_f32 v165, v148, v149, v150
    v_max3_f32 v164, v164, v151, v152
    v_min3_f32 v165, v165, v151, v152
    v_max3_f32 v164, v164, v153, v154
    v_min3_f32 v165, v165, v153, v154
    v_max3_f32 v164, v164, v155, v156
    v_min3_f32 v165, v165, v155, v156
    v_max3_f32 v164, v164, v157, v158
    v_min3_f32 v165, v165, v157, v158
    v_max3_f32 v164, v164, v159, v160
    v_min3_f32 v165, v165, v159, v160
    v_max3_f32 v164, v164, v161, v162
    v_min3_f32 v165, v165, v161, v162
    v_max_f32 v164, v164, v163
    v_min_f32 v165, v165, v163
    v_mov_b32 v166, v164
    v_mov_b32 v167, v164
    s_nop 1
    v_permlane32_swap_b32 v166, v167
    s_nop 1
    v_max_f32 v164, v166, v167
    v_mov_b32 v166, v165
    v_mov_b32 v167, v165
    s_nop 1
    v_permlane32_swap_b32 v166, v167
    s_nop 1
    v_min_f32 v165, v166, v167
    v_mul_f32 v188, s44, v164
    v_mul_f32 v190, s44, v165
    v_sub_f32 v188, 0, v188
    v_pk_fma_f32 v[100:101], v[148:149], s[44:45], v[188:189] op_sel_hi:[1,1,0]
    v_pk_fma_f32 v[84:85], v[148:149], s[46:47], v[190:191] op_sel_hi:[1,1,0]
    v_pk_fma_f32 v[102:103], v[150:151], s[44:45], v[188:189] op_sel_hi:[1,1,0]
    v_pk_fma_f32 v[86:87], v[150:151], s[46:47], v[190:191] op_sel_hi:[1,1,0]
    v_pk_fma_f32 v[104:105], v[152:153], s[44:45], v[188:189] op_sel_hi:[1,1,0]
    v_pk_fma_f32 v[88:89], v[152:153], s[46:47], v[190:191] op_sel_hi:[1,1,0]
    v_pk_fma_f32 v[106:107], v[154:155], s[44:45], v[188:189] op_sel_hi:[1,1,0]
    v_pk_fma_f32 v[90:91], v[154:155], s[46:47], v[190:191] op_sel_hi:[1,1,0]
    v_pk_fma_f32 v[108:109], v[156:157], s[44:45], v[188:189] op_sel_hi:[1,1,0]
    v_pk_fma_f32 v[92:93], v[156:157], s[46:47], v[190:191] op_sel_hi:[1,1,0]
    v_pk_fma_f32 v[110:111], v[158:159], s[44:45], v[188:189] op_sel_hi:[1,1,0]
    v_pk_fma_f32 v[94:95], v[158:159], s[46:47], v[190:191] op_sel_hi:[1,1,0]
    v_pk_fma_f32 v[112:113], v[160:161], s[44:45], v[188:189] op_sel_hi:[1,1,0]
    v_pk_fma_f32 v[96:97], v[160:161], s[46:47], v[190:191] op_sel_hi:[1,1,0]
    v_pk_fma_f32 v[114:115], v[162:163], s[44:45], v[188:189] op_sel_hi:[1,1,0]
    v_pk_fma_f32 v[98:99], v[162:163], s[46:47], v[190:191] op_sel_hi:[1,1,0]
    v_exp_f32 v100, v100
    v_exp_f32 v84, v84
    v_exp_f32 v101, v101
    v_exp_f32 v85, v85
    v_exp_f32 v102, v102
    v_exp_f32 v86, v86
    v_exp_f32 v103, v103
    v_exp_f32 v87, v87
    v_exp_f32 v104, v104
    v_exp_f32 v88, v88
    v_exp_f32 v105, v105
    v_exp_f32 v89, v89
    v_exp_f32 v106, v106
    v_exp_f32 v90, v90
    v_exp_f32 v107, v107
    v_exp_f32 v91, v91
    v_exp_f32 v108, v108
    v_exp_f32 v92, v92
    v_exp_f32 v109, v109
    v_exp_f32 v93, v93
    v_exp_f32 v110, v110
    v_exp_f32 v94, v94
    v_exp_f32 v111, v111
    v_exp_f32 v95, v95
    v_exp_f32 v112, v112
    v_exp_f32 v96, v96
    v_exp_f32 v113, v113
    v_exp_f32 v97, v97
    v_exp_f32 v114, v114
    v_exp_f32 v98, v98
    v_exp_f32 v115, v115
    v_exp_f32 v99, v99
    s_nop 0
    v_cndmask_b32 v112, v112, 0, s[42:43]
    v_cndmask_b32 v96, v96, 0, s[42:43]
    v_cndmask_b32 v113, v113, 0, s[42:43]
    v_cndmask_b32 v97, v97, 0, s[42:43]
    v_cndmask_b32 v114, v114, 0, s[42:43]
    v_cndmask_b32 v98, v98, 0, s[42:43]
    v_cndmask_b32 v115, v115, 0, s[42:43]
    v_cndmask_b32 v99, v99, 0, s[42:43]
    v_pk_add_f32 v[192:193], v[100:101], v[102:103]
    v_pk_add_f32 v[194:195], v[84:85], v[86:87]
    v_pk_add_f32 v[192:193], v[192:193], v[104:105]
    v_pk_add_f32 v[194:195], v[194:195], v[88:89]
    v_pk_add_f32 v[192:193], v[192:193], v[106:107]
    v_pk_add_f32 v[194:195], v[194:195], v[90:91]
    v_pk_add_f32 v[192:193], v[192:193], v[108:109]
    v_pk_add_f32 v[194:195], v[194:195], v[92:93]
    v_pk_add_f32 v[192:193], v[192:193], v[110:111]
    v_pk_add_f32 v[194:195], v[194:195], v[94:95]
    v_pk_add_f32 v[192:193], v[192:193], v[112:113]
    v_pk_add_f32 v[194:195], v[194:195], v[96:97]
    v_pk_add_f32 v[192:193], v[192:193], v[114:115]
    v_pk_add_f32 v[194:195], v[194:195], v[98:99]
    v_add_f32 v168, v192, v193
    v_add_f32 v169, v194, v195
    v_mov_b32 v166, v168
    v_mov_b32 v167, v168
    s_nop 1
    v_permlane32_swap_b32 v166, v167
    s_nop 1
    v_add_f32 v168, v166, v167
    v_mov_b32 v166, v169
    v_mov_b32 v167, v169
    s_nop 1
    v_permlane32_swap_b32 v166, v167
    s_nop 1
    v_add_f32 v169, v166, v167
    v_rcp_f32 v192, v168
    v_rcp_f32 v194, v169
    s_nop 0
    v_pk_mul_f32 v[100:101], v[100:101], v[192:193] op_sel_hi:[1,0]
    v_pk_mul_f32 v[84:85], v[84:85], v[194:195] op_sel_hi:[1,0]
    v_pk_mul_f32 v[102:103], v[102:103], v[192:193] op_sel_hi:[1,0]
    v_pk_mul_f32 v[86:87], v[86:87], v[194:195] op_sel_hi:[1,0]
    v_pk_mul_f32 v[104:105], v[104:105], v[192:193] op_sel_hi:[1,0]
    v_pk_mul_f32 v[88:89], v[88:89], v[194:195] op_sel_hi:[1,0]
    v_pk_mul_f32 v[106:107], v[106:107], v[192:193] op_sel_hi:[1,0]
    v_pk_mul_f32 v[90:91], v[90:91], v[194:195] op_sel_hi:[1,0]
    v_pk_mul_f32 v[108:109], v[108:109], v[192:193] op_sel_hi:[1,0]
    v_pk_mul_f32 v[92:93], v[92:93], v[194:195] op_sel_hi:[1,0]
    v_pk_mul_f32 v[110:111], v[110:111], v[192:193] op_sel_hi:[1,0]
    v_pk_mul_f32 v[94:95], v[94:95], v[194:195] op_sel_hi:[1,0]
    v_pk_mul_f32 v[112:113], v[112:113], v[192:193] op_sel_hi:[1,0]
    v_pk_mul_f32 v[96:97], v[96:97], v[194:195] op_sel_hi:[1,0]
    v_pk_mul_f32 v[114:115], v[114:115], v[192:193] op_sel_hi:[1,0]
    v_pk_mul_f32 v[98:99], v[98:99], v[194:195] op_sel_hi:[1,0]
    v_cvt_pk_bf16_f32 v100, v100, v101
    v_cvt_pk_bf16_f32 v84, v84, v85
    v_cvt_pk_bf16_f32 v101, v102, v103
    v_cvt_pk_bf16_f32 v85, v86, v87
    v_cvt_pk_bf16_f32 v102, v104, v105
    v_cvt_pk_bf16_f32 v86, v88, v89
    v_cvt_pk_bf16_f32 v103, v106, v107
    v_cvt_pk_bf16_f32 v87, v90, v91
    v_cvt_pk_bf16_f32 v104, v108, v109
    v_cvt_pk_bf16_f32 v88, v92, v93
    v_cvt_pk_bf16_f32 v105, v110, v111
    v_cvt_pk_bf16_f32 v89, v94, v95
    v_cvt_pk_bf16_f32 v106, v112, v113
    v_cvt_pk_bf16_f32 v90, v96, v97
    v_cvt_pk_bf16_f32 v107, v114, v115
    v_cvt_pk_bf16_f32 v91, v98, v99
    ds_write_b64 v4, v[100:101] offset:8832
    ds_write_b64 v4, v[84:85] offset:8896
    ds_write_b64 v4, v[102:103] offset:8848
    ds_write_b64 v4, v[86:87] offset:8912
    ds_write_b64 v4, v[104:105] offset:8864
    ds_write_b64 v4, v[88:89] offset:8928
    ds_write_b64 v4, v[106:107] offset:8880
    ds_write_b64 v4, v[90:91] offset:8944
    s_cmp_ge_u32 s21, 2
    s_cbranch_scc1 k1_kst
    v_mul_u32_u24 v5, 272, v2
    v_lshl_add_u32 v5, v3, 4, v5
    v_add_u32 v5, s53, v5
    v_lshlrev_b32 v6, 4, v1
    s_lshl_b32 s46, s40, 11
    s_lshl_b32 s47, s39, 12
    s_add_u32 s46, s46, s47
    s_waitcnt lgkmcnt(0)
    ds_read_b128 v[20:23], v5 offset:0
    ds_read_b128 v[24:27], v5 offset:32
    ds_read_b128 v[28:31], v5 offset:64
    ds_read_b128 v[32:35], v5 offset:96
    ds_read_b128 v[36:39], v5 offset:128
    ds_read_b128 v[40:43], v5 offset:160
    ds_read_b128 v[44:47], v5 offset:192
    ds_read_b128 v[48:51], v5 offset:224
    ds_read_b128 v[52:55], v5 offset:8704
    ds_read_b128 v[56:59], v5 offset:8736
    ds_read_b128 v[60:63], v5 offset:8768
    ds_read_b128 v[64:67], v5 offset:8800
    ds_read_b128 v[68:71], v5 offset:8832
    ds_read_b128 v[72:75], v5 offset:8864
    ds_read_b128 v[76:79], v5 offset:8896
    ds_read_b128 v[80:83], v5 offset:8928
    s_waitcnt lgkmcnt(15)
    s_add_u32 s47, s46, 0
    buffer_store_dwordx4 v[20:23], v6, s[16:19], s47 offen sc1
    s_waitcnt lgkmcnt(14)
    s_add_u32 s47, s46, 1024
    buffer_store_dwordx4 v[24:27], v6, s[16:19], s47 offen sc1
    s_waitcnt lgkmcnt(13)
    s_add_u32 s47, s46, 2048
    buffer_store_dwordx4 v[28:31], v6, s[16:19], s47 offen sc1
    s_waitcnt lgkmcnt(12)
    s_add_u32 s47, s46, 3072
    buffer_store_dwordx4 v[32:35], v6, s[16:19], s47 offen sc1
    s_waitcnt lgkmcnt(11)
    s_add_u32 s47, s46, 4096
    buffer_store_dwordx4 v[36:39], v6, s[16:19], s47 offen sc1
    s_waitcnt lgkmcnt(10)
    s_add_u32 s47, s46, 5120
    buffer_store_dwordx4 v[40:43], v6, s[16:19], s47 offen sc1
    s_waitcnt lgkmcnt(9)
    s_add_u32 s47, s46, 6144
    buffer_store_dwordx4 v[44:47], v6, s[16:19], s47 offen sc1
    s_waitcnt lgkmcnt(8)
    s_add_u32 s47, s46, 7168
    buffer_store_dwordx4 v[48:51], v6, s[16:19], s47 offen sc1
    s_waitcnt lgkmcnt(7)
    s_add_u32 s47, s46, 65536
    buffer_store_dwordx4 v[52:55], v6, s[16:19], s47 offen sc1
    s_waitcnt lgkmcnt(6)
    s_add_u32 s47, s46, 66560
    buffer_store_dwordx4 v[56:59], v6, s[16:19], s47 offen sc1
    s_waitcnt lgkmcnt(5)
    s_add_u32 s47, s46, 67584
    buffer_store_dwordx4 v[60:63], v6, s[16:19], s47 offen sc1
    s_waitcnt lgkmcnt(4)
    s_add_u32 s47, s46, 68608
    buffer_store_dwordx4 v[64:67], v6, s[16:19], s47 offen sc1
    s_waitcnt lgkmcnt(3)
    s_add_u32 s47, s46, 69632
    buffer_store_dwordx4 v[68:71], v6, s[16:19], s47 offen sc1
    s_waitcnt lgkmcnt(2)
    s_add_u32 s47, s46, 70656
    buffer_store_dwordx4 v[72:75], v6, s[16:19], s47 offen sc1
    s_waitcnt lgkmcnt(1)
    s_add_u32 s47, s46, 71680
    buffer_store_dwordx4 v[76:79], v6, s[16:19], s47 offen sc1
    s_waitcnt lgkmcnt(0)
    s_add_u32 s47, s46, 72704
    buffer_store_dwordx4 v[80:83], v6, s[16:19], s47 offen sc1
    s_branch k1_end
k1_kst:
    v_lshrrev_b32 v7, 4, v1
    v_and_b32 v8, 15, v1
    v_mul_u32_u24 v5, 272, v7
    v_lshl_add_u32 v5, v8, 4, v5
    v_add_u32 v5, s53, v5
    v_lshlrev_b32 v6, 11, v7
    v_lshl_add_u32 v6, v8, 4, v6
    s_lshl_b32 s46, s40, 11
    s_lshl_b32 s47, s39, 7
    s_add_u32 s46, s46, s47
    s_add_u32 s46, s46, 4194304
    s_waitcnt lgkmcnt(0)
    ds_read_b128 v[20:23], v5 offset:0
    ds_read_b128 v[24:27], v5 offset:1088
    ds_read_b128 v[28:31], v5 offset:2176
    ds_read_b128 v[32:35], v5 offset:3264
    ds_read_b128 v[36:39], v5 offset:4352
    ds_read_b128 v[40:43], v5 offset:5440
    ds_read_b128 v[44:47], v5 offset:6528
    ds_read_b128 v[48:51], v5 offset:7616
    ds_read_b128 v[52:55], v5 offset:8704
    ds_read_b128 v[56:59], v5 offset:9792
    ds_read_b128 v[60:63], v5 offset:10880
    ds_read_b128 v[64:67], v5 offset:11968
    ds_read_b128 v[68:71], v5 offset:13056
    ds_read_b128 v[72:75], v5 offset:14144
    ds_read_b128 v[76:79], v5 offset:15232
    ds_read_b128 v[80:83], v5 offset:16320
    s_waitcnt lgkmcnt(15)
    buffer_store_dwordx4 v[20:23], v6, s[16:19], s46 offen sc1
    s_add_u32 s46, s46, 8192
    s_waitcnt lgkmcnt(14)
    buffer_store_dwordx4 v[24:27], v6, s[16:19], s46 offen sc1
    s_add_u32 s46, s46, 8192
    s_waitcnt lgkmcnt(13)
    buffer_store_dwordx4 v[28:31], v6, s[16:19], s46 offen sc1
    s_add_u32 s46, s46, 8192
    s_waitcnt lgkmcnt(12)
    buffer_store_dwordx4 v[32:35], v6, s[16:19], s46 offen sc1
    s_add_u32 s46, s46, 8192
    s_waitcnt lgkmcnt(11)
    buffer_store_dwordx4 v[36:39], v6, s[16:19], s46 offen sc1
    s_add_u32 s46, s46, 8192
    s_waitcnt lgkmcnt(10)
    buffer_store_dwordx4 v[40:43], v6, s[16:19], s46 offen sc1
    s_add_u32 s46, s46, 8192
    s_waitcnt lgkmcnt(9)
    buffer_store_dwordx4 v[44:47], v6, s[16:19], s46 offen sc1
    s_add_u32 s46, s46, 8192
    s_waitcnt lgkmcnt(8)
    buffer_store_dwordx4 v[48:51], v6, s[16:19], s46 offen sc1
    s_add_u32 s46, s46, 8192
    s_waitcnt lgkmcnt(7)
    buffer_store_dwordx4 v[52:55], v6, s[16:19], s46 offen sc1
    s_add_u32 s46, s46, 8192
    s_waitcnt lgkmcnt(6)
    buffer_store_dwordx4 v[56:59], v6, s[16:19], s46 offen sc1
    s_add_u32 s46, s46, 8192
    s_waitcnt lgkmcnt(5)
    buffer_store_dwordx4 v[60:63], v6, s[16:19], s46 offen sc1
    s_add_u32 s46, s46, 8192
    s_waitcnt lgkmcnt(4)
    buffer_store_dwordx4 v[64:67], v6, s[16:19], s46 offen sc1
    s_add_u32 s46, s46, 8192
    s_waitcnt lgkmcnt(3)
    buffer_store_dwordx4 v[68:71], v6, s[16:19], s46 offen sc1
    s_add_u32 s46, s46, 8192
    s_waitcnt lgkmcnt(2)
    buffer_store_dwordx4 v[72:75], v6, s[16:19], s46 offen sc1
    s_add_u32 s46, s46, 8192
    s_waitcnt lgkmcnt(1)
    buffer_store_dwordx4 v[76:79], v6, s[16:19], s46 offen sc1
    s_add_u32 s46, s46, 8192
    s_waitcnt lgkmcnt(0)
    buffer_store_dwordx4 v[80:83], v6, s[16:19], s46 offen sc1
    s_add_u32 s46, s46, 8192
    s_branch k1_end
k1_vpath:
    v_cvt_pk_bf16_f32 v140, v20, v21
    v_cvt_pk_bf16_f32 v141, v22, v23
    v_cvt_pk_bf16_f32 v142, v24, v25
    v_cvt_pk_bf16_f32 v143, v26, v27
    v_cvt_pk_bf16_f32 v144, v28, v29
    v_cvt_pk_bf16_f32 v145, v30, v31
    v_cvt_pk_bf16_f32 v146, v32, v33
    v_cvt_pk_bf16_f32 v147, v34, v35
    ds_write_b64 v4, v[140:141] offset:0
    ds_write_b64 v4, v[142:143] offset:16
    ds_write_b64 v4, v[144:145] offset:32
    s_mov_b64 exec, 0xffffffff
    ds_write_b64 v4, v[146:147] offset:48
    s_mov_b64 exec, -1
    v_cvt_pk_bf16_f32 v140, v36, v37
    v_cvt_pk_bf16_f32 v141, v38, v39
    v_cvt_pk_bf16_f32 v142, v40, v41
    v_cvt_pk_bf16_f32 v143, v42, v43
    v_cvt_pk_bf16_f32 v144, v44, v45
    v_cvt_pk_bf16_f32 v145, v46, v47
    v_cvt_pk_bf16_f32 v146, v48, v49
    v_cvt_pk_bf16_f32 v147, v50, v51
    ds_write_b64 v4, v[140:141] offset:8704
    ds_write_b64 v4, v[142:143] offset:8720
    ds_write_b64 v4, v[144:145] offset:8736
    s_mov_b64 exec, 0xffffffff
    ds_write_b64 v4, v[146:147] offset:8752
    s_mov_b64 exec, -1
    v_cvt_pk_bf16_f32 v140, v52, v53
    v_cvt_pk_bf16_f32 v141, v54, v55
    v_cvt_pk_bf16_f32 v142, v56, v57
    v_cvt_pk_bf16_f32 v143, v58, v59
    v_cvt_pk_bf16_f32 v144, v60, v61
    v_cvt_pk_bf16_f32 v145, v62, v63
    v_cvt_pk_bf16_f32 v146, v64, v65
    v_cvt_pk_bf16_f32 v147, v66, v67
    ds_write_b64 v4, v[140:141] offset:56
    ds_write_b64 v4, v[142:143] offset:72
    ds_write_b64 v4, v[144:145] offset:88
    s_mov_b64 exec, 0xffffffff
    ds_write_b64 v4, v[146:147] offset:104
    s_mov_b64 exec, -1
    v_cvt_pk_bf16_f32 v140, v68, v69
    v_cvt_pk_bf16_f32 v141, v70, v71
    v_cvt_pk_bf16_f32 v142, v72, v73
    v_cvt_pk_bf16_f32 v143, v74, v75
    v_cvt_pk_bf16_f32 v144, v76, v77
    v_cvt_pk_bf16_f32 v145, v78, v79
    v_cvt_pk_bf16_f32 v146, v80, v81
    v_cvt_pk_bf16_f32 v147, v82, v83
    ds_write_b64 v4, v[140:141] offset:8760
    ds_write_b64 v4, v[142:143] offset:8776
    ds_write_b64 v4, v[144:145] offset:8792
    s_mov_b64 exec, 0xffffffff
    ds_write_b64 v4, v[146:147] offset:8808
    s_mov_b64 exec, -1
    v_lshrrev_b32 v7, 3, v1
    v_and_b32 v8, 7, v1
    v_mul_u32_u24 v5, 272, v7
    v_lshl_add_u32 v5, v8, 4, v5
    v_add_u32 v5, s45, v5
    v_mul_u32_u24 v6, 896, v7
    v_lshl_add_u32 v6, v8, 4, v6
    s_mul_i32 s46, s40, 896
    s_mul_i32 s47, s39, 56
    s_add_u32 s46, s46, s47
    s_add_u32 s46, s46, 8388608
    v_cmp_gt_u32 vcc, 7, v8
    s_waitcnt lgkmcnt(0)
    ds_read_b128 v[20:23], v5 offset:0
    ds_read_b128 v[24:27], v5 offset:2176
    ds_read_b128 v[28:31], v5 offset:4352
    ds_read_b128 v[32:35], v5 offset:6528
    ds_read_b128 v[36:39], v5 offset:8704
    ds_read_b128 v[40:43], v5 offset:10880
    ds_read_b128 v[44:47], v5 offset:13056
    ds_read_b128 v[48:51], v5 offset:15232
    s_and_saveexec_b64 s[50:51], vcc
    s_waitcnt lgkmcnt(7)
    buffer_store_dwordx4 v[20:23], v6, s[16:19], s46 offen sc1
    s_add_u32 s46, s46, 7168
    s_waitcnt lgkmcnt(6)
    buffer_store_dwordx4 v[24:27], v6, s[16:19], s46 offen sc1
    s_add_u32 s46, s46, 7168
    s_waitcnt lgkmcnt(5)
    buffer_store_dwordx4 v[28:31], v6, s[16:19], s46 offen sc1
    s_add_u32 s46, s46, 7168
    s_waitcnt lgkmcnt(4)
    buffer_store_dwordx4 v[32:35], v6, s[16:19], s46 offen sc1
    s_add_u32 s46, s46, 7168
    s_waitcnt lgkmcnt(3)
    buffer_store_dwordx4 v[36:39], v6, s[16:19], s46 offen sc1
    s_add_u32 s46, s46, 7168
    s_waitcnt lgkmcnt(2)
    buffer_store_dwordx4 v[40:43], v6, s[16:19], s46 offen sc1
    s_add_u32 s46, s46, 7168
    s_waitcnt lgkmcnt(1)
    buffer_store_dwordx4 v[44:47], v6, s[16:19], s46 offen sc1
    s_add_u32 s46, s46, 7168
    s_waitcnt lgkmcnt(0)
    buffer_store_dwordx4 v[48:51], v6, s[16:19], s46 offen sc1
    s_add_u32 s46, s46, 7168
    s_branch k1_end
k1_zpath:
    s_lshr_b32 s40, s23, 2
    s_mul_i32 s40, s40, 256
    s_and_b32 s41, s23, 3
    s_mul_i32 s41, s41, 28672
    v_add_u32 v7, s40, v12
    v_add_u32 v13, s41, v13
    v_add_u32 v14, s41, v14
    v_add_u32 v15, s41, v15
    v_add_u32 v16, s41, v16
    s_cmp_eq_u32 s23, 7
    s_cbranch_scc1 k1w_15
    s_mul_i32 s38, s22, 64
    s_add_u32 m0, s48, 28672
    s_nop 0
    buffer_load_dwordx4 v10, s[8:11], s38 offen lds
    s_add_u32 m0, s48, 29696
    s_nop 0
    buffer_load_dwordx4 v11, s[8:11], s38 offen lds
k1w_15:
    ds_read_b64_tr_b16 v[84:85], v7 offset:0
    ds_read_b64_tr_b16 v[86:87], v7 offset:1792
    ds_read_b64_tr_b16 v[88:89], v7 offset:64
    ds_read_b64_tr_b16 v[90:91], v7 offset:1856
    ds_read_b64_tr_b16 v[92:93], v7 offset:128
    ds_read_b64_tr_b16 v[94:95], v7 offset:1920
    ds_read_b64_tr_b16 v[96:97], v7 offset:192
    ds_read_b64_tr_b16 v[98:99], v7 offset:1984
    ds_read_b128 v[100:103], v13 offset:0
    ds_read_b64_tr_b16 v[104:105], v7 offset:7168
    ds_read_b64_tr_b16 v[106:107], v7 offset:8960
    ds_read_b64_tr_b16 v[108:109], v7 offset:7232
    ds_read_b64_tr_b16 v[110:111], v7 offset:9024
    ds_read_b64_tr_b16 v[112:113], v7 offset:7296
    ds_read_b64_tr_b16 v[114:115], v7 offset:9088
    ds_read_b64_tr_b16 v[116:117], v7 offset:7360
    ds_read_b64_tr_b16 v[118:119], v7 offset:9152
    ds_read_b128 v[120:123], v14 offset:0
    s_waitcnt lgkmcnt(9)
    v_mfma_f32_32x32x16_bf16 v[20:35], v[84:87], v[100:103], v[20:35]
    v_mfma_f32_32x32x16_bf16 v[36:51], v[88:91], v[100:103], v[36:51]
    v_mfma_f32_32x32x16_bf16 v[52:67], v[92:95], v[100:103], v[52:67]
    v_mfma_f32_32x32x16_bf16 v[68:83], v[96:99], v[100:103], v[68:83]
    s_waitcnt lgkmcnt(0)
    v_mfma_f32_32x32x16_bf16 v[20:35], v[104:107], v[120:123], v[20:35]
    v_mfma_f32_32x32x16_bf16 v[36:51], v[108:111], v[120:123], v[36:51]
    v_mfma_f32_32x32x16_bf16 v[52:67], v[112:115], v[120:123], v[52:67]
    v_mfma_f32_32x32x16_bf16 v[68:83], v[116:119], v[120:123], v[68:83]
    s_waitcnt vmcnt(2)
    s_barrier
    s_cmp_eq_u32 s23, 7
    s_cbranch_scc1 k1w_16
    s_mul_i32 s38, s22, 96
    s_add_u32 m0, s48, 0
    s_nop 0
    buffer_load_dwordx4 v10, s[8:11], s38 offen lds
    s_add_u32 m0, s48, 1024
    s_nop 0
    buffer_load_dwordx4 v11, s[8:11], s38 offen lds
k1w_16:
    ds_read_b64_tr_b16 v[84:85], v7 offset:14336
    ds_read_b64_tr_b16 v[86:87], v7 offset:16128
    ds_read_b64_tr_b16 v[88:89], v7 offset:14400
    ds_read_b64_tr_b16 v[90:91], v7 offset:16192
    ds_read_b64_tr_b16 v[92:93], v7 offset:14464
    ds_read_b64_tr_b16 v[94:95], v7 offset:16256
    ds_read_b64_tr_b16 v[96:97], v7 offset:14528
    ds_read_b64_tr_b16 v[98:99], v7 offset:16320
    ds_read_b128 v[100:103], v15 offset:0
    ds_read_b64_tr_b16 v[104:105], v7 offset:21504
    ds_read_b64_tr_b16 v[106:107], v7 offset:23296
    ds_read_b64_tr_b16 v[108:109], v7 offset:21568
    ds_read_b64_tr_b16 v[110:111], v7 offset:23360
    ds_read_b64_tr_b16 v[112:113], v7 offset:21632
    ds_read_b64_tr_b16 v[114:115], v7 offset:23424
    ds_read_b64_tr_b16 v[116:117], v7 offset:21696
    ds_read_b64_tr_b16 v[118:119], v7 offset:23488
    ds_read_b128 v[120:123], v16 offset:0
    s_waitcnt lgkmcnt(9)
    v_mfma_f32_32x32x16_bf16 v[20:35], v[84:87], v[100:103], v[20:35]
    v_mfma_f32_32x32x16_bf16 v[36:51], v[88:91], v[100:103], v[36:51]
    v_mfma_f32_32x32x16_bf16 v[52:67], v[92:95], v[100:103], v[52:67]
    v_mfma_f32_32x32x16_bf16 v[68:83], v[96:99], v[100:103], v[68:83]
    s_waitcnt lgkmcnt(0)
    v_mfma_f32_32x32x16_bf16 v[20:35], v[104:107], v[120:123], v[20:35]
    v_mfma_f32_32x32x16_bf16 v[36:51], v[108:111], v[120:123], v[36:51]
    v_mfma_f32_32x32x16_bf16 v[52:67], v[112:115], v[120:123], v[52:67]
    v_mfma_f32_32x32x16_bf16 v[68:83], v[116:119], v[120:123], v[68:83]
    s_waitcnt vmcnt(2)
    s_barrier
    s_cmp_eq_u32 s23, 7
    s_cbranch_scc1 k1w_17
    s_mul_i32 s38, s22, 128
    s_add_u32 m0, s48, 14336
    s_nop 0
    buffer_load_dwordx4 v10, s[8:11], s38 offen lds
    s_add_u32 m0, s48, 15360
    s_nop 0
    buffer_load_dwordx4 v11, s[8:11], s38 offen lds
k1w_17:
    ds_read_b64_tr_b16 v[84:85], v7 offset:28672
    ds_read_b64_tr_b16 v[86:87], v7 offset:30464
    ds_read_b64_tr_b16 v[88:89], v7 offset:28736
    ds_read_b64_tr_b16 v[90:91], v7 offset:30528
    ds_read_b64_tr_b16 v[92:93], v7 offset:28800
    ds_read_b64_tr_b16 v[94:95], v7 offset:30592
    ds_read_b64_tr_b16 v[96:97], v7 offset:28864
    ds_read_b64_tr_b16 v[98:99], v7 offset:30656
    ds_read_b128 v[100:103], v13 offset:128
    ds_read_b64_tr_b16 v[104:105], v7 offset:35840
    ds_read_b64_tr_b16 v[106:107], v7 offset:37632
    ds_read_b64_tr_b16 v[108:109], v7 offset:35904
    ds_read_b64_tr_b16 v[110:111], v7 offset:37696
    ds_read_b64_tr_b16 v[112:113], v7 offset:35968
    ds_read_b64_tr_b16 v[114:115], v7 offset:37760
    ds_read_b64_tr_b16 v[116:117], v7 offset:36032
    ds_read_b64_tr_b16 v[118:119], v7 offset:37824
    ds_read_b128 v[120:123], v14 offset:128
    s_waitcnt lgkmcnt(9)
    v_mfma_f32_32x32x16_bf16 v[20:35], v[84:87], v[100:103], v[20:35]
    v_mfma_f32_32x32x16_bf16 v[36:51], v[88:91], v[100:103], v[36:51]
    v_mfma_f32_32x32x16_bf16 v[52:67], v[92:95], v[100:103], v[52:67]
    v_mfma_f32_32x32x16_bf16 v[68:83], v[96:99], v[100:103], v[68:83]
    s_waitcnt lgkmcnt(0)
    v_mfma_f32_32x32x16_bf16 v[20:35], v[104:107], v[120:123], v[20:35]
    v_mfma_f32_32x32x16_bf16 v[36:51], v[108:111], v[120:123], v[36:51]
    v_mfma_f32_32x32x16_bf16 v[52:67], v[112:115], v[120:123], v[52:67]
    v_mfma_f32_32x32x16_bf16 v[68:83], v[116:119], v[120:123], v[68:83]
    s_waitcnt vmcnt(2)
    s_barrier
    s_cmp_eq_u32 s23, 7
    s_cbranch_scc1 k1w_18
    s_mul_i32 s38, s22, 160
    s_add_u32 m0, s48, 28672
    s_nop 0
    buffer_load_dwordx4 v10, s[8:11], s38 offen lds
    s_add_u32 m0, s48, 29696
    s_nop 0
    buffer_load_dwordx4 v11, s[8:11], s38 offen lds
k1w_18:
    ds_read_b64_tr_b16 v[84:85], v7 offset:0
    ds_read_b64_tr_b16 v[86:87], v7 offset:1792
    ds_read_b64_tr_b16 v[88:89], v7 offset:64
    ds_read_b64_tr_b16 v[90:91], v7 offset:1856
    ds_read_b64_tr_b16 v[92:93], v7 offset:128
    ds_read_b64_tr_b16 v[94:95], v7 offset:1920
    ds_read_b64_tr_b16 v[96:97], v7 offset:192
    ds_read_b64_tr_b16 v[98:99], v7 offset:1984
    ds_read_b128 v[100:103], v15 offset:128
    ds_read_b64_tr_b16 v[104:105], v7 offset:7168
    ds_read_b64_tr_b16 v[106:107], v7 offset:8960
    ds_read_b64_tr_b16 v[108:109], v7 offset:7232
    ds_read_b64_tr_b16 v[110:111], v7 offset:9024
    ds_read_b64_tr_b16 v[112:113], v7 offset:7296
    ds_read_b64_tr_b16 v[114:115], v7 offset:9088
    ds_read_b64_tr_b16 v[116:117], v7 offset:7360
    ds_read_b64_tr_b16 v[118:119], v7 offset:9152
    ds_read_b128 v[120:123], v16 offset:128
    s_waitcnt lgkmcnt(9)
    v_mfma_f32_32x32x16_bf16 v[20:35], v[84:87], v[100:103], v[20:35]
    v_mfma_f32_32x32x16_bf16 v[36:51], v[88:91], v[100:103], v[36:51]
    v_mfma_f32_32x32x16_bf16 v[52:67], v[92:95], v[100:103], v[52:67]
    v_mfma_f32_32x32x16_bf16 v[68:83], v[96:99], v[100:103], v[68:83]
    s_waitcnt lgkmcnt(0)
    v_mfma_f32_32x32x16_bf16 v[20:35], v[104:107], v[120:123], v[20:35]
    v_mfma_f32_32x32x16_bf16 v[36:51], v[108:111], v[120:123], v[36:51]
    v_mfma_f32_32x32x16_bf16 v[52:67], v[112:115], v[120:123], v[52:67]
    v_mfma_f32_32x32x16_bf16 v[68:83], v[116:119], v[120:123], v[68:83]
    s_waitcnt vmcnt(2)
    s_barrier
    s_cmp_eq_u32 s23, 7
    s_cbranch_scc1 k1w_19
    s_mul_i32 s38, s22, 192
    s_add_u32 m0, s48, 0
    s_nop 0
    buffer_load_dwordx4 v10, s[8:11], s38 offen lds
    s_add_u32 m0, s48, 1024
    s_nop 0
    buffer_load_dwordx4 v11, s[8:11], s38 offen lds
k1w_19:
    ds_read_b64_tr_b16 v[84:85], v7 offset:14336
    ds_read_b64_tr_b16 v[86:87], v7 offset:16128
    ds_read_b64_tr_b16 v[88:89], v7 offset:14400
    ds_read_b64_tr_b16 v[90:91], v7 offset:16192
    ds_read_b64_tr_b16 v[92:93], v7 offset:14464
    ds_read_b64_tr_b16 v[94:95], v7 offset:16256
    ds_read_b64_tr_b16 v[96:97], v7 offset:14528
    ds_read_b64_tr_b16 v[98:99], v7 offset:16320
    ds_read_b128 v[100:103], v13 offset:256
    ds_read_b64_tr_b16 v[104:105], v7 offset:21504
    ds_read_b64_tr_b16 v[106:107], v7 offset:23296
    ds_read_b64_tr_b16 v[108:109], v7 offset:21568
    ds_read_b64_tr_b16 v[110:111], v7 offset:23360
    ds_read_b64_tr_b16 v[112:113], v7 offset:21632
    ds_read_b64_tr_b16 v[114:115], v7 offset:23424
    ds_read_b64_tr_b16 v[116:117], v7 offset:21696
    ds_read_b64_tr_b16 v[118:119], v7 offset:23488
    ds_read_b128 v[120:123], v14 offset:256
    s_waitcnt lgkmcnt(9)
    v_mfma_f32_32x32x16_bf16 v[20:35], v[84:87], v[100:103], v[20:35]
    v_mfma_f32_32x32x16_bf16 v[36:51], v[88:91], v[100:103], v[36:51]
    v_mfma_f32_32x32x16_bf16 v[52:67], v[92:95], v[100:103], v[52:67]
    v_mfma_f32_32x32x16_bf16 v[68:83], v[96:99], v[100:103], v[68:83]
    s_waitcnt lgkmcnt(0)
    v_mfma_f32_32x32x16_bf16 v[20:35], v[104:107], v[120:123], v[20:35]
    v_mfma_f32_32x32x16_bf16 v[36:51], v[108:111], v[120:123], v[36:51]
    v_mfma_f32_32x32x16_bf16 v[52:67], v[112:115], v[120:123], v[52:67]
    v_mfma_f32_32x32x16_bf16 v[68:83], v[116:119], v[120:123], v[68:83]
    s_waitcnt vmcnt(2)
    s_barrier
    s_cmp_eq_u32 s23, 7
    s_cbranch_scc1 k1w_20
    s_mul_i32 s38, s22, 224
    s_add_u32 m0, s48, 14336
    s_nop 0
    buffer_load_dwordx4 v10, s[8:11], s38 offen lds
    s_add_u32 m0, s48, 15360
    s_nop 0
    buffer_load_dwordx4 v11, s[8:11], s38 offen lds
k1w_20:
    ds_read_b64_tr_b16 v[84:85], v7 offset:28672
    ds_read_b64_tr_b16 v[86:87], v7 offset:30464
    ds_read_b64_tr_b16 v[88:89], v7 offset:28736
    ds_read_b64_tr_b16 v[90:91], v7 offset:30528
    ds_read_b64_tr_b16 v[92:93], v7 offset:28800
    ds_read_b64_tr_b16 v[94:95], v7 offset:30592
    ds_read_b64_tr_b16 v[96:97], v7 offset:28864
    ds_read_b64_tr_b16 v[98:99], v7 offset:30656
    ds_read_b128 v[100:103], v15 offset:256
    ds_read_b64_tr_b16 v[104:105], v7 offset:35840
    ds_read_b64_tr_b16 v[106:107], v7 offset:37632
    ds_read_b64_tr_b16 v[108:109], v7 offset:35904
    ds_read_b64_tr_b16 v[110:111], v7 offset:37696
    ds_read_b64_tr_b16 v[112:113], v7 offset:35968
    ds_read_b64_tr_b16 v[114:115], v7 offset:37760
    ds_read_b64_tr_b16 v[116:117], v7 offset:36032
    ds_read_b64_tr_b16 v[118:119], v7 offset:37824
    ds_read_b128 v[120:123], v16 offset:256
    s_waitcnt lgkmcnt(9)
    v_mfma_f32_32x32x16_bf16 v[20:35], v[84:87], v[100:103], v[20:35]
    v_mfma_f32_32x32x16_bf16 v[36:51], v[88:91], v[100:103], v[36:51]
    v_mfma_f32_32x32x16_bf16 v[52:67], v[92:95], v[100:103], v[52:67]
    v_mfma_f32_32x32x16_bf16 v[68:83], v[96:99], v[100:103], v[68:83]
    s_waitcnt lgkmcnt(0)
    v_mfma_f32_32x32x16_bf16 v[20:35], v[104:107], v[120:123], v[20:35]
    v_mfma_f32_32x32x16_bf16 v[36:51], v[108:111], v[120:123], v[36:51]
    v_mfma_f32_32x32x16_bf16 v[52:67], v[112:115], v[120:123], v[52:67]
    v_mfma_f32_32x32x16_bf16 v[68:83], v[116:119], v[120:123], v[68:83]
    s_waitcnt vmcnt(2)
    s_barrier
    s_cmp_eq_u32 s23, 7
    s_cbranch_scc1 k1w_21
    s_mul_i32 s38, s22, 256
    s_add_u32 m0, s48, 28672
    s_nop 0
    buffer_load_dwordx4 v10, s[8:11], s38 offen lds
    s_add_u32 m0, s48, 29696
    s_nop 0
    buffer_load_dwordx4 v11, s[8:11], s38 offen lds
k1w_21:
    ds_read_b64_tr_b16 v[84:85], v7 offset:0
    ds_read_b64_tr_b16 v[86:87], v7 offset:1792
    ds_read_b64_tr_b16 v[88:89], v7 offset:64
    ds_read_b64_tr_b16 v[90:91], v7 offset:1856
    ds_read_b64_tr_b16 v[92:93], v7 offset:128
    ds_read_b64_tr_b16 v[94:95], v7 offset:1920
    ds_read_b64_tr_b16 v[96:97], v7 offset:192
    ds_read_b64_tr_b16 v[98:99], v7 offset:1984
    ds_read_b128 v[100:103], v13 offset:384
    ds_read_b64_tr_b16 v[104:105], v7 offset:7168
    ds_read_b64_tr_b16 v[106:107], v7 offset:8960
    ds_read_b64_tr_b16 v[108:109], v7 offset:7232
    ds_read_b64_tr_b16 v[110:111], v7 offset:9024
    ds_read_b64_tr_b16 v[112:113], v7 offset:7296
    ds_read_b64_tr_b16 v[114:115], v7 offset:9088
    ds_read_b64_tr_b16 v[116:117], v7 offset:7360
    ds_read_b64_tr_b16 v[118:119], v7 offset:9152
    ds_read_b128 v[120:123], v14 offset:384
    s_waitcnt lgkmcnt(9)
    v_mfma_f32_32x32x16_bf16 v[20:35], v[84:87], v[100:103], v[20:35]
    v_mfma_f32_32x32x16_bf16 v[36:51], v[88:91], v[100:103], v[36:51]
    v_mfma_f32_32x32x16_bf16 v[52:67], v[92:95], v[100:103], v[52:67]
    v_mfma_f32_32x32x16_bf16 v[68:83], v[96:99], v[100:103], v[68:83]
    s_waitcnt lgkmcnt(0)
    v_mfma_f32_32x32x16_bf16 v[20:35], v[104:107], v[120:123], v[20:35]
    v_mfma_f32_32x32x16_bf16 v[36:51], v[108:111], v[120:123], v[36:51]
    v_mfma_f32_32x32x16_bf16 v[52:67], v[112:115], v[120:123], v[52:67]
    v_mfma_f32_32x32x16_bf16 v[68:83], v[116:119], v[120:123], v[68:83]
    s_waitcnt vmcnt(2)
    s_barrier
    s_cmp_eq_u32 s23, 7
    s_cbranch_scc1 k1w_22
    s_mul_i32 s38, s22, 288
    s_add_u32 m0, s48, 0
    s_nop 0
    buffer_load_dwordx4 v10, s[8:11], s38 offen lds
    s_add_u32 m0, s48, 1024
    s_nop 0
    buffer_load_dwordx4 v11, s[8:11], s38 offen lds
k1w_22:
    ds_read_b64_tr_b16 v[84:85], v7 offset:14336
    ds_read_b64_tr_b16 v[86:87], v7 offset:16128
    ds_read_b64_tr_b16 v[88:89], v7 offset:14400
    ds_read_b64_tr_b16 v[90:91], v7 offset:16192
    ds_read_b64_tr_b16 v[92:93], v7 offset:14464
    ds_read_b64_tr_b16 v[94:95], v7 offset:16256
    ds_read_b64_tr_b16 v[96:97], v7 offset:14528
    ds_read_b64_tr_b16 v[98:99], v7 offset:16320
    ds_read_b128 v[100:103], v15 offset:384
    ds_read_b64_tr_b16 v[104:105], v7 offset:21504
    ds_read_b64_tr_b16 v[106:107], v7 offset:23296
    ds_read_b64_tr_b16 v[108:109], v7 offset:21568
    ds_read_b64_tr_b16 v[110:111], v7 offset:23360
    ds_read_b64_tr_b16 v[112:113], v7 offset:21632
    ds_read_b64_tr_b16 v[114:115], v7 offset:23424
    ds_read_b64_tr_b16 v[116:117], v7 offset:21696
    ds_read_b64_tr_b16 v[118:119], v7 offset:23488
    ds_read_b128 v[120:123], v16 offset:384
    s_waitcnt lgkmcnt(9)
    v_mfma_f32_32x32x16_bf16 v[20:35], v[84:87], v[100:103], v[20:35]
    v_mfma_f32_32x32x16_bf16 v[36:51], v[88:91], v[100:103], v[36:51]
    v_mfma_f32_32x32x16_bf16 v[52:67], v[92:95], v[100:103], v[52:67]
    v_mfma_f32_32x32x16_bf16 v[68:83], v[96:99], v[100:103], v[68:83]
    s_waitcnt lgkmcnt(0)
    v_mfma_f32_32x32x16_bf16 v[20:35], v[104:107], v[120:123], v[20:35]
    v_mfma_f32_32x32x16_bf16 v[36:51], v[108:111], v[120:123], v[36:51]
    v_mfma_f32_32x32x16_bf16 v[52:67], v[112:115], v[120:123], v[52:67]
    v_mfma_f32_32x32x16_bf16 v[68:83], v[116:119], v[120:123], v[68:83]
    s_waitcnt vmcnt(2)
    s_barrier
    s_cmp_eq_u32 s23, 7
    s_cbranch_scc1 k1w_23
    s_mul_i32 s38, s22, 320
    s_add_u32 m0, s48, 14336
    s_nop 0
    buffer_load_dwordx4 v10, s[8:11], s38 offen lds
    s_add_u32 m0, s48, 15360
    s_nop 0
    buffer_load_dwordx4 v11, s[8:11], s38 offen lds
k1w_23:
    ds_read_b64_tr_b16 v[84:85], v7 offset:28672
    ds_read_b64_tr_b16 v[86:87], v7 offset:30464
    ds_read_b64_tr_b16 v[88:89], v7 offset:28736
    ds_read_b64_tr_b16 v[90:91], v7 offset:30528
    ds_read_b64_tr_b16 v[92:93], v7 offset:28800
    ds_read_b64_tr_b16 v[94:95], v7 offset:30592
    ds_read_b64_tr_b16 v[96:97], v7 offset:28864
    ds_read_b64_tr_b16 v[98:99], v7 offset:30656
    ds_read_b128 v[100:103], v13 offset:512
    ds_read_b64_tr_b16 v[104:105], v7 offset:35840
    ds_read_b64_tr_b16 v[106:107], v7 offset:37632
    ds_read_b64_tr_b16 v[108:109], v7 offset:35904
    ds_read_b64_tr_b16 v[110:111], v7 offset:37696
    ds_read_b64_tr_b16 v[112:113], v7 offset:35968
    ds_read_b64_tr_b16 v[114:115], v7 offset:37760
    ds_read_b64_tr_b16 v[116:117], v7 offset:36032
    ds_read_b64_tr_b16 v[118:119], v7 offset:37824
    ds_read_b128 v[120:123], v14 offset:512
    s_waitcnt lgkmcnt(9)
    v_mfma_f32_32x32x16_bf16 v[20:35], v[84:87], v[100:103], v[20:35]
    v_mfma_f32_32x32x16_bf16 v[36:51], v[88:91], v[100:103], v[36:51]
    v_mfma_f32_32x32x16_bf16 v[52:67], v[92:95], v[100:103], v[52:67]
    v_mfma_f32_32x32x16_bf16 v[68:83], v[96:99], v[100:103], v[68:83]
    s_waitcnt lgkmcnt(0)
    v_mfma_f32_32x32x16_bf16 v[20:35], v[104:107], v[120:123], v[20:35]
    v_mfma_f32_32x32x16_bf16 v[36:51], v[108:111], v[120:123], v[36:51]
    v_mfma_f32_32x32x16_bf16 v[52:67], v[112:115], v[120:123], v[52:67]
    v_mfma_f32_32x32x16_bf16 v[68:83], v[116:119], v[120:123], v[68:83]
    s_waitcnt vmcnt(2)
    s_barrier
    s_cmp_eq_u32 s23, 7
    s_cbranch_scc1 k1w_24
    s_mul_i32 s38, s22, 352
    s_add_u32 m0, s48, 28672
    s_nop 0
    buffer_load_dwordx4 v10, s[8:11], s38 offen lds
    s_add_u32 m0, s48, 29696
    s_nop 0
    buffer_load_dwordx4 v11, s[8:11], s38 offen lds
k1w_24:
    ds_read_b64_tr_b16 v[84:85], v7 offset:0
    ds_read_b64_tr_b16 v[86:87], v7 offset:1792
    ds_read_b64_tr_b16 v[88:89], v7 offset:64
    ds_read_b64_tr_b16 v[90:91], v7 offset:1856
    ds_read_b64_tr_b16 v[92:93], v7 offset:128
    ds_read_b64_tr_b16 v[94:95], v7 offset:1920
    ds_read_b64_tr_b16 v[96:97], v7 offset:192
    ds_read_b64_tr_b16 v[98:99], v7 offset:1984
    ds_read_b128 v[100:103], v15 offset:512
    ds_read_b64_tr_b16 v[104:105], v7 offset:7168
    ds_read_b64_tr_b16 v[106:107], v7 offset:8960
    ds_read_b64_tr_b16 v[108:109], v7 offset:7232
    ds_read_b64_tr_b16 v[110:111], v7 offset:9024
    ds_read_b64_tr_b16 v[112:113], v7 offset:7296
    ds_read_b64_tr_b16 v[114:115], v7 offset:9088
    ds_read_b64_tr_b16 v[116:117], v7 offset:7360
    ds_read_b64_tr_b16 v[118:119], v7 offset:9152
    ds_read_b128 v[120:123], v16 offset:512
    s_waitcnt lgkmcnt(9)
    v_mfma_f32_32x32x16_bf16 v[20:35], v[84:87], v[100:103], v[20:35]
    v_mfma_f32_32x32x16_bf16 v[36:51], v[88:91], v[100:103], v[36:51]
    v_mfma_f32_32x32x16_bf16 v[52:67], v[92:95], v[100:103], v[52:67]
    v_mfma_f32_32x32x16_bf16 v[68:83], v[96:99], v[100:103], v[68:83]
    s_waitcnt lgkmcnt(0)
    v_mfma_f32_32x32x16_bf16 v[20:35], v[104:107], v[120:123], v[20:35]
    v_mfma_f32_32x32x16_bf16 v[36:51], v[108:111], v[120:123], v[36:51]
    v_mfma_f32_32x32x16_bf16 v[52:67], v[112:115], v[120:123], v[52:67]
    v_mfma_f32_32x32x16_bf16 v[68:83], v[116:119], v[120:123], v[68:83]
    s_waitcnt vmcnt(2)
    s_barrier
    s_cmp_eq_u32 s23, 7
    s_cbranch_scc1 k1w_25
    s_mul_i32 s38, s22, 384
    s_add_u32 m0, s48, 0
    s_nop 0
    buffer_load_dwordx4 v10, s[8:11], s38 offen lds
    s_add_u32 m0, s48, 1024
    s_nop 0
    buffer_load_dwordx4 v11, s[8:11], s38 offen lds
k1w_25:
    ds_read_b64_tr_b16 v[84:85], v7 offset:14336
    ds_read_b64_tr_b16 v[86:87], v7 offset:16128
    ds_read_b64_tr_b16 v[88:89], v7 offset:14400
    ds_read_b64_tr_b16 v[90:91], v7 offset:16192
    ds_read_b64_tr_b16 v[92:93], v7 offset:14464
    ds_read_b64_tr_b16 v[94:95], v7 offset:16256
    ds_read_b64_tr_b16 v[96:97], v7 offset:14528
    ds_read_b64_tr_b16 v[98:99], v7 offset:16320
    ds_read_b128 v[100:103], v13 offset:640
    ds_read_b64_tr_b16 v[104:105], v7 offset:21504
    ds_read_b64_tr_b16 v[106:107], v7 offset:23296
    ds_read_b64_tr_b16 v[108:109], v7 offset:21568
    ds_read_b64_tr_b16 v[110:111], v7 offset:23360
    ds_read_b64_tr_b16 v[112:113], v7 offset:21632
    ds_read_b64_tr_b16 v[114:115], v7 offset:23424
    ds_read_b64_tr_b16 v[116:117], v7 offset:21696
    ds_read_b64_tr_b16 v[118:119], v7 offset:23488
    ds_read_b128 v[120:123], v14 offset:640
    s_waitcnt lgkmcnt(9)
    v_mfma_f32_32x32x16_bf16 v[20:35], v[84:87], v[100:103], v[20:35]
    v_mfma_f32_32x32x16_bf16 v[36:51], v[88:91], v[100:103], v[36:51]
    v_mfma_f32_32x32x16_bf16 v[52:67], v[92:95], v[100:103], v[52:67]
    v_mfma_f32_32x32x16_bf16 v[68:83], v[96:99], v[100:103], v[68:83]
    s_waitcnt lgkmcnt(0)
    v_mfma_f32_32x32x16_bf16 v[20:35], v[104:107], v[120:123], v[20:35]
    v_mfma_f32_32x32x16_bf16 v[36:51], v[108:111], v[120:123], v[36:51]
    v_mfma_f32_32x32x16_bf16 v[52:67], v[112:115], v[120:123], v[52:67]
    v_mfma_f32_32x32x16_bf16 v[68:83], v[116:119], v[120:123], v[68:83]
    s_waitcnt vmcnt(2)
    s_barrier
    s_cmp_eq_u32 s23, 7
    s_cbranch_scc1 k1w_26
    s_mul_i32 s38, s22, 416
    s_add_u32 m0, s48, 14336
    s_nop 0
    buffer_load_dwordx4 v10, s[8:11], s38 offen lds
    s_add_u32 m0, s48, 15360
    s_nop 0
    buffer_load_dwordx4 v11, s[8:11], s38 offen lds
k1w_26:
    ds_read_b64_tr_b16 v[84:85], v7 offset:28672
    ds_read_b64_tr_b16 v[86:87], v7 offset:30464
    ds_read_b64_tr_b16 v[88:89], v7 offset:28736
    ds_read_b64_tr_b16 v[90:91], v7 offset:30528
    ds_read_b64_tr_b16 v[92:93], v7 offset:28800
    ds_read_b64_tr_b16 v[94:95], v7 offset:30592
    ds_read_b64_tr_b16 v[96:97], v7 offset:28864
    ds_read_b64_tr_b16 v[98:99], v7 offset:30656
    ds_read_b128 v[100:103], v15 offset:640
    ds_read_b64_tr_b16 v[104:105], v7 offset:35840
    ds_read_b64_tr_b16 v[106:107], v7 offset:37632
    ds_read_b64_tr_b16 v[108:109], v7 offset:35904
    ds_read_b64_tr_b16 v[110:111], v7 offset:37696
    ds_read_b64_tr_b16 v[112:113], v7 offset:35968
    ds_read_b64_tr_b16 v[114:115], v7 offset:37760
    ds_read_b64_tr_b16 v[116:117], v7 offset:36032
    ds_read_b64_tr_b16 v[118:119], v7 offset:37824
    ds_read_b128 v[120:123], v16 offset:640
    s_waitcnt lgkmcnt(9)
    v_mfma_f32_32x32x16_bf16 v[20:35], v[84:87], v[100:103], v[20:35]
    v_mfma_f32_32x32x16_bf16 v[36:51], v[88:91], v[100:103], v[36:51]
    v_mfma_f32_32x32x16_bf16 v[52:67], v[92:95], v[100:103], v[52:67]
    v_mfma_f32_32x32x16_bf16 v[68:83], v[96:99], v[100:103], v[68:83]
    s_waitcnt lgkmcnt(0)
    v_mfma_f32_32x32x16_bf16 v[20:35], v[104:107], v[120:123], v[20:35]
    v_mfma_f32_32x32x16_bf16 v[36:51], v[108:111], v[120:123], v[36:51]
    v_mfma_f32_32x32x16_bf16 v[52:67], v[112:115], v[120:123], v[52:67]
    v_mfma_f32_32x32x16_bf16 v[68:83], v[116:119], v[120:123], v[68:83]
    s_waitcnt vmcnt(2)
    s_barrier
    ds_read_b64_tr_b16 v[84:85], v7 offset:0
    ds_read_b64_tr_b16 v[86:87], v7 offset:1792
    ds_read_b64_tr_b16 v[88:89], v7 offset:64
    ds_read_b64_tr_b16 v[90:91], v7 offset:1856
    ds_read_b64_tr_b16 v[92:93], v7 offset:128
    ds_read_b64_tr_b16 v[94:95], v7 offset:1920
    ds_read_b64_tr_b16 v[96:97], v7 offset:192
    ds_read_b64_tr_b16 v[98:99], v7 offset:1984
    ds_read_b128 v[100:103], v13 offset:768
    ds_read_b64_tr_b16 v[104:105], v7 offset:7168
    ds_read_b64_tr_b16 v[106:107], v7 offset:8960
    ds_read_b64_tr_b16 v[108:109], v7 offset:7232
    ds_read_b64_tr_b16 v[110:111], v7 offset:9024
    ds_read_b64_tr_b16 v[112:113], v7 offset:7296
    ds_read_b64_tr_b16 v[114:115], v7 offset:9088
    ds_read_b64_tr_b16 v[116:117], v7 offset:7360
    ds_read_b64_tr_b16 v[118:119], v7 offset:9152
    ds_read_b128 v[120:123], v14 offset:768
    s_waitcnt lgkmcnt(9)
    v_mfma_f32_32x32x16_bf16 v[20:35], v[84:87], v[100:103], v[20:35]
    v_mfma_f32_32x32x16_bf16 v[36:51], v[88:91], v[100:103], v[36:51]
    v_mfma_f32_32x32x16_bf16 v[52:67], v[92:95], v[100:103], v[52:67]
    v_mfma_f32_32x32x16_bf16 v[68:83], v[96:99], v[100:103], v[68:83]
    s_waitcnt lgkmcnt(0)
    v_mfma_f32_32x32x16_bf16 v[20:35], v[104:107], v[120:123], v[20:35]
    v_mfma_f32_32x32x16_bf16 v[36:51], v[108:111], v[120:123], v[36:51]
    v_mfma_f32_32x32x16_bf16 v[52:67], v[112:115], v[120:123], v[52:67]
    v_mfma_f32_32x32x16_bf16 v[68:83], v[116:119], v[120:123], v[68:83]
    s_waitcnt vmcnt(0)
    s_barrier
    ds_read_b64_tr_b16 v[84:85], v7 offset:14336
    ds_read_b64_tr_b16 v[86:87], v7 offset:16128
    ds_read_b64_tr_b16 v[88:89], v7 offset:14400
    ds_read_b64_tr_b16 v[90:91], v7 offset:16192
    ds_read_b64_tr_b16 v[92:93], v7 offset:14464
    ds_read_b64_tr_b16 v[94:95], v7 offset:16256
    ds_read_b64_tr_b16 v[96:97], v7 offset:14528
    ds_read_b64_tr_b16 v[98:99], v7 offset:16320
    ds_read_b128 v[100:103], v15 offset:768
    ds_read_b64_tr_b16 v[104:105], v7 offset:21504
    ds_read_b64_tr_b16 v[106:107], v7 offset:23296
    ds_read_b64_tr_b16 v[108:109], v7 offset:21568
    ds_read_b64_tr_b16 v[110:111], v7 offset:23360
    ds_read_b64_tr_b16 v[112:113], v7 offset:21632
    ds_read_b64_tr_b16 v[114:115], v7 offset:23424
    ds_read_b64_tr_b16 v[116:117], v7 offset:21696
    ds_read_b64_tr_b16 v[118:119], v7 offset:23488
    ds_read_b128 v[120:123], v16 offset:768
    s_waitcnt lgkmcnt(9)
    v_mfma_f32_32x32x16_bf16 v[20:35], v[84:87], v[100:103], v[20:35]
    v_mfma_f32_32x32x16_bf16 v[36:51], v[88:91], v[100:103], v[36:51]
    v_mfma_f32_32x32x16_bf16 v[52:67], v[92:95], v[100:103], v[52:67]
    v_mfma_f32_32x32x16_bf16 v[68:83], v[96:99], v[100:103], v[68:83]
    s_waitcnt lgkmcnt(0)
    v_mfma_f32_32x32x16_bf16 v[20:35], v[104:107], v[120:123], v[20:35]
    v_mfma_f32_32x32x16_bf16 v[36:51], v[108:111], v[120:123], v[36:51]
    v_mfma_f32_32x32x16_bf16 v[52:67], v[112:115], v[120:123], v[52:67]
    v_mfma_f32_32x32x16_bf16 v[68:83], v[116:119], v[120:123], v[68:83]
    s_mov_b32 s56, s54
    s_and_b32 s57, s55, 0xffff
    s_mov_b32 s58, 8388608
    s_mov_b32 s59, 0x00020000
    s_and_b32 s38, s2, 7
    s_lshl_b32 s38, s38, 20
    s_lshr_b32 s49, s2, 3
    s_lshl_b32 s49, s49, 13
    s_add_u32 s38, s38, s49
    buffer_load_dwordx4 v[232:235], v3, s[56:59], s38 offen
    s_add_u32 s38, s38, 229376
    buffer_load_dwordx4 v[232:235], v3, s[56:59], s38 offen
    s_add_u32 s38, s38, 229376
    buffer_load_dwordx4 v[232:235], v3, s[56:59], s38 offen
    s_add_u32 s38, s38, 229376
    buffer_load_dwordx4 v[232:235], v3, s[56:59], s38 offen
    s_add_u32 s38, s38, 229376
    buffer_load_dwordx4 v[232:235], v3, s[56:59], s38 offen
    s_add_u32 s38, s38, 229376
    s_barrier
    v_and_b32 v2, 31, v1
    v_lshrrev_b32 v3, 5, v1
    s_mul_i32 s49, s23, 8704
    v_mul_u32_u24 v4, 272, v2
    v_lshl_add_u32 v4, v3, 3, v4
    v_add_u32 v4, s49, v4
    s_lshl_b32 s40, s20, 7
    s_and_b32 s41, s23, 3
    s_lshl_b32 s41, s41, 5
    s_add_u32 s40, s40, s41
    v_add_u32 v2, s40, v2
    s_sub_u32 s41, s21, 6
    s_and_b32 s45, s41, 3
    s_mul_i32 s45, s45, 448
    s_lshr_b32 s46, s23, 2
    s_lshl_b32 s46, s46, 8
    s_add_u32 s45, s45, s46
    s_cmp_ge_u32 s41, 4
    s_mov_b32 s46, 13897728
    s_cselect_b32 s46, s46, 10227712
    s_add_u32 s45, s45, s46
    s_mul_i32 s46, s40, 1792
    s_add_u32 s45, s45, s46
    s_and_b32 s46, s41, 3
    s_lshl_b32 s46, s46, 14
    s_add_u32 s46, s46, 21237760
    v_lshlrev_b32 v9, 2, v2
    s_mov_b32 s44, 3222493025
    s_mov_b32 s47, 1027024659
    v_mov_b32 v188, 3184710632
    v_mov_b32 v189, 3184710632
    v_mov_b32 v190, 3222493025
    v_mov_b32 v191, 3222493025
    v_mov_b32 v192, 1.0
    v_mov_b32 v193, 1.0
    v_mov_b32 v180, 0
    v_mov_b32 v181, 0
    v_cvt_pk_bf16_f32 v182, v20, v21
    v_lshlrev_b32 v140, 16, v182
    v_and_b32 v141, 0xffff0000, v182
    v_cvt_pk_bf16_f32 v182, v22, v23
    v_lshlrev_b32 v142, 16, v182
    v_and_b32 v143, 0xffff0000, v182
    v_cvt_pk_bf16_f32 v182, v24, v25
    v_lshlrev_b32 v144, 16, v182
    v_and_b32 v145, 0xffff0000, v182
    v_cvt_pk_bf16_f32 v182, v26, v27
    v_lshlrev_b32 v146, 16, v182
    v_and_b32 v147, 0xffff0000, v182
    v_cvt_pk_bf16_f32 v182, v28, v29
    v_lshlrev_b32 v148, 16, v182
    v_and_b32 v149, 0xffff0000, v182
    v_cvt_pk_bf16_f32 v182, v30, v31
    v_lshlrev_b32 v150, 16, v182
    v_and_b32 v151, 0xffff0000, v182
    v_cvt_pk_bf16_f32 v182, v32, v33
    v_lshlrev_b32 v152, 16, v182
    v_and_b32 v153, 0xffff0000, v182
    v_cvt_pk_bf16_f32 v182, v34, v35
    v_lshlrev_b32 v154, 16, v182
    v_and_b32 v155, 0xffff0000, v182
    v_pk_mul_f32 v[156:157], v[140:141], v[140:141]
    v_pk_fma_f32 v[156:157], v[156:157], v[188:189], v[190:191]
    v_pk_mul_f32 v[156:157], v[156:157], v[140:141]
    v_pk_mul_f32 v[158:159], v[142:143], v[142:143]
    v_pk_fma_f32 v[158:159], v[158:159], v[188:189], v[190:191]
    v_pk_mul_f32 v[158:159], v[158:159], v[142:143]
    v_pk_mul_f32 v[160:161], v[144:145], v[144:145]
    v_pk_fma_f32 v[160:161], v[160:161], v[188:189], v[190:191]
    v_pk_mul_f32 v[160:161], v[160:161], v[144:145]
    v_pk_mul_f32 v[162:163], v[146:147], v[146:147]
    v_pk_fma_f32 v[162:163], v[162:163], v[188:189], v[190:191]
    v_pk_mul_f32 v[162:163], v[162:163], v[146:147]
    v_pk_mul_f32 v[164:165], v[148:149], v[148:149]
    v_pk_fma_f32 v[164:165], v[164:165], v[188:189], v[190:191]
    v_pk_mul_f32 v[164:165], v[164:165], v[148:149]
    v_pk_mul_f32 v[166:167], v[150:151], v[150:151]
    v_pk_fma_f32 v[166:167], v[166:167], v[188:189], v[190:191]
    v_pk_mul_f32 v[166:167], v[166:167], v[150:151]
    v_pk_mul_f32 v[168:169], v[152:153], v[152:153]
    v_pk_fma_f32 v[168:169], v[168:169], v[188:189], v[190:191]
    v_pk_mul_f32 v[168:169], v[168:169], v[152:153]
    v_pk_mul_f32 v[170:171], v[154:155], v[154:155]
    v_pk_fma_f32 v[170:171], v[170:171], v[188:189], v[190:191]
    v_pk_mul_f32 v[170:171], v[170:171], v[154:155]
    v_exp_f32 v156, v156
    v_exp_f32 v157, v157
    v_exp_f32 v158, v158
    v_exp_f32 v159, v159
    v_exp_f32 v160, v160
    v_exp_f32 v161, v161
    v_exp_f32 v162, v162
    v_exp_f32 v163, v163
    v_exp_f32 v164, v164
    v_exp_f32 v165, v165
    v_exp_f32 v166, v166
    v_exp_f32 v167, v167
    v_exp_f32 v168, v168
    v_exp_f32 v169, v169
    v_exp_f32 v170, v170
    v_exp_f32 v171, v171
    s_nop 0
    v_pk_add_f32 v[156:157], v[156:157], v[192:193]
    v_pk_add_f32 v[158:159], v[158:159], v[192:193]
    v_pk_add_f32 v[160:161], v[160:161], v[192:193]
    v_pk_add_f32 v[162:163], v[162:163], v[192:193]
    v_pk_add_f32 v[164:165], v[164:165], v[192:193]
    v_pk_add_f32 v[166:167], v[166:167], v[192:193]
    v_pk_add_f32 v[168:169], v[168:169], v[192:193]
    v_pk_add_f32 v[170:171], v[170:171], v[192:193]
    v_rcp_f32 v156, v156
    v_rcp_f32 v157, v157
    v_rcp_f32 v158, v158
    v_rcp_f32 v159, v159
    v_rcp_f32 v160, v160
    v_rcp_f32 v161, v161
    v_rcp_f32 v162, v162
    v_rcp_f32 v163, v163
    v_rcp_f32 v164, v164
    v_rcp_f32 v165, v165
    v_rcp_f32 v166, v166
    v_rcp_f32 v167, v167
    v_rcp_f32 v168, v168
    v_rcp_f32 v169, v169
    v_rcp_f32 v170, v170
    v_rcp_f32 v171, v171
    s_nop 0
    v_pk_mul_f32 v[156:157], v[156:157], v[140:141]
    v_pk_mul_f32 v[158:159], v[158:159], v[142:143]
    v_pk_mul_f32 v[160:161], v[160:161], v[144:145]
    v_pk_mul_f32 v[162:163], v[162:163], v[146:147]
    v_pk_mul_f32 v[164:165], v[164:165], v[148:149]
    v_pk_mul_f32 v[166:167], v[166:167], v[150:151]
    v_pk_mul_f32 v[168:169], v[168:169], v[152:153]
    v_pk_mul_f32 v[170:171], v[170:171], v[154:155]
    v_cvt_pk_bf16_f32 v140, v156, v157
    v_cvt_pk_bf16_f32 v141, v158, v159
    v_cvt_pk_bf16_f32 v142, v160, v161
    v_cvt_pk_bf16_f32 v143, v162, v163
    v_cvt_pk_bf16_f32 v144, v164, v165
    v_cvt_pk_bf16_f32 v145, v166, v167
    v_cvt_pk_bf16_f32 v146, v168, v169
    v_cvt_pk_bf16_f32 v147, v170, v171
    ds_write_b64 v4, v[140:141] offset:0
    ds_write_b64 v4, v[142:143] offset:16
    ds_write_b64 v4, v[144:145] offset:32
    ds_write_b64 v4, v[146:147] offset:48
    v_dot2c_f32_bf16 v181, v140, v140
    v_lshlrev_b32 v182, 16, v140
    v_and_b32 v183, 0xffff0000, v140
    v_add_f32 v180, v180, v182
    v_add_f32 v180, v180, v183
    v_dot2c_f32_bf16 v181, v141, v141
    v_lshlrev_b32 v182, 16, v141
    v_and_b32 v183, 0xffff0000, v141
    v_add_f32 v180, v180, v182
    v_add_f32 v180, v180, v183
    v_dot2c_f32_bf16 v181, v142, v142
    v_lshlrev_b32 v182, 16, v142
    v_and_b32 v183, 0xffff0000, v142
    v_add_f32 v180, v180, v182
    v_add_f32 v180, v180, v183
    v_dot2c_f32_bf16 v181, v143, v143
    v_lshlrev_b32 v182, 16, v143
    v_and_b32 v183, 0xffff0000, v143
    v_add_f32 v180, v180, v182
    v_add_f32 v180, v180, v183
    v_dot2c_f32_bf16 v181, v144, v144
    v_lshlrev_b32 v182, 16, v144
    v_and_b32 v183, 0xffff0000, v144
    v_add_f32 v180, v180, v182
    v_add_f32 v180, v180, v183
    v_dot2c_f32_bf16 v181, v145, v145
    v_lshlrev_b32 v182, 16, v145
    v_and_b32 v183, 0xffff0000, v145
    v_add_f32 v180, v180, v182
    v_add_f32 v180, v180, v183
    v_dot2c_f32_bf16 v181, v146, v146
    v_lshlrev_b32 v182, 16, v146
    v_and_b32 v183, 0xffff0000, v146
    v_add_f32 v180, v180, v182
    v_add_f32 v180, v180, v183
    v_dot2c_f32_bf16 v181, v147, v147
    v_lshlrev_b32 v182, 16, v147
    v_and_b32 v183, 0xffff0000, v147
    v_add_f32 v180, v180, v182
    v_add_f32 v180, v180, v183
    v_cvt_pk_bf16_f32 v182, v36, v37
    v_lshlrev_b32 v140, 16, v182
    v_and_b32 v141, 0xffff0000, v182
    v_cvt_pk_bf16_f32 v182, v38, v39
    v_lshlrev_b32 v142, 16, v182
    v_and_b32 v143, 0xffff0000, v182
    v_cvt_pk_bf16_f32 v182, v40, v41
    v_lshlrev_b32 v144, 16, v182
    v_and_b32 v145, 0xffff0000, v182
    v_cvt_pk_bf16_f32 v182, v42, v43
    v_lshlrev_b32 v146, 16, v182
    v_and_b32 v147, 0xffff0000, v182
    v_cvt_pk_bf16_f32 v182, v44, v45
    v_lshlrev_b32 v148, 16, v182
    v_and_b32 v149, 0xffff0000, v182
    v_cvt_pk_bf16_f32 v182, v46, v47
    v_lshlrev_b32 v150, 16, v182
    v_and_b32 v151, 0xffff0000, v182
    v_cvt_pk_bf16_f32 v182, v48, v49
    v_lshlrev_b32 v152, 16, v182
    v_and_b32 v153, 0xffff0000, v182
    v_cvt_pk_bf16_f32 v182, v50, v51
    v_lshlrev_b32 v154, 16, v182
    v_and_b32 v155, 0xffff0000, v182
    v_pk_mul_f32 v[156:157], v[140:141], v[140:141]
    v_pk_fma_f32 v[156:157], v[156:157], v[188:189], v[190:191]
    v_pk_mul_f32 v[156:157], v[156:157], v[140:141]
    v_pk_mul_f32 v[158:159], v[142:143], v[142:143]
    v_pk_fma_f32 v[158:159], v[158:159], v[188:189], v[190:191]
    v_pk_mul_f32 v[158:159], v[158:159], v[142:143]
    v_pk_mul_f32 v[160:161], v[144:145], v[144:145]
    v_pk_fma_f32 v[160:161], v[160:161], v[188:189], v[190:191]
    v_pk_mul_f32 v[160:161], v[160:161], v[144:145]
    v_pk_mul_f32 v[162:163], v[146:147], v[146:147]
    v_pk_fma_f32 v[162:163], v[162:163], v[188:189], v[190:191]
    v_pk_mul_f32 v[162:163], v[162:163], v[146:147]
    v_pk_mul_f32 v[164:165], v[148:149], v[148:149]
    v_pk_fma_f32 v[164:165], v[164:165], v[188:189], v[190:191]
    v_pk_mul_f32 v[164:165], v[164:165], v[148:149]
    v_pk_mul_f32 v[166:167], v[150:151], v[150:151]
    v_pk_fma_f32 v[166:167], v[166:167], v[188:189], v[190:191]
    v_pk_mul_f32 v[166:167], v[166:167], v[150:151]
    v_pk_mul_f32 v[168:169], v[152:153], v[152:153]
    v_pk_fma_f32 v[168:169], v[168:169], v[188:189], v[190:191]
    v_pk_mul_f32 v[168:169], v[168:169], v[152:153]
    v_pk_mul_f32 v[170:171], v[154:155], v[154:155]
    v_pk_fma_f32 v[170:171], v[170:171], v[188:189], v[190:191]
    v_pk_mul_f32 v[170:171], v[170:171], v[154:155]
    v_exp_f32 v156, v156
    v_exp_f32 v157, v157
    v_exp_f32 v158, v158
    v_exp_f32 v159, v159
    v_exp_f32 v160, v160
    v_exp_f32 v161, v161
    v_exp_f32 v162, v162
    v_exp_f32 v163, v163
    v_exp_f32 v164, v164
    v_exp_f32 v165, v165
    v_exp_f32 v166, v166
    v_exp_f32 v167, v167
    v_exp_f32 v168, v168
    v_exp_f32 v169, v169
    v_exp_f32 v170, v170
    v_exp_f32 v171, v171
    s_nop 0
    v_pk_add_f32 v[156:157], v[156:157], v[192:193]
    v_pk_add_f32 v[158:159], v[158:159], v[192:193]
    v_pk_add_f32 v[160:161], v[160:161], v[192:193]
    v_pk_add_f32 v[162:163], v[162:163], v[192:193]
    v_pk_add_f32 v[164:165], v[164:165], v[192:193]
    v_pk_add_f32 v[166:167], v[166:167], v[192:193]
    v_pk_add_f32 v[168:169], v[168:169], v[192:193]
    v_pk_add_f32 v[170:171], v[170:171], v[192:193]
    v_rcp_f32 v156, v156
    v_rcp_f32 v157, v157
    v_rcp_f32 v158, v158
    v_rcp_f32 v159, v159
    v_rcp_f32 v160, v160
    v_rcp_f32 v161, v161
    v_rcp_f32 v162, v162
    v_rcp_f32 v163, v163
    v_rcp_f32 v164, v164
    v_rcp_f32 v165, v165
    v_rcp_f32 v166, v166
    v_rcp_f32 v167, v167
    v_rcp_f32 v168, v168
    v_rcp_f32 v169, v169
    v_rcp_f32 v170, v170
    v_rcp_f32 v171, v171
    s_nop 0
    v_pk_mul_f32 v[156:157], v[156:157], v[140:141]
    v_pk_mul_f32 v[158:159], v[158:159], v[142:143]
    v_pk_mul_f32 v[160:161], v[160:161], v[144:145]
    v_pk_mul_f32 v[162:163], v[162:163], v[146:147]
    v_pk_mul_f32 v[164:165], v[164:165], v[148:149]
    v_pk_mul_f32 v[166:167], v[166:167], v[150:151]
    v_pk_mul_f32 v[168:169], v[168:169], v[152:153]
    v_pk_mul_f32 v[170:171], v[170:171], v[154:155]
    v_cvt_pk_bf16_f32 v140, v156, v157
    v_cvt_pk_bf16_f32 v141, v158, v159
    v_cvt_pk_bf16_f32 v142, v160, v161
    v_cvt_pk_bf16_f32 v143, v162, v163
    v_cvt_pk_bf16_f32 v144, v164, v165
    v_cvt_pk_bf16_f32 v145, v166, v167
    v_cvt_pk_bf16_f32 v146, v168, v169
    v_cvt_pk_bf16_f32 v147, v170, v171
    ds_write_b64 v4, v[140:141] offset:64
    ds_write_b64 v4, v[142:143] offset:80
    ds_write_b64 v4, v[144:145] offset:96
    ds_write_b64 v4, v[146:147] offset:112
    v_dot2c_f32_bf16 v181, v140, v140
    v_lshlrev_b32 v182, 16, v140
    v_and_b32 v183, 0xffff0000, v140
    v_add_f32 v180, v180, v182
    v_add_f32 v180, v180, v183
    v_dot2c_f32_bf16 v181, v141, v141
    v_lshlrev_b32 v182, 16, v141
    v_and_b32 v183, 0xffff0000, v141
    v_add_f32 v180, v180, v182
    v_add_f32 v180, v180, v183
    v_dot2c_f32_bf16 v181, v142, v142
    v_lshlrev_b32 v182, 16, v142
    v_and_b32 v183, 0xffff0000, v142
    v_add_f32 v180, v180, v182
    v_add_f32 v180, v180, v183
    v_dot2c_f32_bf16 v181, v143, v143
    v_lshlrev_b32 v182, 16, v143
    v_and_b32 v183, 0xffff0000, v143
    v_add_f32 v180, v180, v182
    v_add_f32 v180, v180, v183
    v_dot2c_f32_bf16 v181, v144, v144
    v_lshlrev_b32 v182, 16, v144
    v_and_b32 v183, 0xffff0000, v144
    v_add_f32 v180, v180, v182
    v_add_f32 v180, v180, v183
    v_dot2c_f32_bf16 v181, v145, v145
    v_lshlrev_b32 v182, 16, v145
    v_and_b32 v183, 0xffff0000, v145
    v_add_f32 v180, v180, v182
    v_add_f32 v180, v180, v183
    v_dot2c_f32_bf16 v181, v146, v146
    v_lshlrev_b32 v182, 16, v146
    v_and_b32 v183, 0xffff0000, v146
    v_add_f32 v180, v180, v182
    v_add_f32 v180, v180, v183
    v_dot2c_f32_bf16 v181, v147, v147
    v_lshlrev_b32 v182, 16, v147
    v_and_b32 v183, 0xffff0000, v147
    v_add_f32 v180, v180, v182
    v_add_f32 v180, v180, v183
    v_cvt_pk_bf16_f32 v182, v52, v53
    v_lshlrev_b32 v140, 16, v182
    v_and_b32 v141, 0xffff0000, v182
    v_cvt_pk_bf16_f32 v182, v54, v55
    v_lshlrev_b32 v142, 16, v182
    v_and_b32 v143, 0xffff0000, v182
    v_cvt_pk_bf16_f32 v182, v56, v57
    v_lshlrev_b32 v144, 16, v182
    v_and_b32 v145, 0xffff0000, v182
    v_cvt_pk_bf16_f32 v182, v58, v59
    v_lshlrev_b32 v146, 16, v182
    v_and_b32 v147, 0xffff0000, v182
    v_cvt_pk_bf16_f32 v182, v60, v61
    v_lshlrev_b32 v148, 16, v182
    v_and_b32 v149, 0xffff0000, v182
    v_cvt_pk_bf16_f32 v182, v62, v63
    v_lshlrev_b32 v150, 16, v182
    v_and_b32 v151, 0xffff0000, v182
    v_cvt_pk_bf16_f32 v182, v64, v65
    v_lshlrev_b32 v152, 16, v182
    v_and_b32 v153, 0xffff0000, v182
    v_cvt_pk_bf16_f32 v182, v66, v67
    v_lshlrev_b32 v154, 16, v182
    v_and_b32 v155, 0xffff0000, v182
    v_pk_mul_f32 v[156:157], v[140:141], v[140:141]
    v_pk_fma_f32 v[156:157], v[156:157], v[188:189], v[190:191]
    v_pk_mul_f32 v[156:157], v[156:157], v[140:141]
    v_pk_mul_f32 v[158:159], v[142:143], v[142:143]
    v_pk_fma_f32 v[158:159], v[158:159], v[188:189], v[190:191]
    v_pk_mul_f32 v[158:159], v[158:159], v[142:143]
    v_pk_mul_f32 v[160:161], v[144:145], v[144:145]
    v_pk_fma_f32 v[160:161], v[160:161], v[188:189], v[190:191]
    v_pk_mul_f32 v[160:161], v[160:161], v[144:145]
    v_pk_mul_f32 v[162:163], v[146:147], v[146:147]
    v_pk_fma_f32 v[162:163], v[162:163], v[188:189], v[190:191]
    v_pk_mul_f32 v[162:163], v[162:163], v[146:147]
    v_pk_mul_f32 v[164:165], v[148:149], v[148:149]
    v_pk_fma_f32 v[164:165], v[164:165], v[188:189], v[190:191]
    v_pk_mul_f32 v[164:165], v[164:165], v[148:149]
    v_pk_mul_f32 v[166:167], v[150:151], v[150:151]
    v_pk_fma_f32 v[166:167], v[166:167], v[188:189], v[190:191]
    v_pk_mul_f32 v[166:167], v[166:167], v[150:151]
    v_pk_mul_f32 v[168:169], v[152:153], v[152:153]
    v_pk_fma_f32 v[168:169], v[168:169], v[188:189], v[190:191]
    v_pk_mul_f32 v[168:169], v[168:169], v[152:153]
    v_pk_mul_f32 v[170:171], v[154:155], v[154:155]
    v_pk_fma_f32 v[170:171], v[170:171], v[188:189], v[190:191]
    v_pk_mul_f32 v[170:171], v[170:171], v[154:155]
    v_exp_f32 v156, v156
    v_exp_f32 v157, v157
    v_exp_f32 v158, v158
    v_exp_f32 v159, v159
    v_exp_f32 v160, v160
    v_exp_f32 v161, v161
    v_exp_f32 v162, v162
    v_exp_f32 v163, v163
    v_exp_f32 v164, v164
    v_exp_f32 v165, v165
    v_exp_f32 v166, v166
    v_exp_f32 v167, v167
    v_exp_f32 v168, v168
    v_exp_f32 v169, v169
    v_exp_f32 v170, v170
    v_exp_f32 v171, v171
    s_nop 0
    v_pk_add_f32 v[156:157], v[156:157], v[192:193]
    v_pk_add_f32 v[158:159], v[158:159], v[192:193]
    v_pk_add_f32 v[160:161], v[160:161], v[192:193]
    v_pk_add_f32 v[162:163], v[162:163], v[192:193]
    v_pk_add_f32 v[164:165], v[164:165], v[192:193]
    v_pk_add_f32 v[166:167], v[166:167], v[192:193]
    v_pk_add_f32 v[168:169], v[168:169], v[192:193]
    v_pk_add_f32 v[170:171], v[170:171], v[192:193]
    v_rcp_f32 v156, v156
    v_rcp_f32 v157, v157
    v_rcp_f32 v158, v158
    v_rcp_f32 v159, v159
    v_rcp_f32 v160, v160
    v_rcp_f32 v161, v161
    v_rcp_f32 v162, v162
    v_rcp_f32 v163, v163
    v_rcp_f32 v164, v164
    v_rcp_f32 v165, v165
    v_rcp_f32 v166, v166
    v_rcp_f32 v167, v167
    v_rcp_f32 v168, v168
    v_rcp_f32 v169, v169
    v_rcp_f32 v170, v170
    v_rcp_f32 v171, v171
    s_nop 0
    v_pk_mul_f32 v[156:157], v[156:157], v[140:141]
    v_pk_mul_f32 v[158:159], v[158:159], v[142:143]
    v_pk_mul_f32 v[160:161], v[160:161], v[144:145]
    v_pk_mul_f32 v[162:163], v[162:163], v[146:147]
    v_pk_mul_f32 v[164:165], v[164:165], v[148:149]
    v_pk_mul_f32 v[166:167], v[166:167], v[150:151]
    v_pk_mul_f32 v[168:169], v[168:169], v[152:153]
    v_pk_mul_f32 v[170:171], v[170:171], v[154:155]
    v_cvt_pk_bf16_f32 v140, v156, v157
    v_cvt_pk_bf16_f32 v141, v158, v159
    v_cvt_pk_bf16_f32 v142, v160, v161
    v_cvt_pk_bf16_f32 v143, v162, v163
    v_cvt_pk_bf16_f32 v144, v164, v165
    v_cvt_pk_bf16_f32 v145, v166, v167
    v_cvt_pk_bf16_f32 v146, v168, v169
    v_cvt_pk_bf16_f32 v147, v170, v171
    ds_write_b64 v4, v[140:141] offset:128
    ds_write_b64 v4, v[142:143] offset:144
    ds_write_b64 v4, v[144:145] offset:160
    ds_write_b64 v4, v[146:147] offset:176
    v_dot2c_f32_bf16 v181, v140, v140
    v_lshlrev_b32 v182, 16, v140
    v_and_b32 v183, 0xffff0000, v140
    v_add_f32 v180, v180, v182
    v_add_f32 v180, v180, v183
    v_dot2c_f32_bf16 v181, v141, v141
    v_lshlrev_b32 v182, 16, v141
    v_and_b32 v183, 0xffff0000, v141
    v_add_f32 v180, v180, v182
    v_add_f32 v180, v180, v183
    v_dot2c_f32_bf16 v181, v142, v142
    v_lshlrev_b32 v182, 16, v142
    v_and_b32 v183, 0xffff0000, v142
    v_add_f32 v180, v180, v182
    v_add_f32 v180, v180, v183
    v_dot2c_f32_bf16 v181, v143, v143
    v_lshlrev_b32 v182, 16, v143
    v_and_b32 v183, 0xffff0000, v143
    v_add_f32 v180, v180, v182
    v_add_f32 v180, v180, v183
    v_dot2c_f32_bf16 v181, v144, v144
    v_lshlrev_b32 v182, 16, v144
    v_and_b32 v183, 0xffff0000, v144
    v_add_f32 v180, v180, v182
    v_add_f32 v180, v180, v183
    v_dot2c_f32_bf16 v181, v145, v145
    v_lshlrev_b32 v182, 16, v145
    v_and_b32 v183, 0xffff0000, v145
    v_add_f32 v180, v180, v182
    v_add_f32 v180, v180, v183
    v_dot2c_f32_bf16 v181, v146, v146
    v_lshlrev_b32 v182, 16, v146
    v_and_b32 v183, 0xffff0000, v146
    v_add_f32 v180, v180, v182
    v_add_f32 v180, v180, v183
    v_dot2c_f32_bf16 v181, v147, v147
    v_lshlrev_b32 v182, 16, v147
    v_and_b32 v183, 0xffff0000, v147
    v_add_f32 v180, v180, v182
    v_add_f32 v180, v180, v183
    s_cmp_ge_u32 s23, 4
    s_cbranch_scc1 k1zs_30
    v_cvt_pk_bf16_f32 v182, v68, v69
    v_lshlrev_b32 v140, 16, v182
    v_and_b32 v141, 0xffff0000, v182
    v_cvt_pk_bf16_f32 v182, v70, v71
    v_lshlrev_b32 v142, 16, v182
    v_and_b32 v143, 0xffff0000, v182
    v_cvt_pk_bf16_f32 v182, v72, v73
    v_lshlrev_b32 v144, 16, v182
    v_and_b32 v145, 0xffff0000, v182
    v_cvt_pk_bf16_f32 v182, v74, v75
    v_lshlrev_b32 v146, 16, v182
    v_and_b32 v147, 0xffff0000, v182
    v_cvt_pk_bf16_f32 v182, v76, v77
    v_lshlrev_b32 v148, 16, v182
    v_and_b32 v149, 0xffff0000, v182
    v_cvt_pk_bf16_f32 v182, v78, v79
    v_lshlrev_b32 v150, 16, v182
    v_and_b32 v151, 0xffff0000, v182
    v_cvt_pk_bf16_f32 v182, v80, v81
    v_lshlrev_b32 v152, 16, v182
    v_and_b32 v153, 0xffff0000, v182
    v_cvt_pk_bf16_f32 v182, v82, v83
    v_lshlrev_b32 v154, 16, v182
    v_and_b32 v155, 0xffff0000, v182
    v_pk_mul_f32 v[156:157], v[140:141], v[140:141]
    v_pk_fma_f32 v[156:157], v[156:157], v[188:189], v[190:191]
    v_pk_mul_f32 v[156:157], v[156:157], v[140:141]
    v_pk_mul_f32 v[158:159], v[142:143], v[142:143]
    v_pk_fma_f32 v[158:159], v[158:159], v[188:189], v[190:191]
    v_pk_mul_f32 v[158:159], v[158:159], v[142:143]
    v_pk_mul_f32 v[160:161], v[144:145], v[144:145]
    v_pk_fma_f32 v[160:161], v[160:161], v[188:189], v[190:191]
    v_pk_mul_f32 v[160:161], v[160:161], v[144:145]
    v_pk_mul_f32 v[162:163], v[146:147], v[146:147]
    v_pk_fma_f32 v[162:163], v[162:163], v[188:189], v[190:191]
    v_pk_mul_f32 v[162:163], v[162:163], v[146:147]
    v_pk_mul_f32 v[164:165], v[148:149], v[148:149]
    v_pk_fma_f32 v[164:165], v[164:165], v[188:189], v[190:191]
    v_pk_mul_f32 v[164:165], v[164:165], v[148:149]
    v_pk_mul_f32 v[166:167], v[150:151], v[150:151]
    v_pk_fma_f32 v[166:167], v[166:167], v[188:189], v[190:191]
    v_pk_mul_f32 v[166:167], v[166:167], v[150:151]
    v_pk_mul_f32 v[168:169], v[152:153], v[152:153]
    v_pk_fma_f32 v[168:169], v[168:169], v[188:189], v[190:191]
    v_pk_mul_f32 v[168:169], v[168:169], v[152:153]
    v_pk_mul_f32 v[170:171], v[154:155], v[154:155]
    v_pk_fma_f32 v[170:171], v[170:171], v[188:189], v[190:191]
    v_pk_mul_f32 v[170:171], v[170:171], v[154:155]
    v_exp_f32 v156, v156
    v_exp_f32 v157, v157
    v_exp_f32 v158, v158
    v_exp_f32 v159, v159
    v_exp_f32 v160, v160
    v_exp_f32 v161, v161
    v_exp_f32 v162, v162
    v_exp_f32 v163, v163
    v_exp_f32 v164, v164
    v_exp_f32 v165, v165
    v_exp_f32 v166, v166
    v_exp_f32 v167, v167
    v_exp_f32 v168, v168
    v_exp_f32 v169, v169
    v_exp_f32 v170, v170
    v_exp_f32 v171, v171
    s_nop 0
    v_pk_add_f32 v[156:157], v[156:157], v[192:193]
    v_pk_add_f32 v[158:159], v[158:159], v[192:193]
    v_pk_add_f32 v[160:161], v[160:161], v[192:193]
    v_pk_add_f32 v[162:163], v[162:163], v[192:193]
    v_pk_add_f32 v[164:165], v[164:165], v[192:193]
    v_pk_add_f32 v[166:167], v[166:167], v[192:193]
    v_pk_add_f32 v[168:169], v[168:169], v[192:193]
    v_pk_add_f32 v[170:171], v[170:171], v[192:193]
    v_rcp_f32 v156, v156
    v_rcp_f32 v157, v157
    v_rcp_f32 v158, v158
    v_rcp_f32 v159, v159
    v_rcp_f32 v160, v160
    v_rcp_f32 v161, v161
    v_rcp_f32 v162, v162
    v_rcp_f32 v163, v163
    v_rcp_f32 v164, v164
    v_rcp_f32 v165, v165
    v_rcp_f32 v166, v166
    v_rcp_f32 v167, v167
    v_rcp_f32 v168, v168
    v_rcp_f32 v169, v169
    v_rcp_f32 v170, v170
    v_rcp_f32 v171, v171
    s_nop 0
    v_pk_mul_f32 v[156:157], v[156:157], v[140:141]
    v_pk_mul_f32 v[158:159], v[158:159], v[142:143]
    v_pk_mul_f32 v[160:161], v[160:161], v[144:145]
    v_pk_mul_f32 v[162:163], v[162:163], v[146:147]
    v_pk_mul_f32 v[164:165], v[164:165], v[148:149]
    v_pk_mul_f32 v[166:167], v[166:167], v[150:151]
    v_pk_mul_f32 v[168:169], v[168:169], v[152:153]
    v_pk_mul_f32 v[170:171], v[170:171], v[154:155]
    v_cvt_pk_bf16_f32 v140, v156, v157
    v_cvt_pk_bf16_f32 v141, v158, v159
    v_cvt_pk_bf16_f32 v142, v160, v161
    v_cvt_pk_bf16_f32 v143, v162, v163
    v_cvt_pk_bf16_f32 v144, v164, v165
    v_cvt_pk_bf16_f32 v145, v166, v167
    v_cvt_pk_bf16_f32 v146, v168, v169
    v_cvt_pk_bf16_f32 v147, v170, v171
    ds_write_b64 v4, v[140:141] offset:192
    ds_write_b64 v4, v[142:143] offset:208
    ds_write_b64 v4, v[144:145] offset:224
    ds_write_b64 v4, v[146:147] offset:240
    v_dot2c_f32_bf16 v181, v140, v140
    v_lshlrev_b32 v182, 16, v140
    v_and_b32 v183, 0xffff0000, v140
    v_add_f32 v180, v180, v182
    v_add_f32 v180, v180, v183
    v_dot2c_f32_bf16 v181, v141, v141
    v_lshlrev_b32 v182, 16, v141
    v_and_b32 v183, 0xffff0000, v141
    v_add_f32 v180, v180, v182
    v_add_f32 v180, v180, v183
    v_dot2c_f32_bf16 v181, v142, v142
    v_lshlrev_b32 v182, 16, v142
    v_and_b32 v183, 0xffff0000, v142
    v_add_f32 v180, v180, v182
    v_add_f32 v180, v180, v183
    v_dot2c_f32_bf16 v181, v143, v143
    v_lshlrev_b32 v182, 16, v143
    v_and_b32 v183, 0xffff0000, v143
    v_add_f32 v180, v180, v182
    v_add_f32 v180, v180, v183
    v_dot2c_f32_bf16 v181, v144, v144
    v_lshlrev_b32 v182, 16, v144
    v_and_b32 v183, 0xffff0000, v144
    v_add_f32 v180, v180, v182
    v_add_f32 v180, v180, v183
    v_dot2c_f32_bf16 v181, v145, v145
    v_lshlrev_b32 v182, 16, v145
    v_and_b32 v183, 0xffff0000, v145
    v_add_f32 v180, v180, v182
    v_add_f32 v180, v180, v183
    v_dot2c_f32_bf16 v181, v146, v146
    v_lshlrev_b32 v182, 16, v146
    v_and_b32 v183, 0xffff0000, v146
    v_add_f32 v180, v180, v182
    v_add_f32 v180, v180, v183
    v_dot2c_f32_bf16 v181, v147, v147
    v_lshlrev_b32 v182, 16, v147
    v_and_b32 v183, 0xffff0000, v147
    v_add_f32 v180, v180, v182
    v_add_f32 v180, v180, v183
k1zs_30:
    v_lshrrev_b32 v7, 4, v1
    v_and_b32 v8, 15, v1
    v_mul_u32_u24 v5, 272, v7
    v_lshl_add_u32 v5, v8, 4, v5
    v_add_u32 v5, s49, v5
    v_mul_u32_u24 v6, 1792, v7
    v_lshl_add_u32 v6, v8, 4, v6
    s_cmp_ge_u32 s23, 4
    s_cselect_b32 s52, 12, 16
    v_cmp_gt_u32 vcc, s52, v8
    s_waitcnt lgkmcnt(0)
    ds_read_b128 v[20:23], v5 offset:0
    ds_read_b128 v[24:27], v5 offset:1088
    ds_read_b128 v[28:31], v5 offset:2176
    ds_read_b128 v[32:35], v5 offset:3264
    ds_read_b128 v[36:39], v5 offset:4352
    ds_read_b128 v[40:43], v5 offset:5440
    ds_read_b128 v[44:47], v5 offset:6528
    ds_read_b128 v[48:51], v5 offset:7616
    s_and_saveexec_b64 s[50:51], vcc
    s_waitcnt lgkmcnt(7)
    buffer_store_dwordx4 v[20:23], v6, s[16:19], s45 offen sc1
    s_add_u32 s45, s45, 7168
    s_waitcnt lgkmcnt(6)
    buffer_store_dwordx4 v[24:27], v6, s[16:19], s45 offen sc1
    s_add_u32 s45, s45, 7168
    s_waitcnt lgkmcnt(5)
    buffer_store_dwordx4 v[28:31], v6, s[16:19], s45 offen sc1
    s_add_u32 s45, s45, 7168
    s_waitcnt lgkmcnt(4)
    buffer_store_dwordx4 v[32:35], v6, s[16:19], s45 offen sc1
    s_add_u32 s45, s45, 7168
    s_waitcnt lgkmcnt(3)
    buffer_store_dwordx4 v[36:39], v6, s[16:19], s45 offen sc1
    s_add_u32 s45, s45, 7168
    s_waitcnt lgkmcnt(2)
    buffer_store_dwordx4 v[40:43], v6, s[16:19], s45 offen sc1
    s_add_u32 s45, s45, 7168
    s_waitcnt lgkmcnt(1)
    buffer_store_dwordx4 v[44:47], v6, s[16:19], s45 offen sc1
    s_add_u32 s45, s45, 7168
    s_waitcnt lgkmcnt(0)
    buffer_store_dwordx4 v[48:51], v6, s[16:19], s45 offen sc1
    s_add_u32 s45, s45, 7168
    s_mov_b64 exec, -1
    s_cmp_lt_u32 s41, 4
    s_cbranch_scc1 k1_end
    v_mov_b32 v182, v180
    v_mov_b32 v183, v180
    s_nop 1
    v_permlane32_swap_b32 v182, v183
    s_nop 1
    v_add_f32 v180, v182, v183
    v_mov_b32 v182, v181
    v_mov_b32 v183, v181
    s_nop 1
    v_permlane32_swap_b32 v182, v183
    s_nop 1
    v_add_f32 v181, v182, v183
    v_and_b32 v182, 31, v1
    v_lshlrev_b32 v182, 3, v182
    s_and_b32 s47, s23, 3
    s_lshl_b32 s47, s47, 8
    s_add_u32 s47, s47, 81920
    v_add_u32 v182, s47, v182
    v_mov_b32 v196, v180
    v_mov_b32 v197, v181
    s_cmp_lt_u32 s23, 4
    s_cbranch_scc1 k1st_31
    ds_write_b64 v182, v[196:197]
    s_waitcnt lgkmcnt(0)
k1st_31:
    s_barrier
    s_cmp_ge_u32 s23, 4
    s_cbranch_scc1 k1_end
    ds_read_b64 v[196:197], v182
    s_waitcnt lgkmcnt(0)
    v_add_f32 v180, v180, v196
    v_add_f32 v181, v181, v197
    s_mov_b64 exec, 0xffffffff
    buffer_store_dword v180, v9, s[16:19], s46 offen sc1
    s_add_u32 s46, s46, 8192
    buffer_store_dword v181, v9, s[16:19], s46 offen sc1
k1_end:
    s_mov_b64 exec, -1
k1_end_x:
    s_endpgm
.p2align 8
.globl k2_mix_kernel
.type k2_mix_kernel,@function
k2_mix_kernel:
    s_cmp_ge_u32 s2, 240
    s_cbranch_scc1 k2_end_x
    s_load_dwordx4 s[24:27], s[0:1], 48
    s_load_dwordx2 s[32:33], s[0:1], 88
    s_load_dwordx2 s[54:55], s[0:1], 24
    s_load_dwordx2 s[56:57], s[0:1], 64
    v_and_b32 v1, 63, v0
    v_lshrrev_b32 v2, 6, v0
    s_nop 0
    v_readfirstlane_b32 s23, v2
    s_and_b32 s20, s2, 7
    s_lshl_b32 s20, s20, 1
    s_lshr_b32 s21, s2, 3
    s_and_b32 s34, s21, 1
    s_add_u32 s20, s20, s34
    s_lshr_b32 s21, s2, 4
    v_lshrrev_b32 v2, 3, v0
    v_and_b32 v3, 7, v0
    v_lshlrev_b32 v3, 4, v3
    v_mul_u32_u24 v12, 1792, v2
    v_add_u32 v12, v12, v3
    s_lshl_b32 s34, s21, 7
    s_add_u32 s34, s34, 13897728
    v_add_u32 v12, s34, v12
    v_mul_u32_u24 v13, 192, v2
    v_add_u32 v13, v13, v3
    v_add_u32 v13, 16384, v13
    v_lshlrev_b32 v14, 3, v2
    s_lshl_b32 s34, s20, 19
    s_lshl_b32 s35, s23, 16
    s_add_u32 s34, s34, s35
    v_lshrrev_b32 v4, 3, v1
    v_lshrrev_b32 v5, 4, v1
    v_and_b32 v6, 7, v1
    v_add_u32 v7, 0, v5
    v_and_b32 v7, 7, v7
    v_xor_b32 v7, v7, v6
    v_add_u32 v8, 0, v4
    v_lshlrev_b32 v15, 12, v8
    v_lshl_add_u32 v15, v7, 4, v15
    v_add_u32 v15, s34, v15
    v_add_u32 v7, 4, v5
    v_and_b32 v7, 7, v7
    v_xor_b32 v7, v7, v6
    v_add_u32 v8, 8, v4
    v_lshlrev_b32 v16, 12, v8
    v_lshl_add_u32 v16, v7, 4, v16
    v_add_u32 v16, s34, v16
    s_lshl_b32 s35, s23, 11
    s_add_u32 s35, s35, 53248
    v_lshlrev_b32 v4, 4, v0
    s_waitcnt lgkmcnt(0)
    s_mov_b32 s4, s24
    s_and_b32 s5, s25, 0xffff
    s_mov_b32 s6, 8388608
    s_mov_b32 s7, 0x00020000
    s_mov_b32 s8, s26
    s_and_b32 s9, s27, 0xffff
    s_mov_b32 s10, 4096
    s_mov_b32 s11, 0x00020000
    s_mov_b32 s16, s32
    s_and_b32 s17, s33, 0xffff
    s_mov_b32 s18, 268435456
    s_mov_b32 s19, 0x00020000
    s_cmp_ge_u32 s2, 224
    s_cbranch_scc1 k2_kv
    s_mov_b32 s38, 21237760
    buffer_load_dwordx4 v[40:43], v4, s[16:19], s38 offen
    s_mov_b32 s38, 21245952
    buffer_load_dwordx4 v[44:47], v4, s[16:19], s38 offen
    s_mov_b32 s38, 21254144
    buffer_load_dwordx4 v[48:51], v4, s[16:19], s38 offen
    s_mov_b32 s38, 21262336
    buffer_load_dwordx4 v[52:55], v4, s[16:19], s38 offen
    s_mov_b32 s38, 21270528
    buffer_load_dwordx4 v[56:59], v4, s[16:19], s38 offen
    s_mov_b32 s38, 21278720
    buffer_load_dwordx4 v[60:63], v4, s[16:19], s38 offen
    s_mov_b32 s38, 21286912
    buffer_load_dwordx4 v[64:67], v4, s[16:19], s38 offen
    s_mov_b32 s38, 21295104
    buffer_load_dwordx4 v[68:71], v4, s[16:19], s38 offen
    s_mov_b32 s36, 0
    s_mov_b32 s37, 0
    buffer_load_dwordx4 v[20:23], v12, s[16:19], s36 offen
    s_add_u32 m0, s35, 0
    s_nop 0
    buffer_load_dwordx4 v15, s[4:7], s37 offen lds
    s_add_u32 m0, s35, 1024
    s_nop 0
    buffer_load_dwordx4 v16, s[4:7], s37 offen lds
    s_mov_b32 s36, 114688
    s_mov_b32 s37, 128
    buffer_load_dwordx4 v[24:27], v12, s[16:19], s36 offen
    s_add_u32 m0, s35, 16384
    s_nop 0
    buffer_load_dwordx4 v15, s[4:7], s37 offen lds
    s_add_u32 m0, s35, 17408
    s_nop 0
    buffer_load_dwordx4 v16, s[4:7], s37 offen lds
    s_mov_b32 s36, 229376
    s_mov_b32 s37, 256
    buffer_load_dwordx4 v[28:31], v12, s[16:19], s36 offen
    s_add_u32 m0, s35, 32768
    s_nop 0
    buffer_load_dwordx4 v15, s[4:7], s37 offen lds
    s_add_u32 m0, s35, 33792
    s_nop 0
    buffer_load_dwordx4 v16, s[4:7], s37 offen lds
    s_mov_b32 s36, 344064
    s_mov_b32 s37, 384
    buffer_load_dwordx4 v[32:35], v12, s[16:19], s36 offen
    s_add_u32 m0, s35, 49152
    s_nop 0
    buffer_load_dwordx4 v15, s[4:7], s37 offen lds
    s_add_u32 m0, s35, 50176
    s_nop 0
    buffer_load_dwordx4 v16, s[4:7], s37 offen lds
    v_bfe_u32 v5, v1, 4, 1
    v_lshrrev_b32 v6, 5, v1
    v_bfe_u32 v7, v1, 2, 2
    v_and_b32 v8, 3, v1
    v_lshl_add_u32 v7, v6, 3, v7
    v_mul_u32_u24 v17, 192, v7
    v_lshl_add_u32 v8, v5, 2, v8
    v_lshl_add_u32 v17, v8, 3, v17
    s_lshr_b32 s40, s23, 1
    s_mul_i32 s41, s40, 3072
    s_add_u32 s41, s41, 16384
    v_add_u32 v17, s41, v17
    v_and_b32 v5, 31, v1
    v_lshrrev_b32 v6, 5, v1
    s_lshl_b32 s41, s40, 1
    v_add_u32 v6, s41, v6
    v_bfe_u32 v7, v5, 1, 3
    v_xor_b32 v6, v6, v7
    v_lshlrev_b32 v18, 7, v5
    v_lshl_add_u32 v18, v6, 4, v18
    s_and_b32 s41, s23, 1
    s_lshl_b32 s41, s41, 13
    s_add_u32 s41, s41, 53248
    v_add_u32 v18, s41, v18
    s_waitcnt vmcnt(12)
    v_add_f32 v137, v40, v48
    v_add_f32 v136, v44, v52
    v_add_f32 v137, v137, v56
    v_add_f32 v136, v136, v60
    v_add_f32 v137, v137, v64
    v_add_f32 v136, v136, v68
    v_mul_f32 v137, 982665509, v137
    v_mul_f32 v136, 982665509, v136
    v_fma_f32 v136, -v137, v137, v136
    v_max_f32 v136, 0, v136
    v_cvt_pk_bf16_f32 v137, v137, v137
    v_lshlrev_b32 v137, 16, v137
    v_cvt_pk_bf16_f32 v136, v136, v136
    v_lshlrev_b32 v136, 16, v136
    v_add_f32 v136, 925353388, v136
    v_cvt_pk_bf16_f32 v136, v136, v136
    v_lshlrev_b32 v136, 16, v136
    v_sqrt_f32 v136, v136
    s_nop 0
    v_cvt_pk_bf16_f32 v136, v136, v136
    v_lshlrev_b32 v136, 16, v136
    v_rcp_f32 v136, v136
    s_nop 0
    v_mul_f32 v137, v137, v136
    v_add_f32 v139, v41, v49
    v_add_f32 v138, v45, v53
    v_add_f32 v139, v139, v57
    v_add_f32 v138, v138, v61
    v_add_f32 v139, v139, v65
    v_add_f32 v138, v138, v69
    v_mul_f32 v139, 982665509, v139
    v_mul_f32 v138, 982665509, v138
    v_fma_f32 v138, -v139, v139, v138
    v_max_f32 v138, 0, v138
    v_cvt_pk_bf16_f32 v139, v139, v139
    v_lshlrev_b32 v139, 16, v139
    v_cvt_pk_bf16_f32 v138, v138, v138
    v_lshlrev_b32 v138, 16, v138
    v_add_f32 v138, 925353388, v138
    v_cvt_pk_bf16_f32 v138, v138, v138
    v_lshlrev_b32 v138, 16, v138
    v_sqrt_f32 v138, v138
    s_nop 0
    v_cvt_pk_bf16_f32 v138, v138, v138
    v_lshlrev_b32 v138, 16, v138
    v_rcp_f32 v138, v138
    s_nop 0
    v_mul_f32 v139, v139, v138
    v_add_f32 v141, v42, v50
    v_add_f32 v140, v46, v54
    v_add_f32 v141, v141, v58
    v_add_f32 v140, v140, v62
    v_add_f32 v141, v141, v66
    v_add_f32 v140, v140, v70
    v_mul_f32 v141, 982665509, v141
    v_mul_f32 v140, 982665509, v140
    v_fma_f32 v140, -v141, v141, v140
    v_max_f32 v140, 0, v140
    v_cvt_pk_bf16_f32 v141, v141, v141
    v_lshlrev_b32 v141, 16, v141
    v_cvt_pk_bf16_f32 v140, v140, v140
    v_lshlrev_b32 v140, 16, v140
    v_add_f32 v140, 925353388, v140
    v_cvt_pk_bf16_f32 v140, v140, v140
    v_lshlrev_b32 v140, 16, v140
    v_sqrt_f32 v140, v140
    s_nop 0
    v_cvt_pk_bf16_f32 v140, v140, v140
    v_lshlrev_b32 v140, 16, v140
    v_rcp_f32 v140, v140
    s_nop 0
    v_mul_f32 v141, v141, v140
    v_add_f32 v143, v43, v51
    v_add_f32 v142, v47, v55
    v_add_f32 v143, v143, v59
    v_add_f32 v142, v142, v63
    v_add_f32 v143, v143, v67
    v_add_f32 v142, v142, v71
    v_mul_f32 v143, 982665509, v143
    v_mul_f32 v142, 982665509, v142
    v_fma_f32 v142, -v143, v143, v142
    v_max_f32 v142, 0, v142
    v_cvt_pk_bf16_f32 v143, v143, v143
    v_lshlrev_b32 v143, 16, v143
    v_cvt_pk_bf16_f32 v142, v142, v142
    v_lshlrev_b32 v142, 16, v142
    v_add_f32 v142, 925353388, v142
    v_cvt_pk_bf16_f32 v142, v142, v142
    v_lshlrev_b32 v142, 16, v142
    v_sqrt_f32 v142, v142
    s_nop 0
    v_cvt_pk_bf16_f32 v142, v142, v142
    v_lshlrev_b32 v142, 16, v142
    v_rcp_f32 v142, v142
    s_nop 0
    v_mul_f32 v143, v143, v142
    v_lshlrev_b32 v5, 5, v0
    ds_write_b128 v5, v[136:139]
    ds_write_b128 v5, v[140:143] offset:16
    v_mov_b32 v40, 0
    v_mov_b32 v41, 0
    v_mov_b32 v42, 0
    v_mov_b32 v43, 0
    v_mov_b32 v44, 0
    v_mov_b32 v45, 0
    v_mov_b32 v46, 0
    v_mov_b32 v47, 0
    v_mov_b32 v48, 0
    v_mov_b32 v49, 0
    v_mov_b32 v50, 0
    v_mov_b32 v51, 0
    v_mov_b32 v52, 0
    v_mov_b32 v53, 0
    v_mov_b32 v54, 0
    v_mov_b32 v55, 0
    v_mov_b32 v56, 0
    v_mov_b32 v57, 0
    v_mov_b32 v58, 0
    v_mov_b32 v59, 0
    v_mov_b32 v60, 0
    v_mov_b32 v61, 0
    v_mov_b32 v62, 0
    v_mov_b32 v63, 0
    v_mov_b32 v64, 0
    v_mov_b32 v65, 0
    v_mov_b32 v66, 0
    v_mov_b32 v67, 0
    v_mov_b32 v68, 0
    v_mov_b32 v69, 0
    v_mov_b32 v70, 0
    v_mov_b32 v71, 0
    v_mov_b32 v72, 0
    v_mov_b32 v73, 0
    v_mov_b32 v74, 0
    v_mov_b32 v75, 0
    v_mov_b32 v76, 0
    v_mov_b32 v77, 0
    v_mov_b32 v78, 0
    v_mov_b32 v79, 0
    v_mov_b32 v80, 0
    v_mov_b32 v81, 0
    v_mov_b32 v82, 0
    v_mov_b32 v83, 0
    v_mov_b32 v84, 0
    v_mov_b32 v85, 0
    v_mov_b32 v86, 0
    v_mov_b32 v87, 0
    v_mov_b32 v88, 0
    v_mov_b32 v89, 0
    v_mov_b32 v90, 0
    v_mov_b32 v91, 0
    v_mov_b32 v92, 0
    v_mov_b32 v93, 0
    v_mov_b32 v94, 0
    v_mov_b32 v95, 0
    v_mov_b32 v96, 0
    v_mov_b32 v97, 0
    v_mov_b32 v98, 0
    v_mov_b32 v99, 0
    v_mov_b32 v100, 0
    v_mov_b32 v101, 0
    v_mov_b32 v102, 0
    v_mov_b32 v103, 0
    s_waitcnt lgkmcnt(0)
    s_barrier
    ds_read_b64 v[36:37], v14 offset:0
    ds_read_b64 v[38:39], v14 offset:512
    s_waitcnt vmcnt(6) lgkmcnt(0)
    v_lshlrev_b32 v7, 16, v20
    v_and_b32 v8, 0xffff0000, v20
    v_fma_f32 v7, v7, v36, -v37
    v_fma_f32 v8, v8, v36, -v37
    v_cvt_pk_bf16_f32 v20, v7, v8
    v_lshlrev_b32 v7, 16, v21
    v_and_b32 v8, 0xffff0000, v21
    v_fma_f32 v7, v7, v36, -v37
    v_fma_f32 v8, v8, v36, -v37
    v_cvt_pk_bf16_f32 v21, v7, v8
    v_lshlrev_b32 v7, 16, v22
    v_and_b32 v8, 0xffff0000, v22
    v_fma_f32 v7, v7, v36, -v37
    v_fma_f32 v8, v8, v36, -v37
    v_cvt_pk_bf16_f32 v22, v7, v8
    v_lshlrev_b32 v7, 16, v23
    v_and_b32 v8, 0xffff0000, v23
    v_fma_f32 v7, v7, v36, -v37
    v_fma_f32 v8, v8, v36, -v37
    v_cvt_pk_bf16_f32 v23, v7, v8
    ds_write_b128 v13, v[20:23] offset:0
    v_lshlrev_b32 v7, 16, v24
    v_and_b32 v8, 0xffff0000, v24
    v_fma_f32 v7, v7, v38, -v39
    v_fma_f32 v8, v8, v38, -v39
    v_cvt_pk_bf16_f32 v24, v7, v8
    v_lshlrev_b32 v7, 16, v25
    v_and_b32 v8, 0xffff0000, v25
    v_fma_f32 v7, v7, v38, -v39
    v_fma_f32 v8, v8, v38, -v39
    v_cvt_pk_bf16_f32 v25, v7, v8
    v_lshlrev_b32 v7, 16, v26
    v_and_b32 v8, 0xffff0000, v26
    v_fma_f32 v7, v7, v38, -v39
    v_fma_f32 v8, v8, v38, -v39
    v_cvt_pk_bf16_f32 v26, v7, v8
    v_lshlrev_b32 v7, 16, v27
    v_and_b32 v8, 0xffff0000, v27
    v_fma_f32 v7, v7, v38, -v39
    v_fma_f32 v8, v8, v38, -v39
    v_cvt_pk_bf16_f32 v27, v7, v8
    ds_write_b128 v13, v[24:27] offset:12288
    ds_read_b64 v[36:37], v14 offset:1024
    s_waitcnt lgkmcnt(0)
    s_barrier
    ds_read_b64_tr_b16 v[104:105], v17 offset:0
    ds_read_b64_tr_b16 v[106:107], v17 offset:768
    ds_read_b64_tr_b16 v[108:109], v17 offset:64
    ds_read_b64_tr_b16 v[110:111], v17 offset:832
    ds_read_b128 v[112:115], v18 offset:0
    ds_read_b128 v[116:119], v18 offset:4096
    s_mov_b32 s36, 458752
    s_mov_b32 s37, 512
    buffer_load_dwordx4 v[20:23], v12, s[16:19], s36 offen
    s_add_u32 m0, s35, 0
    s_nop 0
    buffer_load_dwordx4 v15, s[4:7], s37 offen lds
    s_add_u32 m0, s35, 1024
    s_nop 0
    buffer_load_dwordx4 v16, s[4:7], s37 offen lds
    s_waitcnt lgkmcnt(0)
    ds_read_b64_tr_b16 v[120:121], v17 offset:12288
    ds_read_b64_tr_b16 v[122:123], v17 offset:13056
    ds_read_b64_tr_b16 v[124:125], v17 offset:12352
    ds_read_b64_tr_b16 v[126:127], v17 offset:13120
    ds_read_b128 v[128:131], v18 offset:16384
    ds_read_b128 v[132:135], v18 offset:20480
    v_mfma_f32_32x32x16_bf16 v[40:55], v[104:107], v[112:115], v[40:55]
    s_waitcnt vmcnt(6)
    v_lshlrev_b32 v7, 16, v28
    v_and_b32 v8, 0xffff0000, v28
    v_fma_f32 v7, v7, v36, -v37
    v_fma_f32 v8, v8, v36, -v37
    v_cvt_pk_bf16_f32 v28, v7, v8
    v_lshlrev_b32 v7, 16, v29
    v_and_b32 v8, 0xffff0000, v29
    v_fma_f32 v7, v7, v36, -v37
    v_fma_f32 v8, v8, v36, -v37
    v_cvt_pk_bf16_f32 v29, v7, v8
    v_mfma_f32_32x32x16_bf16 v[56:71], v[104:107], v[116:119], v[56:71]
    v_lshlrev_b32 v7, 16, v30
    v_and_b32 v8, 0xffff0000, v30
    v_fma_f32 v7, v7, v36, -v37
    v_fma_f32 v8, v8, v36, -v37
    v_cvt_pk_bf16_f32 v30, v7, v8
    v_lshlrev_b32 v7, 16, v31
    v_and_b32 v8, 0xffff0000, v31
    v_fma_f32 v7, v7, v36, -v37
    v_fma_f32 v8, v8, v36, -v37
    v_cvt_pk_bf16_f32 v31, v7, v8
    v_mfma_f32_32x32x16_bf16 v[72:87], v[108:111], v[112:115], v[72:87]
    ds_write_b128 v13, v[28:31] offset:24576
    ds_read_b64 v[38:39], v14 offset:1536
    v_mfma_f32_32x32x16_bf16 v[88:103], v[108:111], v[116:119], v[88:103]
    s_waitcnt lgkmcnt(0)
    s_barrier
    s_mov_b32 s36, 573440
    s_mov_b32 s37, 640
    buffer_load_dwordx4 v[24:27], v12, s[16:19], s36 offen
    s_add_u32 m0, s35, 16384
    s_nop 0
    buffer_load_dwordx4 v15, s[4:7], s37 offen lds
    s_add_u32 m0, s35, 17408
    s_nop 0
    buffer_load_dwordx4 v16, s[4:7], s37 offen lds
    s_waitcnt lgkmcnt(0)
    ds_read_b64_tr_b16 v[104:105], v17 offset:24576
    ds_read_b64_tr_b16 v[106:107], v17 offset:25344
    ds_read_b64_tr_b16 v[108:109], v17 offset:24640
    ds_read_b64_tr_b16 v[110:111], v17 offset:25408
    ds_read_b128 v[112:115], v18 offset:32768
    ds_read_b128 v[116:119], v18 offset:36864
    v_mfma_f32_32x32x16_bf16 v[40:55], v[120:123], v[128:131], v[40:55]
    s_waitcnt vmcnt(6)
    v_lshlrev_b32 v7, 16, v32
    v_and_b32 v8, 0xffff0000, v32
    v_fma_f32 v7, v7, v38, -v39
    v_fma_f32 v8, v8, v38, -v39
    v_cvt_pk_bf16_f32 v32, v7, v8
    v_lshlrev_b32 v7, 16, v33
    v_and_b32 v8, 0xffff0000, v33
    v_fma_f32 v7, v7, v38, -v39
    v_fma_f32 v8, v8, v38, -v39
    v_cvt_pk_bf16_f32 v33, v7, v8
    v_mfma_f32_32x32x16_bf16 v[56:71], v[120:123], v[132:135], v[56:71]
    v_lshlrev_b32 v7, 16, v34
    v_and_b32 v8, 0xffff0000, v34
    v_fma_f32 v7, v7, v38, -v39
    v_fma_f32 v8, v8, v38, -v39
    v_cvt_pk_bf16_f32 v34, v7, v8
    v_lshlrev_b32 v7, 16, v35
    v_and_b32 v8, 0xffff0000, v35
    v_fma_f32 v7, v7, v38, -v39
    v_fma_f32 v8, v8, v38, -v39
    v_cvt_pk_bf16_f32 v35, v7, v8
    v_mfma_f32_32x32x16_bf16 v[72:87], v[124:127], v[128:131], v[72:87]
    ds_write_b128 v13, v[32:35] offset:0
    ds_read_b64 v[36:37], v14 offset:2048
    v_mfma_f32_32x32x16_bf16 v[88:103], v[124:127], v[132:135], v[88:103]
    s_waitcnt lgkmcnt(0)
    s_barrier
    s_mov_b32 s36, 688128
    s_mov_b32 s37, 768
    buffer_load_dwordx4 v[28:31], v12, s[16:19], s36 offen
    s_add_u32 m0, s35, 32768
    s_nop 0
    buffer_load_dwordx4 v15, s[4:7], s37 offen lds
    s_add_u32 m0, s35, 33792
    s_nop 0
    buffer_load_dwordx4 v16, s[4:7], s37 offen lds
    s_waitcnt lgkmcnt(0)
    ds_read_b64_tr_b16 v[120:121], v17 offset:0
    ds_read_b64_tr_b16 v[122:123], v17 offset:768
    ds_read_b64_tr_b16 v[124:125], v17 offset:64
    ds_read_b64_tr_b16 v[126:127], v17 offset:832
    ds_read_b128 v[128:131], v18 offset:49152
    ds_read_b128 v[132:135], v18 offset:53248
    v_mfma_f32_32x32x16_bf16 v[40:55], v[104:107], v[112:115], v[40:55]
    s_waitcnt vmcnt(6)
    v_lshlrev_b32 v7, 16, v20
    v_and_b32 v8, 0xffff0000, v20
    v_fma_f32 v7, v7, v36, -v37
    v_fma_f32 v8, v8, v36, -v37
    v_cvt_pk_bf16_f32 v20, v7, v8
    v_lshlrev_b32 v7, 16, v21
    v_and_b32 v8, 0xffff0000, v21
    v_fma_f32 v7, v7, v36, -v37
    v_fma_f32 v8, v8, v36, -v37
    v_cvt_pk_bf16_f32 v21, v7, v8
    v_mfma_f32_32x32x16_bf16 v[56:71], v[104:107], v[116:119], v[56:71]
    v_lshlrev_b32 v7, 16, v22
    v_and_b32 v8, 0xffff0000, v22
    v_fma_f32 v7, v7, v36, -v37
    v_fma_f32 v8, v8, v36, -v37
    v_cvt_pk_bf16_f32 v22, v7, v8
    v_lshlrev_b32 v7, 16, v23
    v_and_b32 v8, 0xffff0000, v23
    v_fma_f32 v7, v7, v36, -v37
    v_fma_f32 v8, v8, v36, -v37
    v_cvt_pk_bf16_f32 v23, v7, v8
    v_mfma_f32_32x32x16_bf16 v[72:87], v[108:111], v[112:115], v[72:87]
    ds_write_b128 v13, v[20:23] offset:12288
    ds_read_b64 v[38:39], v14 offset:2560
    v_mfma_f32_32x32x16_bf16 v[88:103], v[108:111], v[116:119], v[88:103]
    s_waitcnt lgkmcnt(0)
    s_barrier
    s_mov_b32 s36, 802816
    s_mov_b32 s37, 896
    buffer_load_dwordx4 v[32:35], v12, s[16:19], s36 offen
    s_add_u32 m0, s35, 49152
    s_nop 0
    buffer_load_dwordx4 v15, s[4:7], s37 offen lds
    s_add_u32 m0, s35, 50176
    s_nop 0
    buffer_load_dwordx4 v16, s[4:7], s37 offen lds
    s_waitcnt lgkmcnt(0)
    ds_read_b64_tr_b16 v[104:105], v17 offset:12288
    ds_read_b64_tr_b16 v[106:107], v17 offset:13056
    ds_read_b64_tr_b16 v[108:109], v17 offset:12352
    ds_read_b64_tr_b16 v[110:111], v17 offset:13120
    ds_read_b128 v[112:115], v18 offset:0
    ds_read_b128 v[116:119], v18 offset:4096
    v_mfma_f32_32x32x16_bf16 v[40:55], v[120:123], v[128:131], v[40:55]
    s_waitcnt vmcnt(6)
    v_lshlrev_b32 v7, 16, v24
    v_and_b32 v8, 0xffff0000, v24
    v_fma_f32 v7, v7, v38, -v39
    v_fma_f32 v8, v8, v38, -v39
    v_cvt_pk_bf16_f32 v24, v7, v8
    v_lshlrev_b32 v7, 16, v25
    v_and_b32 v8, 0xffff0000, v25
    v_fma_f32 v7, v7, v38, -v39
    v_fma_f32 v8, v8, v38, -v39
    v_cvt_pk_bf16_f32 v25, v7, v8
    v_mfma_f32_32x32x16_bf16 v[56:71], v[120:123], v[132:135], v[56:71]
    v_lshlrev_b32 v7, 16, v26
    v_and_b32 v8, 0xffff0000, v26
    v_fma_f32 v7, v7, v38, -v39
    v_fma_f32 v8, v8, v38, -v39
    v_cvt_pk_bf16_f32 v26, v7, v8
    v_lshlrev_b32 v7, 16, v27
    v_and_b32 v8, 0xffff0000, v27
    v_fma_f32 v7, v7, v38, -v39
    v_fma_f32 v8, v8, v38, -v39
    v_cvt_pk_bf16_f32 v27, v7, v8
    v_mfma_f32_32x32x16_bf16 v[72:87], v[124:127], v[128:131], v[72:87]
    ds_write_b128 v13, v[24:27] offset:24576
    ds_read_b64 v[36:37], v14 offset:3072
    v_mfma_f32_32x32x16_bf16 v[88:103], v[124:127], v[132:135], v[88:103]
    s_waitcnt lgkmcnt(0)
    s_barrier
    s_mov_b32 s36, 917504
    s_mov_b32 s37, 1024
    buffer_load_dwordx4 v[20:23], v12, s[16:19], s36 offen
    s_add_u32 m0, s35, 0
    s_nop 0
    buffer_load_dwordx4 v15, s[4:7], s37 offen lds
    s_add_u32 m0, s35, 1024
    s_nop 0
    buffer_load_dwordx4 v16, s[4:7], s37 offen lds
    s_waitcnt lgkmcnt(0)
    ds_read_b64_tr_b16 v[120:121], v17 offset:24576
    ds_read_b64_tr_b16 v[122:123], v17 offset:25344
    ds_read_b64_tr_b16 v[124:125], v17 offset:24640
    ds_read_b64_tr_b16 v[126:127], v17 offset:25408
    ds_read_b128 v[128:131], v18 offset:16384
    ds_read_b128 v[132:135], v18 offset:20480
    v_mfma_f32_32x32x16_bf16 v[40:55], v[104:107], v[112:115], v[40:55]
    s_waitcnt vmcnt(6)
    v_lshlrev_b32 v7, 16, v28
    v_and_b32 v8, 0xffff0000, v28
    v_fma_f32 v7, v7, v36, -v37
    v_fma_f32 v8, v8, v36, -v37
    v_cvt_pk_bf16_f32 v28, v7, v8
    v_lshlrev_b32 v7, 16, v29
    v_and_b32 v8, 0xffff0000, v29
    v_fma_f32 v7, v7, v36, -v37
    v_fma_f32 v8, v8, v36, -v37
    v_cvt_pk_bf16_f32 v29, v7, v8
    v_mfma_f32_32x32x16_bf16 v[56:71], v[104:107], v[116:119], v[56:71]
    v_lshlrev_b32 v7, 16, v30
    v_and_b32 v8, 0xffff0000, v30
    v_fma_f32 v7, v7, v36, -v37
    v_fma_f32 v8, v8, v36, -v37
    v_cvt_pk_bf16_f32 v30, v7, v8
    v_lshlrev_b32 v7, 16, v31
    v_and_b32 v8, 0xffff0000, v31
    v_fma_f32 v7, v7, v36, -v37
    v_fma_f32 v8, v8, v36, -v37
    v_cvt_pk_bf16_f32 v31, v7, v8
    v_mfma_f32_32x32x16_bf16 v[72:87], v[108:111], v[112:115], v[72:87]
    ds_write_b128 v13, v[28:31] offset:0
    ds_read_b64 v[38:39], v14 offset:3584
    v_mfma_f32_32x32x16_bf16 v[88:103], v[108:111], v[116:119], v[88:103]
    s_waitcnt lgkmcnt(0)
    s_barrier
    s_mov_b32 s36, 1032192
    s_mov_b32 s37, 1152
    buffer_load_dwordx4 v[24:27], v12, s[16:19], s36 offen
    s_add_u32 m0, s35, 16384
    s_nop 0
    buffer_load_dwordx4 v15, s[4:7], s37 offen lds
    s_add_u32 m0, s35, 17408
    s_nop 0
    buffer_load_dwordx4 v16, s[4:7], s37 offen lds
    s_waitcnt lgkmcnt(0)
    ds_read_b64_tr_b16 v[104:105], v17 offset:0
    ds_read_b64_tr_b16 v[106:107], v17 offset:768
    ds_read_b64_tr_b16 v[108:109], v17 offset:64
    ds_read_b64_tr_b16 v[110:111], v17 offset:832
    ds_read_b128 v[112:115], v18 offset:32768
    ds_read_b128 v[116:119], v18 offset:36864
    v_mfma_f32_32x32x16_bf16 v[40:55], v[120:123], v[128:131], v[40:55]
    s_waitcnt vmcnt(6)
    v_lshlrev_b32 v7, 16, v32
    v_and_b32 v8, 0xffff0000, v32
    v_fma_f32 v7, v7, v38, -v39
    v_fma_f32 v8, v8, v38, -v39
    v_cvt_pk_bf16_f32 v32, v7, v8
    v_lshlrev_b32 v7, 16, v33
    v_and_b32 v8, 0xffff0000, v33
    v_fma_f32 v7, v7, v38, -v39
    v_fma_f32 v8, v8, v38, -v39
    v_cvt_pk_bf16_f32 v33, v7, v8
    v_mfma_f32_32x32x16_bf16 v[56:71], v[120:123], v[132:135], v[56:71]
    v_lshlrev_b32 v7, 16, v34
    v_and_b32 v8, 0xffff0000, v34
    v_fma_f32 v7, v7, v38, -v39
    v_fma_f32 v8, v8, v38, -v39
    v_cvt_pk_bf16_f32 v34, v7, v8
    v_lshlrev_b32 v7, 16, v35
    v_and_b32 v8, 0xffff0000, v35
    v_fma_f32 v7, v7, v38, -v39
    v_fma_f32 v8, v8, v38, -v39
    v_cvt_pk_bf16_f32 v35, v7, v8
    v_mfma_f32_32x32x16_bf16 v[72:87], v[124:127], v[128:131], v[72:87]
    ds_write_b128 v13, v[32:35] offset:12288
    ds_read_b64 v[36:37], v14 offset:4096
    v_mfma_f32_32x32x16_bf16 v[88:103], v[124:127], v[132:135], v[88:103]
    s_waitcnt lgkmcnt(0)
    s_barrier
    s_mov_b32 s36, 1146880
    s_mov_b32 s37, 1280
    buffer_load_dwordx4 v[28:31], v12, s[16:19], s36 offen
    s_add_u32 m0, s35, 32768
    s_nop 0
    buffer_load_dwordx4 v15, s[4:7], s37 offen lds
    s_add_u32 m0, s35, 33792
    s_nop 0
    buffer_load_dwordx4 v16, s[4:7], s37 offen lds
    s_waitcnt lgkmcnt(0)
    ds_read_b64_tr_b16 v[120:121], v17 offset:12288
    ds_read_b64_tr_b16 v[122:123], v17 offset:13056
    ds_read_b64_tr_b16 v[124:125], v17 offset:12352
    ds_read_b64_tr_b16 v[126:127], v17 offset:13120
    ds_read_b128 v[128:131], v18 offset:49152
    ds_read_b128 v[132:135], v18 offset:53248
    v_mfma_f32_32x32x16_bf16 v[40:55], v[104:107], v[112:115], v[40:55]
    s_waitcnt vmcnt(6)
    v_lshlrev_b32 v7, 16, v20
    v_and_b32 v8, 0xffff0000, v20
    v_fma_f32 v7, v7, v36, -v37
    v_fma_f32 v8, v8, v36, -v37
    v_cvt_pk_bf16_f32 v20, v7, v8
    v_lshlrev_b32 v7, 16, v21
    v_and_b32 v8, 0xffff0000, v21
    v_fma_f32 v7, v7, v36, -v37
    v_fma_f32 v8, v8, v36, -v37
    v_cvt_pk_bf16_f32 v21, v7, v8
    v_mfma_f32_32x32x16_bf16 v[56:71], v[104:107], v[116:119], v[56:71]
    v_lshlrev_b32 v7, 16, v22
    v_and_b32 v8, 0xffff0000, v22
    v_fma_f32 v7, v7, v36, -v37
    v_fma_f32 v8, v8, v36, -v37
    v_cvt_pk_bf16_f32 v22, v7, v8
    v_lshlrev_b32 v7, 16, v23
    v_and_b32 v8, 0xffff0000, v23
    v_fma_f32 v7, v7, v36, -v37
    v_fma_f32 v8, v8, v36, -v37
    v_cvt_pk_bf16_f32 v23, v7, v8
    v_mfma_f32_32x32x16_bf16 v[72:87], v[108:111], v[112:115], v[72:87]
    ds_write_b128 v13, v[20:23] offset:24576
    ds_read_b64 v[38:39], v14 offset:4608
    v_mfma_f32_32x32x16_bf16 v[88:103], v[108:111], v[116:119], v[88:103]
    s_waitcnt lgkmcnt(0)
    s_barrier
    s_mov_b32 s36, 1261568
    s_mov_b32 s37, 1408
    buffer_load_dwordx4 v[32:35], v12, s[16:19], s36 offen
    s_add_u32 m0, s35, 49152
    s_nop 0
    buffer_load_dwordx4 v15, s[4:7], s37 offen lds
    s_add_u32 m0, s35, 50176
    s_nop 0
    buffer_load_dwordx4 v16, s[4:7], s37 offen lds
    s_waitcnt lgkmcnt(0)
    ds_read_b64_tr_b16 v[104:105], v17 offset:24576
    ds_read_b64_tr_b16 v[106:107], v17 offset:25344
    ds_read_b64_tr_b16 v[108:109], v17 offset:24640
    ds_read_b64_tr_b16 v[110:111], v17 offset:25408
    ds_read_b128 v[112:115], v18 offset:0
    ds_read_b128 v[116:119], v18 offset:4096
    v_mfma_f32_32x32x16_bf16 v[40:55], v[120:123], v[128:131], v[40:55]
    s_waitcnt vmcnt(6)
    v_lshlrev_b32 v7, 16, v24
    v_and_b32 v8, 0xffff0000, v24
    v_fma_f32 v7, v7, v38, -v39
    v_fma_f32 v8, v8, v38, -v39
    v_cvt_pk_bf16_f32 v24, v7, v8
    v_lshlrev_b32 v7, 16, v25
    v_and_b32 v8, 0xffff0000, v25
    v_fma_f32 v7, v7, v38, -v39
    v_fma_f32 v8, v8, v38, -v39
    v_cvt_pk_bf16_f32 v25, v7, v8
    v_mfma_f32_32x32x16_bf16 v[56:71], v[120:123], v[132:135], v[56:71]
    v_lshlrev_b32 v7, 16, v26
    v_and_b32 v8, 0xffff0000, v26
    v_fma_f32 v7, v7, v38, -v39
    v_fma_f32 v8, v8, v38, -v39
    v_cvt_pk_bf16_f32 v26, v7, v8
    v_lshlrev_b32 v7, 16, v27
    v_and_b32 v8, 0xffff0000, v27
    v_fma_f32 v7, v7, v38, -v39
    v_fma_f32 v8, v8, v38, -v39
    v_cvt_pk_bf16_f32 v27, v7, v8
    v_mfma_f32_32x32x16_bf16 v[72:87], v[124:127], v[128:131], v[72:87]
    ds_write_b128 v13, v[24:27] offset:0
    ds_read_b64 v[36:37], v14 offset:5120
    v_mfma_f32_32x32x16_bf16 v[88:103], v[124:127], v[132:135], v[88:103]
    s_waitcnt lgkmcnt(0)
    s_barrier
    s_mov_b32 s36, 1376256
    s_mov_b32 s37, 1536
    buffer_load_dwordx4 v[20:23], v12, s[16:19], s36 offen
    s_add_u32 m0, s35, 0
    s_nop 0
    buffer_load_dwordx4 v15, s[4:7], s37 offen lds
    s_add_u32 m0, s35, 1024
    s_nop 0
    buffer_load_dwordx4 v16, s[4:7], s37 offen lds
    s_waitcnt lgkmcnt(0)
    ds_read_b64_tr_b16 v[120:121], v17 offset:0
    ds_read_b64_tr_b16 v[122:123], v17 offset:768
    ds_read_b64_tr_b16 v[124:125], v17 offset:64
    ds_read_b64_tr_b16 v[126:127], v17 offset:832
    ds_read_b128 v[128:131], v18 offset:16384
    ds_read_b128 v[132:135], v18 offset:20480
    v_mfma_f32_32x32x16_bf16 v[40:55], v[104:107], v[112:115], v[40:55]
    s_waitcnt vmcnt(6)
    v_lshlrev_b32 v7, 16, v28
    v_and_b32 v8, 0xffff0000, v28
    v_fma_f32 v7, v7, v36, -v37
    v_fma_f32 v8, v8, v36, -v37
    v_cvt_pk_bf16_f32 v28, v7, v8
    v_lshlrev_b32 v7, 16, v29
    v_and_b32 v8, 0xffff0000, v29
    v_fma_f32 v7, v7, v36, -v37
    v_fma_f32 v8, v8, v36, -v37
    v_cvt_pk_bf16_f32 v29, v7, v8
    v_mfma_f32_32x32x16_bf16 v[56:71], v[104:107], v[116:119], v[56:71]
    v_lshlrev_b32 v7, 16, v30
    v_and_b32 v8, 0xffff0000, v30
    v_fma_f32 v7, v7, v36, -v37
    v_fma_f32 v8, v8, v36, -v37
    v_cvt_pk_bf16_f32 v30, v7, v8
    v_lshlrev_b32 v7, 16, v31
    v_and_b32 v8, 0xffff0000, v31
    v_fma_f32 v7, v7, v36, -v37
    v_fma_f32 v8, v8, v36, -v37
    v_cvt_pk_bf16_f32 v31, v7, v8
    v_mfma_f32_32x32x16_bf16 v[72:87], v[108:111], v[112:115], v[72:87]
    ds_write_b128 v13, v[28:31] offset:12288
    ds_read_b64 v[38:39], v14 offset:5632
    v_mfma_f32_32x32x16_bf16 v[88:103], v[108:111], v[116:119], v[88:103]
    s_waitcnt lgkmcnt(0)
    s_barrier
    s_mov_b32 s36, 1490944
    s_mov_b32 s37, 1664
    buffer_load_dwordx4 v[24:27], v12, s[16:19], s36 offen
    s_add_u32 m0, s35, 16384
    s_nop 0
    buffer_load_dwordx4 v15, s[4:7], s37 offen lds
    s_add_u32 m0, s35, 17408
    s_nop 0
    buffer_load_dwordx4 v16, s[4:7], s37 offen lds
    s_waitcnt lgkmcnt(0)
    ds_read_b64_tr_b16 v[104:105], v17 offset:12288
    ds_read_b64_tr_b16 v[106:107], v17 offset:13056
    ds_read_b64_tr_b16 v[108:109], v17 offset:12352
    ds_read_b64_tr_b16 v[110:111], v17 offset:13120
    ds_read_b128 v[112:115], v18 offset:32768
    ds_read_b128 v[116:119], v18 offset:36864
    v_mfma_f32_32x32x16_bf16 v[40:55], v[120:123], v[128:131], v[40:55]
    s_waitcnt vmcnt(6)
    v_lshlrev_b32 v7, 16, v32
    v_and_b32 v8, 0xffff0000, v32
    v_fma_f32 v7, v7, v38, -v39
    v_fma_f32 v8, v8, v38, -v39
    v_cvt_pk_bf16_f32 v32, v7, v8
    v_lshlrev_b32 v7, 16, v33
    v_and_b32 v8, 0xffff0000, v33
    v_fma_f32 v7, v7, v38, -v39
    v_fma_f32 v8, v8, v38, -v39
    v_cvt_pk_bf16_f32 v33, v7, v8
    v_mfma_f32_32x32x16_bf16 v[56:71], v[120:123], v[132:135], v[56:71]
    v_lshlrev_b32 v7, 16, v34
    v_and_b32 v8, 0xffff0000, v34
    v_fma_f32 v7, v7, v38, -v39
    v_fma_f32 v8, v8, v38, -v39
    v_cvt_pk_bf16_f32 v34, v7, v8
    v_lshlrev_b32 v7, 16, v35
    v_and_b32 v8, 0xffff0000, v35
    v_fma_f32 v7, v7, v38, -v39
    v_fma_f32 v8, v8, v38, -v39
    v_cvt_pk_bf16_f32 v35, v7, v8
    v_mfma_f32_32x32x16_bf16 v[72:87], v[124:127], v[128:131], v[72:87]
    ds_write_b128 v13, v[32:35] offset:24576
    ds_read_b64 v[36:37], v14 offset:6144
    v_mfma_f32_32x32x16_bf16 v[88:103], v[124:127], v[132:135], v[88:103]
    s_waitcnt lgkmcnt(0)
    s_barrier
    s_mov_b32 s36, 1605632
    s_mov_b32 s37, 1792
    buffer_load_dwordx4 v[28:31], v12, s[16:19], s36 offen
    s_add_u32 m0, s35, 32768
    s_nop 0
    buffer_load_dwordx4 v15, s[4:7], s37 offen lds
    s_add_u32 m0, s35, 33792
    s_nop 0
    buffer_load_dwordx4 v16, s[4:7], s37 offen lds
    s_waitcnt lgkmcnt(0)
    ds_read_b64_tr_b16 v[120:121], v17 offset:24576
    ds_read_b64_tr_b16 v[122:123], v17 offset:25344
    ds_read_b64_tr_b16 v[124:125], v17 offset:24640
    ds_read_b64_tr_b16 v[126:127], v17 offset:25408
    ds_read_b128 v[128:131], v18 offset:49152
    ds_read_b128 v[132:135], v18 offset:53248
    v_mfma_f32_32x32x16_bf16 v[40:55], v[104:107], v[112:115], v[40:55]
    s_waitcnt vmcnt(6)
    v_lshlrev_b32 v7, 16, v20
    v_and_b32 v8, 0xffff0000, v20
    v_fma_f32 v7, v7, v36, -v37
    v_fma_f32 v8, v8, v36, -v37
    v_cvt_pk_bf16_f32 v20, v7, v8
    v_lshlrev_b32 v7, 16, v21
    v_and_b32 v8, 0xffff0000, v21
    v_fma_f32 v7, v7, v36, -v37
    v_fma_f32 v8, v8, v36, -v37
    v_cvt_pk_bf16_f32 v21, v7, v8
    v_mfma_f32_32x32x16_bf16 v[56:71], v[104:107], v[116:119], v[56:71]
    v_lshlrev_b32 v7, 16, v22
    v_and_b32 v8, 0xffff0000, v22
    v_fma_f32 v7, v7, v36, -v37
    v_fma_f32 v8, v8, v36, -v37
    v_cvt_pk_bf16_f32 v22, v7, v8
    v_lshlrev_b32 v7, 16, v23
    v_and_b32 v8, 0xffff0000, v23
    v_fma_f32 v7, v7, v36, -v37
    v_fma_f32 v8, v8, v36, -v37
    v_cvt_pk_bf16_f32 v23, v7, v8
    v_mfma_f32_32x32x16_bf16 v[72:87], v[108:111], v[112:115], v[72:87]
    ds_write_b128 v13, v[20:23] offset:0
    ds_read_b64 v[38:39], v14 offset:6656
    v_mfma_f32_32x32x16_bf16 v[88:103], v[108:111], v[116:119], v[88:103]
    s_waitcnt lgkmcnt(0)
    s_barrier
    s_mov_b32 s36, 1720320
    s_mov_b32 s37, 1920
    buffer_load_dwordx4 v[32:35], v12, s[16:19], s36 offen
    s_add_u32 m0, s35, 49152
    s_nop 0
    buffer_load_dwordx4 v15, s[4:7], s37 offen lds
    s_add_u32 m0, s35, 50176
    s_nop 0
    buffer_load_dwordx4 v16, s[4:7], s37 offen lds
    s_waitcnt lgkmcnt(0)
    ds_read_b64_tr_b16 v[104:105], v17 offset:0
    ds_read_b64_tr_b16 v[106:107], v17 offset:768
    ds_read_b64_tr_b16 v[108:109], v17 offset:64
    ds_read_b64_tr_b16 v[110:111], v17 offset:832
    ds_read_b128 v[112:115], v18 offset:0
    ds_read_b128 v[116:119], v18 offset:4096
    v_mfma_f32_32x32x16_bf16 v[40:55], v[120:123], v[128:131], v[40:55]
    s_waitcnt vmcnt(6)
    v_lshlrev_b32 v7, 16, v24
    v_and_b32 v8, 0xffff0000, v24
    v_fma_f32 v7, v7, v38, -v39
    v_fma_f32 v8, v8, v38, -v39
    v_cvt_pk_bf16_f32 v24, v7, v8
    v_lshlrev_b32 v7, 16, v25
    v_and_b32 v8, 0xffff0000, v25
    v_fma_f32 v7, v7, v38, -v39
    v_fma_f32 v8, v8, v38, -v39
    v_cvt_pk_bf16_f32 v25, v7, v8
    v_mfma_f32_32x32x16_bf16 v[56:71], v[120:123], v[132:135], v[56:71]
    v_lshlrev_b32 v7, 16, v26
    v_and_b32 v8, 0xffff0000, v26
    v_fma_f32 v7, v7, v38, -v39
    v_fma_f32 v8, v8, v38, -v39
    v_cvt_pk_bf16_f32 v26, v7, v8
    v_lshlrev_b32 v7, 16, v27
    v_and_b32 v8, 0xffff0000, v27
    v_fma_f32 v7, v7, v38, -v39
    v_fma_f32 v8, v8, v38, -v39
    v_cvt_pk_bf16_f32 v27, v7, v8
    v_mfma_f32_32x32x16_bf16 v[72:87], v[124:127], v[128:131], v[72:87]
    ds_write_b128 v13, v[24:27] offset:12288
    ds_read_b64 v[36:37], v14 offset:7168
    v_mfma_f32_32x32x16_bf16 v[88:103], v[124:127], v[132:135], v[88:103]
    s_waitcnt lgkmcnt(0)
    s_barrier
    s_mov_b32 s36, 1835008
    s_mov_b32 s37, 2048
    buffer_load_dwordx4 v[20:23], v12, s[16:19], s36 offen
    s_add_u32 m0, s35, 0
    s_nop 0
    buffer_load_dwordx4 v15, s[4:7], s37 offen lds
    s_add_u32 m0, s35, 1024
    s_nop 0
    buffer_load_dwordx4 v16, s[4:7], s37 offen lds
    s_waitcnt lgkmcnt(0)
    ds_read_b64_tr_b16 v[120:121], v17 offset:12288
    ds_read_b64_tr_b16 v[122:123], v17 offset:13056
    ds_read_b64_tr_b16 v[124:125], v17 offset:12352
    ds_read_b64_tr_b16 v[126:127], v17 offset:13120
    ds_read_b128 v[128:131], v18 offset:16384
    ds_read_b128 v[132:135], v18 offset:20480
    v_mfma_f32_32x32x16_bf16 v[40:55], v[104:107], v[112:115], v[40:55]
    s_waitcnt vmcnt(6)
    v_lshlrev_b32 v7, 16, v28
    v_and_b32 v8, 0xffff0000, v28
    v_fma_f32 v7, v7, v36, -v37
    v_fma_f32 v8, v8, v36, -v37
    v_cvt_pk_bf16_f32 v28, v7, v8
    v_lshlrev_b32 v7, 16, v29
    v_and_b32 v8, 0xffff0000, v29
    v_fma_f32 v7, v7, v36, -v37
    v_fma_f32 v8, v8, v36, -v37
    v_cvt_pk_bf16_f32 v29, v7, v8
    v_mfma_f32_32x32x16_bf16 v[56:71], v[104:107], v[116:119], v[56:71]
    v_lshlrev_b32 v7, 16, v30
    v_and_b32 v8, 0xffff0000, v30
    v_fma_f32 v7, v7, v36, -v37
    v_fma_f32 v8, v8, v36, -v37
    v_cvt_pk_bf16_f32 v30, v7, v8
    v_lshlrev_b32 v7, 16, v31
    v_and_b32 v8, 0xffff0000, v31
    v_fma_f32 v7, v7, v36, -v37
    v_fma_f32 v8, v8, v36, -v37
    v_cvt_pk_bf16_f32 v31, v7, v8
    v_mfma_f32_32x32x16_bf16 v[72:87], v[108:111], v[112:115], v[72:87]
    ds_write_b128 v13, v[28:31] offset:24576
    ds_read_b64 v[38:39], v14 offset:7680
    v_mfma_f32_32x32x16_bf16 v[88:103], v[108:111], v[116:119], v[88:103]
    s_waitcnt lgkmcnt(0)
    s_barrier
    s_mov_b32 s36, 1949696
    s_mov_b32 s37, 2176
    buffer_load_dwordx4 v[24:27], v12, s[16:19], s36 offen
    s_add_u32 m0, s35, 16384
    s_nop 0
    buffer_load_dwordx4 v15, s[4:7], s37 offen lds
    s_add_u32 m0, s35, 17408
    s_nop 0
    buffer_load_dwordx4 v16, s[4:7], s37 offen lds
    s_waitcnt lgkmcnt(0)
    ds_read_b64_tr_b16 v[104:105], v17 offset:24576
    ds_read_b64_tr_b16 v[106:107], v17 offset:25344
    ds_read_b64_tr_b16 v[108:109], v17 offset:24640
    ds_read_b64_tr_b16 v[110:111], v17 offset:25408
    ds_read_b128 v[112:115], v18 offset:32768
    ds_read_b128 v[116:119], v18 offset:36864
    v_mfma_f32_32x32x16_bf16 v[40:55], v[120:123], v[128:131], v[40:55]
    s_waitcnt vmcnt(6)
    v_lshlrev_b32 v7, 16, v32
    v_and_b32 v8, 0xffff0000, v32
    v_fma_f32 v7, v7, v38, -v39
    v_fma_f32 v8, v8, v38, -v39
    v_cvt_pk_bf16_f32 v32, v7, v8
    v_lshlrev_b32 v7, 16, v33
    v_and_b32 v8, 0xffff0000, v33
    v_fma_f32 v7, v7, v38, -v39
    v_fma_f32 v8, v8, v38, -v39
    v_cvt_pk_bf16_f32 v33, v7, v8
    v_mfma_f32_32x32x16_bf16 v[56:71], v[120:123], v[132:135], v[56:71]
    v_lshlrev_b32 v7, 16, v34
    v_and_b32 v8, 0xffff0000, v34
    v_fma_f32 v7, v7, v38, -v39
    v_fma_f32 v8, v8, v38, -v39
    v_cvt_pk_bf16_f32 v34, v7, v8
    v_lshlrev_b32 v7, 16, v35
    v_and_b32 v8, 0xffff0000, v35
    v_fma_f32 v7, v7, v38, -v39
    v_fma_f32 v8, v8, v38, -v39
    v_cvt_pk_bf16_f32 v35, v7, v8
    v_mfma_f32_32x32x16_bf16 v[72:87], v[124:127], v[128:131], v[72:87]
    ds_write_b128 v13, v[32:35] offset:0
    ds_read_b64 v[36:37], v14 offset:8192
    v_mfma_f32_32x32x16_bf16 v[88:103], v[124:127], v[132:135], v[88:103]
    s_waitcnt lgkmcnt(0)
    s_barrier
    s_mov_b32 s36, 2064384
    s_mov_b32 s37, 2304
    buffer_load_dwordx4 v[28:31], v12, s[16:19], s36 offen
    s_add_u32 m0, s35, 32768
    s_nop 0
    buffer_load_dwordx4 v15, s[4:7], s37 offen lds
    s_add_u32 m0, s35, 33792
    s_nop 0
    buffer_load_dwordx4 v16, s[4:7], s37 offen lds
    s_waitcnt lgkmcnt(0)
    ds_read_b64_tr_b16 v[120:121], v17 offset:0
    ds_read_b64_tr_b16 v[122:123], v17 offset:768
    ds_read_b64_tr_b16 v[124:125], v17 offset:64
    ds_read_b64_tr_b16 v[126:127], v17 offset:832
    ds_read_b128 v[128:131], v18 offset:49152
    ds_read_b128 v[132:135], v18 offset:53248
    v_mfma_f32_32x32x16_bf16 v[40:55], v[104:107], v[112:115], v[40:55]
    s_waitcnt vmcnt(6)
    v_lshlrev_b32 v7, 16, v20
    v_and_b32 v8, 0xffff0000, v20
    v_fma_f32 v7, v7, v36, -v37
    v_fma_f32 v8, v8, v36, -v37
    v_cvt_pk_bf16_f32 v20, v7, v8
    v_lshlrev_b32 v7, 16, v21
    v_and_b32 v8, 0xffff0000, v21
    v_fma_f32 v7, v7, v36, -v37
    v_fma_f32 v8, v8, v36, -v37
    v_cvt_pk_bf16_f32 v21, v7, v8
    v_mfma_f32_32x32x16_bf16 v[56:71], v[104:107], v[116:119], v[56:71]
    v_lshlrev_b32 v7, 16, v22
    v_and_b32 v8, 0xffff0000, v22
    v_fma_f32 v7, v7, v36, -v37
    v_fma_f32 v8, v8, v36, -v37
    v_cvt_pk_bf16_f32 v22, v7, v8
    v_lshlrev_b32 v7, 16, v23
    v_and_b32 v8, 0xffff0000, v23
    v_fma_f32 v7, v7, v36, -v37
    v_fma_f32 v8, v8, v36, -v37
    v_cvt_pk_bf16_f32 v23, v7, v8
    v_mfma_f32_32x32x16_bf16 v[72:87], v[108:111], v[112:115], v[72:87]
    ds_write_b128 v13, v[20:23] offset:12288
    ds_read_b64 v[38:39], v14 offset:8704
    v_mfma_f32_32x32x16_bf16 v[88:103], v[108:111], v[116:119], v[88:103]
    s_waitcnt lgkmcnt(0)
    s_barrier
    s_mov_b32 s36, 2179072
    s_mov_b32 s37, 2432
    buffer_load_dwordx4 v[32:35], v12, s[16:19], s36 offen
    s_add_u32 m0, s35, 49152
    s_nop 0
    buffer_load_dwordx4 v15, s[4:7], s37 offen lds
    s_add_u32 m0, s35, 50176
    s_nop 0
    buffer_load_dwordx4 v16, s[4:7], s37 offen lds
    s_waitcnt lgkmcnt(0)
    ds_read_b64_tr_b16 v[104:105], v17 offset:12288
    ds_read_b64_tr_b16 v[106:107], v17 offset:13056
    ds_read_b64_tr_b16 v[108:109], v17 offset:12352
    ds_read_b64_tr_b16 v[110:111], v17 offset:13120
    ds_read_b128 v[112:115], v18 offset:0
    ds_read_b128 v[116:119], v18 offset:4096
    v_mfma_f32_32x32x16_bf16 v[40:55], v[120:123], v[128:131], v[40:55]
    s_waitcnt vmcnt(6)
    v_lshlrev_b32 v7, 16, v24
    v_and_b32 v8, 0xffff0000, v24
    v_fma_f32 v7, v7, v38, -v39
    v_fma_f32 v8, v8, v38, -v39
    v_cvt_pk_bf16_f32 v24, v7, v8
    v_lshlrev_b32 v7, 16, v25
    v_and_b32 v8, 0xffff0000, v25
    v_fma_f32 v7, v7, v38, -v39
    v_fma_f32 v8, v8, v38, -v39
    v_cvt_pk_bf16_f32 v25, v7, v8
    v_mfma_f32_32x32x16_bf16 v[56:71], v[120:123], v[132:135], v[56:71]
    v_lshlrev_b32 v7, 16, v26
    v_and_b32 v8, 0xffff0000, v26
    v_fma_f32 v7, v7, v38, -v39
    v_fma_f32 v8, v8, v38, -v39
    v_cvt_pk_bf16_f32 v26, v7, v8
    v_lshlrev_b32 v7, 16, v27
    v_and_b32 v8, 0xffff0000, v27
    v_fma_f32 v7, v7, v38, -v39
    v_fma_f32 v8, v8, v38, -v39
    v_cvt_pk_bf16_f32 v27, v7, v8
    v_mfma_f32_32x32x16_bf16 v[72:87], v[124:127], v[128:131], v[72:87]
    ds_write_b128 v13, v[24:27] offset:24576
    ds_read_b64 v[36:37], v14 offset:9216
    v_mfma_f32_32x32x16_bf16 v[88:103], v[124:127], v[132:135], v[88:103]
    s_waitcnt lgkmcnt(0)
    s_barrier
    s_mov_b32 s36, 2293760
    s_mov_b32 s37, 2560
    buffer_load_dwordx4 v[20:23], v12, s[16:19], s36 offen
    s_add_u32 m0, s35, 0
    s_nop 0
    buffer_load_dwordx4 v15, s[4:7], s37 offen lds
    s_add_u32 m0, s35, 1024
    s_nop 0
    buffer_load_dwordx4 v16, s[4:7], s37 offen lds
    s_waitcnt lgkmcnt(0)
    ds_read_b64_tr_b16 v[120:121], v17 offset:24576
    ds_read_b64_tr_b16 v[122:123], v17 offset:25344
    ds_read_b64_tr_b16 v[124:125], v17 offset:24640
    ds_read_b64_tr_b16 v[126:127], v17 offset:25408
    ds_read_b128 v[128:131], v18 offset:16384
    ds_read_b128 v[132:135], v18 offset:20480
    v_mfma_f32_32x32x16_bf16 v[40:55], v[104:107], v[112:115], v[40:55]
    s_waitcnt vmcnt(6)
    v_lshlrev_b32 v7, 16, v28
    v_and_b32 v8, 0xffff0000, v28
    v_fma_f32 v7, v7, v36, -v37
    v_fma_f32 v8, v8, v36, -v37
    v_cvt_pk_bf16_f32 v28, v7, v8
    v_lshlrev_b32 v7, 16, v29
    v_and_b32 v8, 0xffff0000, v29
    v_fma_f32 v7, v7, v36, -v37
    v_fma_f32 v8, v8, v36, -v37
    v_cvt_pk_bf16_f32 v29, v7, v8
    v_mfma_f32_32x32x16_bf16 v[56:71], v[104:107], v[116:119], v[56:71]
    v_lshlrev_b32 v7, 16, v30
    v_and_b32 v8, 0xffff0000, v30
    v_fma_f32 v7, v7, v36, -v37
    v_fma_f32 v8, v8, v36, -v37
    v_cvt_pk_bf16_f32 v30, v7, v8
    v_lshlrev_b32 v7, 16, v31
    v_and_b32 v8, 0xffff0000, v31
    v_fma_f32 v7, v7, v36, -v37
    v_fma_f32 v8, v8, v36, -v37
    v_cvt_pk_bf16_f32 v31, v7, v8
    v_mfma_f32_32x32x16_bf16 v[72:87], v[108:111], v[112:115], v[72:87]
    ds_write_b128 v13, v[28:31] offset:0
    ds_read_b64 v[38:39], v14 offset:9728
    v_mfma_f32_32x32x16_bf16 v[88:103], v[108:111], v[116:119], v[88:103]
    s_waitcnt lgkmcnt(0)
    s_barrier
    s_mov_b32 s36, 2408448
    s_mov_b32 s37, 2688
    buffer_load_dwordx4 v[24:27], v12, s[16:19], s36 offen
    s_add_u32 m0, s35, 16384
    s_nop 0
    buffer_load_dwordx4 v15, s[4:7], s37 offen lds
    s_add_u32 m0, s35, 17408
    s_nop 0
    buffer_load_dwordx4 v16, s[4:7], s37 offen lds
    s_waitcnt lgkmcnt(0)
    ds_read_b64_tr_b16 v[104:105], v17 offset:0
    ds_read_b64_tr_b16 v[106:107], v17 offset:768
    ds_read_b64_tr_b16 v[108:109], v17 offset:64
    ds_read_b64_tr_b16 v[110:111], v17 offset:832
    ds_read_b128 v[112:115], v18 offset:32768
    ds_read_b128 v[116:119], v18 offset:36864
    v_mfma_f32_32x32x16_bf16 v[40:55], v[120:123], v[128:131], v[40:55]
    s_waitcnt vmcnt(6)
    v_lshlrev_b32 v7, 16, v32
    v_and_b32 v8, 0xffff0000, v32
    v_fma_f32 v7, v7, v38, -v39
    v_fma_f32 v8, v8, v38, -v39
    v_cvt_pk_bf16_f32 v32, v7, v8
    v_lshlrev_b32 v7, 16, v33
    v_and_b32 v8, 0xffff0000, v33
    v_fma_f32 v7, v7, v38, -v39
    v_fma_f32 v8, v8, v38, -v39
    v_cvt_pk_bf16_f32 v33, v7, v8
    v_mfma_f32_32x32x16_bf16 v[56:71], v[120:123], v[132:135], v[56:71]
    v_lshlrev_b32 v7, 16, v34
    v_and_b32 v8, 0xffff0000, v34
    v_fma_f32 v7, v7, v38, -v39
    v_fma_f32 v8, v8, v38, -v39
    v_cvt_pk_bf16_f32 v34, v7, v8
    v_lshlrev_b32 v7, 16, v35
    v_and_b32 v8, 0xffff0000, v35
    v_fma_f32 v7, v7, v38, -v39
    v_fma_f32 v8, v8, v38, -v39
    v_cvt_pk_bf16_f32 v35, v7, v8
    v_mfma_f32_32x32x16_bf16 v[72:87], v[124:127], v[128:131], v[72:87]
    ds_write_b128 v13, v[32:35] offset:12288
    ds_read_b64 v[36:37], v14 offset:10240
    v_mfma_f32_32x32x16_bf16 v[88:103], v[124:127], v[132:135], v[88:103]
    s_waitcnt lgkmcnt(0)
    s_barrier
    s_mov_b32 s36, 2523136
    s_mov_b32 s37, 2816
    buffer_load_dwordx4 v[28:31], v12, s[16:19], s36 offen
    s_add_u32 m0, s35, 32768
    s_nop 0
    buffer_load_dwordx4 v15, s[4:7], s37 offen lds
    s_add_u32 m0, s35, 33792
    s_nop 0
    buffer_load_dwordx4 v16, s[4:7], s37 offen lds
    s_waitcnt lgkmcnt(0)
    ds_read_b64_tr_b16 v[120:121], v17 offset:12288
    ds_read_b64_tr_b16 v[122:123], v17 offset:13056
    ds_read_b64_tr_b16 v[124:125], v17 offset:12352
    ds_read_b64_tr_b16 v[126:127], v17 offset:13120
    ds_read_b128 v[128:131], v18 offset:49152
    ds_read_b128 v[132:135], v18 offset:53248
    v_mfma_f32_32x32x16_bf16 v[40:55], v[104:107], v[112:115], v[40:55]
    s_waitcnt vmcnt(6)
    v_lshlrev_b32 v7, 16, v20
    v_and_b32 v8, 0xffff0000, v20
    v_fma_f32 v7, v7, v36, -v37
    v_fma_f32 v8, v8, v36, -v37
    v_cvt_pk_bf16_f32 v20, v7, v8
    v_lshlrev_b32 v7, 16, v21
    v_and_b32 v8, 0xffff0000, v21
    v_fma_f32 v7, v7, v36, -v37
    v_fma_f32 v8, v8, v36, -v37
    v_cvt_pk_bf16_f32 v21, v7, v8
    v_mfma_f32_32x32x16_bf16 v[56:71], v[104:107], v[116:119], v[56:71]
    v_lshlrev_b32 v7, 16, v22
    v_and_b32 v8, 0xffff0000, v22
    v_fma_f32 v7, v7, v36, -v37
    v_fma_f32 v8, v8, v36, -v37
    v_cvt_pk_bf16_f32 v22, v7, v8
    v_lshlrev_b32 v7, 16, v23
    v_and_b32 v8, 0xffff0000, v23
    v_fma_f32 v7, v7, v36, -v37
    v_fma_f32 v8, v8, v36, -v37
    v_cvt_pk_bf16_f32 v23, v7, v8
    v_mfma_f32_32x32x16_bf16 v[72:87], v[108:111], v[112:115], v[72:87]
    ds_write_b128 v13, v[20:23] offset:24576
    ds_read_b64 v[38:39], v14 offset:10752
    v_mfma_f32_32x32x16_bf16 v[88:103], v[108:111], v[116:119], v[88:103]
    s_waitcnt lgkmcnt(0)
    s_barrier
    s_mov_b32 s36, 2637824
    s_mov_b32 s37, 2944
    buffer_load_dwordx4 v[32:35], v12, s[16:19], s36 offen
    s_add_u32 m0, s35, 49152
    s_nop 0
    buffer_load_dwordx4 v15, s[4:7], s37 offen lds
    s_add_u32 m0, s35, 50176
    s_nop 0
    buffer_load_dwordx4 v16, s[4:7], s37 offen lds
    s_waitcnt lgkmcnt(0)
    ds_read_b64_tr_b16 v[104:105], v17 offset:24576
    ds_read_b64_tr_b16 v[106:107], v17 offset:25344
    ds_read_b64_tr_b16 v[108:109], v17 offset:24640
    ds_read_b64_tr_b16 v[110:111], v17 offset:25408
    ds_read_b128 v[112:115], v18 offset:0
    ds_read_b128 v[116:119], v18 offset:4096
    v_mfma_f32_32x32x16_bf16 v[40:55], v[120:123], v[128:131], v[40:55]
    s_waitcnt vmcnt(6)
    v_lshlrev_b32 v7, 16, v24
    v_and_b32 v8, 0xffff0000, v24
    v_fma_f32 v7, v7, v38, -v39
    v_fma_f32 v8, v8, v38, -v39
    v_cvt_pk_bf16_f32 v24, v7, v8
    v_lshlrev_b32 v7, 16, v25
    v_and_b32 v8, 0xffff0000, v25
    v_fma_f32 v7, v7, v38, -v39
    v_fma_f32 v8, v8, v38, -v39
    v_cvt_pk_bf16_f32 v25, v7, v8
    v_mfma_f32_32x32x16_bf16 v[56:71], v[120:123], v[132:135], v[56:71]
    v_lshlrev_b32 v7, 16, v26
    v_and_b32 v8, 0xffff0000, v26
    v_fma_f32 v7, v7, v38, -v39
    v_fma_f32 v8, v8, v38, -v39
    v_cvt_pk_bf16_f32 v26, v7, v8
    v_lshlrev_b32 v7, 16, v27
    v_and_b32 v8, 0xffff0000, v27
    v_fma_f32 v7, v7, v38, -v39
    v_fma_f32 v8, v8, v38, -v39
    v_cvt_pk_bf16_f32 v27, v7, v8
    v_mfma_f32_32x32x16_bf16 v[72:87], v[124:127], v[128:131], v[72:87]
    ds_write_b128 v13, v[24:27] offset:0
    ds_read_b64 v[36:37], v14 offset:11264
    v_mfma_f32_32x32x16_bf16 v[88:103], v[124:127], v[132:135], v[88:103]
    s_waitcnt lgkmcnt(0)
    s_barrier
    s_mov_b32 s36, 2752512
    s_mov_b32 s37, 3072
    buffer_load_dwordx4 v[20:23], v12, s[16:19], s36 offen
    s_add_u32 m0, s35, 0
    s_nop 0
    buffer_load_dwordx4 v15, s[4:7], s37 offen lds
    s_add_u32 m0, s35, 1024
    s_nop 0
    buffer_load_dwordx4 v16, s[4:7], s37 offen lds
    s_waitcnt lgkmcnt(0)
    ds_read_b64_tr_b16 v[120:121], v17 offset:0
    ds_read_b64_tr_b16 v[122:123], v17 offset:768
    ds_read_b64_tr_b16 v[124:125], v17 offset:64
    ds_read_b64_tr_b16 v[126:127], v17 offset:832
    ds_read_b128 v[128:131], v18 offset:16384
    ds_read_b128 v[132:135], v18 offset:20480
    v_mfma_f32_32x32x16_bf16 v[40:55], v[104:107], v[112:115], v[40:55]
    s_waitcnt vmcnt(6)
    v_lshlrev_b32 v7, 16, v28
    v_and_b32 v8, 0xffff0000, v28
    v_fma_f32 v7, v7, v36, -v37
    v_fma_f32 v8, v8, v36, -v37
    v_cvt_pk_bf16_f32 v28, v7, v8
    v_lshlrev_b32 v7, 16, v29
    v_and_b32 v8, 0xffff0000, v29
    v_fma_f32 v7, v7, v36, -v37
    v_fma_f32 v8, v8, v36, -v37
    v_cvt_pk_bf16_f32 v29, v7, v8
    v_mfma_f32_32x32x16_bf16 v[56:71], v[104:107], v[116:119], v[56:71]
    v_lshlrev_b32 v7, 16, v30
    v_and_b32 v8, 0xffff0000, v30
    v_fma_f32 v7, v7, v36, -v37
    v_fma_f32 v8, v8, v36, -v37
    v_cvt_pk_bf16_f32 v30, v7, v8
    v_lshlrev_b32 v7, 16, v31
    v_and_b32 v8, 0xffff0000, v31
    v_fma_f32 v7, v7, v36, -v37
    v_fma_f32 v8, v8, v36, -v37
    v_cvt_pk_bf16_f32 v31, v7, v8
    v_mfma_f32_32x32x16_bf16 v[72:87], v[108:111], v[112:115], v[72:87]
    ds_write_b128 v13, v[28:31] offset:12288
    ds_read_b64 v[38:39], v14 offset:11776
    v_mfma_f32_32x32x16_bf16 v[88:103], v[108:111], v[116:119], v[88:103]
    s_waitcnt lgkmcnt(0)
    s_barrier
    s_mov_b32 s36, 2867200
    s_mov_b32 s37, 3200
    buffer_load_dwordx4 v[24:27], v12, s[16:19], s36 offen
    s_add_u32 m0, s35, 16384
    s_nop 0
    buffer_load_dwordx4 v15, s[4:7], s37 offen lds
    s_add_u32 m0, s35, 17408
    s_nop 0
    buffer_load_dwordx4 v16, s[4:7], s37 offen lds
    s_waitcnt lgkmcnt(0)
    ds_read_b64_tr_b16 v[104:105], v17 offset:12288
    ds_read_b64_tr_b16 v[106:107], v17 offset:13056
    ds_read_b64_tr_b16 v[108:109], v17 offset:12352
    ds_read_b64_tr_b16 v[110:111], v17 offset:13120
    ds_read_b128 v[112:115], v18 offset:32768
    ds_read_b128 v[116:119], v18 offset:36864
    v_mfma_f32_32x32x16_bf16 v[40:55], v[120:123], v[128:131], v[40:55]
    s_waitcnt vmcnt(6)
    v_lshlrev_b32 v7, 16, v32
    v_and_b32 v8, 0xffff0000, v32
    v_fma_f32 v7, v7, v38, -v39
    v_fma_f32 v8, v8, v38, -v39
    v_cvt_pk_bf16_f32 v32, v7, v8
    v_lshlrev_b32 v7, 16, v33
    v_and_b32 v8, 0xffff0000, v33
    v_fma_f32 v7, v7, v38, -v39
    v_fma_f32 v8, v8, v38, -v39
    v_cvt_pk_bf16_f32 v33, v7, v8
    v_mfma_f32_32x32x16_bf16 v[56:71], v[120:123], v[132:135], v[56:71]
    v_lshlrev_b32 v7, 16, v34
    v_and_b32 v8, 0xffff0000, v34
    v_fma_f32 v7, v7, v38, -v39
    v_fma_f32 v8, v8, v38, -v39
    v_cvt_pk_bf16_f32 v34, v7, v8
    v_lshlrev_b32 v7, 16, v35
    v_and_b32 v8, 0xffff0000, v35
    v_fma_f32 v7, v7, v38, -v39
    v_fma_f32 v8, v8, v38, -v39
    v_cvt_pk_bf16_f32 v35, v7, v8
    v_mfma_f32_32x32x16_bf16 v[72:87], v[124:127], v[128:131], v[72:87]
    ds_write_b128 v13, v[32:35] offset:24576
    ds_read_b64 v[36:37], v14 offset:12288
    v_mfma_f32_32x32x16_bf16 v[88:103], v[124:127], v[132:135], v[88:103]
    s_waitcnt lgkmcnt(0)
    s_barrier
    s_mov_b32 s36, 2981888
    s_mov_b32 s37, 3328
    buffer_load_dwordx4 v[28:31], v12, s[16:19], s36 offen
    s_add_u32 m0, s35, 32768
    s_nop 0
    buffer_load_dwordx4 v15, s[4:7], s37 offen lds
    s_add_u32 m0, s35, 33792
    s_nop 0
    buffer_load_dwordx4 v16, s[4:7], s37 offen lds
    s_waitcnt lgkmcnt(0)
    ds_read_b64_tr_b16 v[120:121], v17 offset:24576
    ds_read_b64_tr_b16 v[122:123], v17 offset:25344
    ds_read_b64_tr_b16 v[124:125], v17 offset:24640
    ds_read_b64_tr_b16 v[126:127], v17 offset:25408
    ds_read_b128 v[128:131], v18 offset:49152
    ds_read_b128 v[132:135], v18 offset:53248
    v_mfma_f32_32x32x16_bf16 v[40:55], v[104:107], v[112:115], v[40:55]
    s_waitcnt vmcnt(6)
    v_lshlrev_b32 v7, 16, v20
    v_and_b32 v8, 0xffff0000, v20
    v_fma_f32 v7, v7, v36, -v37
    v_fma_f32 v8, v8, v36, -v37
    v_cvt_pk_bf16_f32 v20, v7, v8
    v_lshlrev_b32 v7, 16, v21
    v_and_b32 v8, 0xffff0000, v21
    v_fma_f32 v7, v7, v36, -v37
    v_fma_f32 v8, v8, v36, -v37
    v_cvt_pk_bf16_f32 v21, v7, v8
    v_mfma_f32_32x32x16_bf16 v[56:71], v[104:107], v[116:119], v[56:71]
    v_lshlrev_b32 v7, 16, v22
    v_and_b32 v8, 0xffff0000, v22
    v_fma_f32 v7, v7, v36, -v37
    v_fma_f32 v8, v8, v36, -v37
    v_cvt_pk_bf16_f32 v22, v7, v8
    v_lshlrev_b32 v7, 16, v23
    v_and_b32 v8, 0xffff0000, v23
    v_fma_f32 v7, v7, v36, -v37
    v_fma_f32 v8, v8, v36, -v37
    v_cvt_pk_bf16_f32 v23, v7, v8
    v_mfma_f32_32x32x16_bf16 v[72:87], v[108:111], v[112:115], v[72:87]
    ds_write_b128 v13, v[20:23] offset:0
    ds_read_b64 v[38:39], v14 offset:12800
    v_mfma_f32_32x32x16_bf16 v[88:103], v[108:111], v[116:119], v[88:103]
    s_waitcnt lgkmcnt(0)
    s_barrier
    s_mov_b32 s36, 3096576
    s_mov_b32 s37, 3456
    buffer_load_dwordx4 v[32:35], v12, s[16:19], s36 offen
    s_add_u32 m0, s35, 49152
    s_nop 0
    buffer_load_dwordx4 v15, s[4:7], s37 offen lds
    s_add_u32 m0, s35, 50176
    s_nop 0
    buffer_load_dwordx4 v16, s[4:7], s37 offen lds
    s_waitcnt lgkmcnt(0)
    ds_read_b64_tr_b16 v[104:105], v17 offset:0
    ds_read_b64_tr_b16 v[106:107], v17 offset:768
    ds_read_b64_tr_b16 v[108:109], v17 offset:64
    ds_read_b64_tr_b16 v[110:111], v17 offset:832
    ds_read_b128 v[112:115], v18 offset:0
    ds_read_b128 v[116:119], v18 offset:4096
    v_mfma_f32_32x32x16_bf16 v[40:55], v[120:123], v[128:131], v[40:55]
    s_waitcnt vmcnt(6)
    v_lshlrev_b32 v7, 16, v24
    v_and_b32 v8, 0xffff0000, v24
    v_fma_f32 v7, v7, v38, -v39
    v_fma_f32 v8, v8, v38, -v39
    v_cvt_pk_bf16_f32 v24, v7, v8
    v_lshlrev_b32 v7, 16, v25
    v_and_b32 v8, 0xffff0000, v25
    v_fma_f32 v7, v7, v38, -v39
    v_fma_f32 v8, v8, v38, -v39
    v_cvt_pk_bf16_f32 v25, v7, v8
    v_mfma_f32_32x32x16_bf16 v[56:71], v[120:123], v[132:135], v[56:71]
    v_lshlrev_b32 v7, 16, v26
    v_and_b32 v8, 0xffff0000, v26
    v_fma_f32 v7, v7, v38, -v39
    v_fma_f32 v8, v8, v38, -v39
    v_cvt_pk_bf16_f32 v26, v7, v8
    v_lshlrev_b32 v7, 16, v27
    v_and_b32 v8, 0xffff0000, v27
    v_fma_f32 v7, v7, v38, -v39
    v_fma_f32 v8, v8, v38, -v39
    v_cvt_pk_bf16_f32 v27, v7, v8
    v_mfma_f32_32x32x16_bf16 v[72:87], v[124:127], v[128:131], v[72:87]
    ds_write_b128 v13, v[24:27] offset:12288
    ds_read_b64 v[36:37], v14 offset:13312
    v_mfma_f32_32x32x16_bf16 v[88:103], v[124:127], v[132:135], v[88:103]
    s_waitcnt lgkmcnt(0)
    s_barrier
    s_mov_b32 s36, 3211264
    s_mov_b32 s37, 3584
    buffer_load_dwordx4 v[20:23], v12, s[16:19], s36 offen
    s_add_u32 m0, s35, 0
    s_nop 0
    buffer_load_dwordx4 v15, s[4:7], s37 offen lds
    s_add_u32 m0, s35, 1024
    s_nop 0
    buffer_load_dwordx4 v16, s[4:7], s37 offen lds
    s_waitcnt lgkmcnt(0)
    ds_read_b64_tr_b16 v[120:121], v17 offset:12288
    ds_read_b64_tr_b16 v[122:123], v17 offset:13056
    ds_read_b64_tr_b16 v[124:125], v17 offset:12352
    ds_read_b64_tr_b16 v[126:127], v17 offset:13120
    ds_read_b128 v[128:131], v18 offset:16384
    ds_read_b128 v[132:135], v18 offset:20480
    v_mfma_f32_32x32x16_bf16 v[40:55], v[104:107], v[112:115], v[40:55]
    s_waitcnt vmcnt(6)
    v_lshlrev_b32 v7, 16, v28
    v_and_b32 v8, 0xffff0000, v28
    v_fma_f32 v7, v7, v36, -v37
    v_fma_f32 v8, v8, v36, -v37
    v_cvt_pk_bf16_f32 v28, v7, v8
    v_lshlrev_b32 v7, 16, v29
    v_and_b32 v8, 0xffff0000, v29
    v_fma_f32 v7, v7, v36, -v37
    v_fma_f32 v8, v8, v36, -v37
    v_cvt_pk_bf16_f32 v29, v7, v8
    v_mfma_f32_32x32x16_bf16 v[56:71], v[104:107], v[116:119], v[56:71]
    v_lshlrev_b32 v7, 16, v30
    v_and_b32 v8, 0xffff0000, v30
    v_fma_f32 v7, v7, v36, -v37
    v_fma_f32 v8, v8, v36, -v37
    v_cvt_pk_bf16_f32 v30, v7, v8
    v_lshlrev_b32 v7, 16, v31
    v_and_b32 v8, 0xffff0000, v31
    v_fma_f32 v7, v7, v36, -v37
    v_fma_f32 v8, v8, v36, -v37
    v_cvt_pk_bf16_f32 v31, v7, v8
    v_mfma_f32_32x32x16_bf16 v[72:87], v[108:111], v[112:115], v[72:87]
    ds_write_b128 v13, v[28:31] offset:24576
    ds_read_b64 v[38:39], v14 offset:13824
    v_mfma_f32_32x32x16_bf16 v[88:103], v[108:111], v[116:119], v[88:103]
    s_waitcnt lgkmcnt(0)
    s_barrier
    s_mov_b32 s36, 3325952
    s_mov_b32 s37, 3712
    buffer_load_dwordx4 v[24:27], v12, s[16:19], s36 offen
    s_add_u32 m0, s35, 16384
    s_nop 0
    buffer_load_dwordx4 v15, s[4:7], s37 offen lds
    s_add_u32 m0, s35, 17408
    s_nop 0
    buffer_load_dwordx4 v16, s[4:7], s37 offen lds
    s_waitcnt lgkmcnt(0)
    ds_read_b64_tr_b16 v[104:105], v17 offset:24576
    ds_read_b64_tr_b16 v[106:107], v17 offset:25344
    ds_read_b64_tr_b16 v[108:109], v17 offset:24640
    ds_read_b64_tr_b16 v[110:111], v17 offset:25408
    ds_read_b128 v[112:115], v18 offset:32768
    ds_read_b128 v[116:119], v18 offset:36864
    v_mfma_f32_32x32x16_bf16 v[40:55], v[120:123], v[128:131], v[40:55]
    s_waitcnt vmcnt(6)
    v_lshlrev_b32 v7, 16, v32
    v_and_b32 v8, 0xffff0000, v32
    v_fma_f32 v7, v7, v38, -v39
    v_fma_f32 v8, v8, v38, -v39
    v_cvt_pk_bf16_f32 v32, v7, v8
    v_lshlrev_b32 v7, 16, v33
    v_and_b32 v8, 0xffff0000, v33
    v_fma_f32 v7, v7, v38, -v39
    v_fma_f32 v8, v8, v38, -v39
    v_cvt_pk_bf16_f32 v33, v7, v8
    v_mfma_f32_32x32x16_bf16 v[56:71], v[120:123], v[132:135], v[56:71]
    v_lshlrev_b32 v7, 16, v34
    v_and_b32 v8, 0xffff0000, v34
    v_fma_f32 v7, v7, v38, -v39
    v_fma_f32 v8, v8, v38, -v39
    v_cvt_pk_bf16_f32 v34, v7, v8
    v_lshlrev_b32 v7, 16, v35
    v_and_b32 v8, 0xffff0000, v35
    v_fma_f32 v7, v7, v38, -v39
    v_fma_f32 v8, v8, v38, -v39
    v_cvt_pk_bf16_f32 v35, v7, v8
    v_mfma_f32_32x32x16_bf16 v[72:87], v[124:127], v[128:131], v[72:87]
    ds_write_b128 v13, v[32:35] offset:0
    ds_read_b64 v[36:37], v14 offset:14336
    v_mfma_f32_32x32x16_bf16 v[88:103], v[124:127], v[132:135], v[88:103]
    s_waitcnt lgkmcnt(0)
    s_barrier
    s_mov_b32 s36, 3440640
    s_mov_b32 s37, 3840
    buffer_load_dwordx4 v[28:31], v12, s[16:19], s36 offen
    s_add_u32 m0, s35, 32768
    s_nop 0
    buffer_load_dwordx4 v15, s[4:7], s37 offen lds
    s_add_u32 m0, s35, 33792
    s_nop 0
    buffer_load_dwordx4 v16, s[4:7], s37 offen lds
    s_waitcnt lgkmcnt(0)
    ds_read_b64_tr_b16 v[120:121], v17 offset:0
    ds_read_b64_tr_b16 v[122:123], v17 offset:768
    ds_read_b64_tr_b16 v[124:125], v17 offset:64
    ds_read_b64_tr_b16 v[126:127], v17 offset:832
    ds_read_b128 v[128:131], v18 offset:49152
    ds_read_b128 v[132:135], v18 offset:53248
    v_mfma_f32_32x32x16_bf16 v[40:55], v[104:107], v[112:115], v[40:55]
    s_waitcnt vmcnt(6)
    v_lshlrev_b32 v7, 16, v20
    v_and_b32 v8, 0xffff0000, v20
    v_fma_f32 v7, v7, v36, -v37
    v_fma_f32 v8, v8, v36, -v37
    v_cvt_pk_bf16_f32 v20, v7, v8
    v_lshlrev_b32 v7, 16, v21
    v_and_b32 v8, 0xffff0000, v21
    v_fma_f32 v7, v7, v36, -v37
    v_fma_f32 v8, v8, v36, -v37
    v_cvt_pk_bf16_f32 v21, v7, v8
    v_mfma_f32_32x32x16_bf16 v[56:71], v[104:107], v[116:119], v[56:71]
    v_lshlrev_b32 v7, 16, v22
    v_and_b32 v8, 0xffff0000, v22
    v_fma_f32 v7, v7, v36, -v37
    v_fma_f32 v8, v8, v36, -v37
    v_cvt_pk_bf16_f32 v22, v7, v8
    v_lshlrev_b32 v7, 16, v23
    v_and_b32 v8, 0xffff0000, v23
    v_fma_f32 v7, v7, v36, -v37
    v_fma_f32 v8, v8, v36, -v37
    v_cvt_pk_bf16_f32 v23, v7, v8
    v_mfma_f32_32x32x16_bf16 v[72:87], v[108:111], v[112:115], v[72:87]
    ds_write_b128 v13, v[20:23] offset:12288
    ds_read_b64 v[38:39], v14 offset:14848
    v_mfma_f32_32x32x16_bf16 v[88:103], v[108:111], v[116:119], v[88:103]
    s_waitcnt lgkmcnt(0)
    s_barrier
    s_mov_b32 s36, 3555328
    s_mov_b32 s37, 3968
    buffer_load_dwordx4 v[32:35], v12, s[16:19], s36 offen
    s_add_u32 m0, s35, 49152
    s_nop 0
    buffer_load_dwordx4 v15, s[4:7], s37 offen lds
    s_add_u32 m0, s35, 50176
    s_nop 0
    buffer_load_dwordx4 v16, s[4:7], s37 offen lds
    s_waitcnt lgkmcnt(0)
    ds_read_b64_tr_b16 v[104:105], v17 offset:12288
    ds_read_b64_tr_b16 v[106:107], v17 offset:13056
    ds_read_b64_tr_b16 v[108:109], v17 offset:12352
    ds_read_b64_tr_b16 v[110:111], v17 offset:13120
    ds_read_b128 v[112:115], v18 offset:0
    ds_read_b128 v[116:119], v18 offset:4096
    v_mfma_f32_32x32x16_bf16 v[40:55], v[120:123], v[128:131], v[40:55]
    s_waitcnt vmcnt(6)
    v_lshlrev_b32 v7, 16, v24
    v_and_b32 v8, 0xffff0000, v24
    v_fma_f32 v7, v7, v38, -v39
    v_fma_f32 v8, v8, v38, -v39
    v_cvt_pk_bf16_f32 v24, v7, v8
    v_lshlrev_b32 v7, 16, v25
    v_and_b32 v8, 0xffff0000, v25
    v_fma_f32 v7, v7, v38, -v39
    v_fma_f32 v8, v8, v38, -v39
    v_cvt_pk_bf16_f32 v25, v7, v8
    v_mfma_f32_32x32x16_bf16 v[56:71], v[120:123], v[132:135], v[56:71]
    v_lshlrev_b32 v7, 16, v26
    v_and_b32 v8, 0xffff0000, v26
    v_fma_f32 v7, v7, v38, -v39
    v_fma_f32 v8, v8, v38, -v39
    v_cvt_pk_bf16_f32 v26, v7, v8
    v_lshlrev_b32 v7, 16, v27
    v_and_b32 v8, 0xffff0000, v27
    v_fma_f32 v7, v7, v38, -v39
    v_fma_f32 v8, v8, v38, -v39
    v_cvt_pk_bf16_f32 v27, v7, v8
    v_mfma_f32_32x32x16_bf16 v[72:87], v[124:127], v[128:131], v[72:87]
    ds_write_b128 v13, v[24:27] offset:24576
    ds_read_b64 v[36:37], v14 offset:15360
    v_mfma_f32_32x32x16_bf16 v[88:103], v[124:127], v[132:135], v[88:103]
    s_waitcnt lgkmcnt(0)
    s_barrier
    s_waitcnt lgkmcnt(0)
    ds_read_b64_tr_b16 v[120:121], v17 offset:24576
    ds_read_b64_tr_b16 v[122:123], v17 offset:25344
    ds_read_b64_tr_b16 v[124:125], v17 offset:24640
    ds_read_b64_tr_b16 v[126:127], v17 offset:25408
    ds_read_b128 v[128:131], v18 offset:16384
    ds_read_b128 v[132:135], v18 offset:20480
    v_mfma_f32_32x32x16_bf16 v[40:55], v[104:107], v[112:115], v[40:55]
    s_waitcnt vmcnt(3)
    v_lshlrev_b32 v7, 16, v28
    v_and_b32 v8, 0xffff0000, v28
    v_fma_f32 v7, v7, v36, -v37
    v_fma_f32 v8, v8, v36, -v37
    v_cvt_pk_bf16_f32 v28, v7, v8
    v_lshlrev_b32 v7, 16, v29
    v_and_b32 v8, 0xffff0000, v29
    v_fma_f32 v7, v7, v36, -v37
    v_fma_f32 v8, v8, v36, -v37
    v_cvt_pk_bf16_f32 v29, v7, v8
    v_mfma_f32_32x32x16_bf16 v[56:71], v[104:107], v[116:119], v[56:71]
    v_lshlrev_b32 v7, 16, v30
    v_and_b32 v8, 0xffff0000, v30
    v_fma_f32 v7, v7, v36, -v37
    v_fma_f32 v8, v8, v36, -v37
    v_cvt_pk_bf16_f32 v30, v7, v8
    v_lshlrev_b32 v7, 16, v31
    v_and_b32 v8, 0xffff0000, v31
    v_fma_f32 v7, v7, v36, -v37
    v_fma_f32 v8, v8, v36, -v37
    v_cvt_pk_bf16_f32 v31, v7, v8
    v_mfma_f32_32x32x16_bf16 v[72:87], v[108:111], v[112:115], v[72:87]
    ds_write_b128 v13, v[28:31] offset:0
    ds_read_b64 v[38:39], v14 offset:15872
    v_mfma_f32_32x32x16_bf16 v[88:103], v[108:111], v[116:119], v[88:103]
    s_waitcnt lgkmcnt(0)
    s_barrier
    s_waitcnt lgkmcnt(0)
    ds_read_b64_tr_b16 v[104:105], v17 offset:0
    ds_read_b64_tr_b16 v[106:107], v17 offset:768
    ds_read_b64_tr_b16 v[108:109], v17 offset:64
    ds_read_b64_tr_b16 v[110:111], v17 offset:832
    ds_read_b128 v[112:115], v18 offset:32768
    ds_read_b128 v[116:119], v18 offset:36864
    v_mfma_f32_32x32x16_bf16 v[40:55], v[120:123], v[128:131], v[40:55]
    s_waitcnt vmcnt(0)
    v_lshlrev_b32 v7, 16, v32
    v_and_b32 v8, 0xffff0000, v32
    v_fma_f32 v7, v7, v38, -v39
    v_fma_f32 v8, v8, v38, -v39
    v_cvt_pk_bf16_f32 v32, v7, v8
    v_lshlrev_b32 v7, 16, v33
    v_and_b32 v8, 0xffff0000, v33
    v_fma_f32 v7, v7, v38, -v39
    v_fma_f32 v8, v8, v38, -v39
    v_cvt_pk_bf16_f32 v33, v7, v8
    v_mfma_f32_32x32x16_bf16 v[56:71], v[120:123], v[132:135], v[56:71]
    v_lshlrev_b32 v7, 16, v34
    v_and_b32 v8, 0xffff0000, v34
    v_fma_f32 v7, v7, v38, -v39
    v_fma_f32 v8, v8, v38, -v39
    v_cvt_pk_bf16_f32 v34, v7, v8
    v_lshlrev_b32 v7, 16, v35
    v_and_b32 v8, 0xffff0000, v35
    v_fma_f32 v7, v7, v38, -v39
    v_fma_f32 v8, v8, v38, -v39
    v_cvt_pk_bf16_f32 v35, v7, v8
    v_mfma_f32_32x32x16_bf16 v[72:87], v[124:127], v[128:131], v[72:87]
    ds_write_b128 v13, v[32:35] offset:12288
    v_mfma_f32_32x32x16_bf16 v[88:103], v[124:127], v[132:135], v[88:103]
    s_waitcnt lgkmcnt(0)
    s_barrier
    s_waitcnt lgkmcnt(0)
    ds_read_b64_tr_b16 v[120:121], v17 offset:12288
    ds_read_b64_tr_b16 v[122:123], v17 offset:13056
    ds_read_b64_tr_b16 v[124:125], v17 offset:12352
    ds_read_b64_tr_b16 v[126:127], v17 offset:13120
    ds_read_b128 v[128:131], v18 offset:49152
    ds_read_b128 v[132:135], v18 offset:53248
    v_mfma_f32_32x32x16_bf16 v[40:55], v[104:107], v[112:115], v[40:55]
    v_mfma_f32_32x32x16_bf16 v[56:71], v[104:107], v[116:119], v[56:71]
    v_mfma_f32_32x32x16_bf16 v[72:87], v[108:111], v[112:115], v[72:87]
    v_mfma_f32_32x32x16_bf16 v[88:103], v[108:111], v[116:119], v[88:103]
    s_waitcnt lgkmcnt(0)
    s_barrier
    s_waitcnt lgkmcnt(0)
    v_mfma_f32_32x32x16_bf16 v[40:55], v[120:123], v[128:131], v[40:55]
    v_mfma_f32_32x32x16_bf16 v[56:71], v[120:123], v[132:135], v[56:71]
    v_mfma_f32_32x32x16_bf16 v[72:87], v[124:127], v[128:131], v[72:87]
    v_mfma_f32_32x32x16_bf16 v[88:103], v[124:127], v[132:135], v[88:103]
    v_lshrrev_b32 v6, 3, v0
    v_and_b32 v7, 7, v0
    s_lshl_b32 s40, s20, 7
    v_add_u32 v8, s40, v6
    v_lshlrev_b32 v5, 1, v8
    v_mul_u32_u24 v3, 1792, v8
    v_lshl_add_u32 v3, v7, 4, v3
    v_add_u32 v4, 114688, v3
    s_lshl_b32 s41, s21, 7
    s_add_u32 s42, s41, 10227712
    s_add_u32 s43, s41, 17567744
    buffer_load_dwordx4 v[20:23], v3, s[16:19], s42 offen
    buffer_load_ushort v28, v5, s[8:11], 0 offen offset:0
    buffer_load_dwordx4 v[24:27], v4, s[16:19], s42 offen
    buffer_load_ushort v29, v5, s[8:11], 0 offen offset:128
    s_mov_b32 s60, s54
    s_and_b32 s61, s55, 0xffff
    s_mov_b32 s62, 401408
    s_mov_b32 s63, 0x00020000
    s_mov_b32 s76, s56
    s_and_b32 s77, s57, 0xffff
    s_mov_b32 s78, 802816
    s_mov_b32 s79, 0x00020000
    v_lshlrev_b32 v11, 4, v0
    s_lshr_b32 s38, s2, 3
    s_lshl_b32 s38, s38, 13
    buffer_load_dwordx4 v[168:171], v11, s[60:63], s38 offen
    s_add_u32 s38, s38, 229376
    buffer_load_dwordx4 v[168:171], v11, s[60:63], s38 offen
    s_add_u32 s38, s38, 229376
    s_lshr_b32 s38, s2, 3
    s_lshl_b32 s38, s38, 13
    buffer_load_dwordx4 v[168:171], v11, s[76:79], s38 offen
    s_add_u32 s38, s38, 229376
    buffer_load_dwordx4 v[168:171], v11, s[76:79], s38 offen
    s_add_u32 s38, s38, 229376
    buffer_load_dwordx4 v[168:171], v11, s[76:79], s38 offen
    s_add_u32 s38, s38, 229376
    buffer_load_dwordx4 v[168:171], v11, s[76:79], s38 offen
    s_add_u32 s38, s38, 229376
    v_and_b32 v11, 31, v1
    v_mul_u32_u24 v9, 272, v11
    v_lshrrev_b32 v11, 5, v1
    v_lshl_add_u32 v9, v11, 4, v9
    s_lshr_b32 s40, s23, 1
    s_mul_i32 s40, s40, 34816
    s_and_b32 s41, s23, 1
    s_mul_i32 s41, s41, 17408
    s_add_u32 s40, s40, s41
    v_add_u32 v9, s40, v9
    v_mul_u32_u24 v10, 272, v6
    v_lshl_add_u32 v10, v7, 5, v10
    s_barrier
    ds_write_b128 v9, v[40:43] offset:0
    ds_write_b128 v9, v[44:47] offset:32
    ds_write_b128 v9, v[48:51] offset:64
    ds_write_b128 v9, v[52:55] offset:96
    ds_write_b128 v9, v[56:59] offset:8704
    ds_write_b128 v9, v[60:63] offset:8736
    ds_write_b128 v9, v[64:67] offset:8768
    ds_write_b128 v9, v[68:71] offset:8800
    ds_write_b128 v9, v[72:75] offset:128
    ds_write_b128 v9, v[76:79] offset:160
    ds_write_b128 v9, v[80:83] offset:192
    ds_write_b128 v9, v[84:87] offset:224
    ds_write_b128 v9, v[88:91] offset:8832
    ds_write_b128 v9, v[92:95] offset:8864
    ds_write_b128 v9, v[96:99] offset:8896
    ds_write_b128 v9, v[100:103] offset:8928
    s_waitcnt lgkmcnt(0)
    s_barrier
    ds_read_b128 v[40:43], v10 offset:0
    ds_read_b128 v[44:47], v10 offset:16
    ds_read_b128 v[48:51], v10 offset:34816
    ds_read_b128 v[52:55], v10 offset:34832
    v_add_u32 v11, 69632, v10
    ds_read_b128 v[56:59], v11
    v_add_u32 v11, 69648, v10
    ds_read_b128 v[60:63], v11
    v_add_u32 v11, 104448, v10
    ds_read_b128 v[64:67], v11
    v_add_u32 v11, 104464, v10
    ds_read_b128 v[68:71], v11
    ds_read_b128 v[72:75], v10 offset:17408
    ds_read_b128 v[76:79], v10 offset:17424
    ds_read_b128 v[80:83], v10 offset:52224
    ds_read_b128 v[84:87], v10 offset:52240
    v_add_u32 v11, 87040, v10
    ds_read_b128 v[88:91], v11
    v_add_u32 v11, 87056, v10
    ds_read_b128 v[92:95], v11
    v_add_u32 v11, 121856, v10
    ds_read_b128 v[96:99], v11
    v_add_u32 v11, 121872, v10
    ds_read_b128 v[100:103], v11
    s_waitcnt vmcnt(6) lgkmcnt(0)
    v_add_f32 v40, v40, v48
    v_add_f32 v41, v41, v49
    v_add_f32 v42, v42, v50
    v_add_f32 v43, v43, v51
    v_add_f32 v44, v44, v52
    v_add_f32 v45, v45, v53
    v_add_f32 v46, v46, v54
    v_add_f32 v47, v47, v55
    v_add_f32 v40, v40, v56
    v_add_f32 v41, v41, v57
    v_add_f32 v42, v42, v58
    v_add_f32 v43, v43, v59
    v_add_f32 v44, v44, v60
    v_add_f32 v45, v45, v61
    v_add_f32 v46, v46, v62
    v_add_f32 v47, v47, v63
    v_add_f32 v40, v40, v64
    v_add_f32 v41, v41, v65
    v_add_f32 v42, v42, v66
    v_add_f32 v43, v43, v67
    v_add_f32 v44, v44, v68
    v_add_f32 v45, v45, v69
    v_add_f32 v46, v46, v70
    v_add_f32 v47, v47, v71
    v_lshlrev_b32 v28, 16, v28
    v_cvt_pk_bf16_f32 v11, v40, v41
    v_lshlrev_b32 v7, 16, v11
    v_and_b32 v8, 0xffff0000, v11
    v_add_f32 v7, v7, v28
    v_add_f32 v8, v8, v28
    v_cvt_pk_bf16_f32 v11, v7, v8
    v_lshlrev_b32 v7, 16, v11
    v_and_b32 v8, 0xffff0000, v11
    v_lshlrev_b32 v11, 16, v20
    v_and_b32 v20, 0xffff0000, v20
    v_mul_f32 v7, v7, v11
    v_mul_f32 v8, v8, v20
    v_cvt_pk_bf16_f32 v20, v7, v8
    v_cvt_pk_bf16_f32 v11, v42, v43
    v_lshlrev_b32 v7, 16, v11
    v_and_b32 v8, 0xffff0000, v11
    v_add_f32 v7, v7, v28
    v_add_f32 v8, v8, v28
    v_cvt_pk_bf16_f32 v11, v7, v8
    v_lshlrev_b32 v7, 16, v11
    v_and_b32 v8, 0xffff0000, v11
    v_lshlrev_b32 v11, 16, v21
    v_and_b32 v21, 0xffff0000, v21
    v_mul_f32 v7, v7, v11
    v_mul_f32 v8, v8, v21
    v_cvt_pk_bf16_f32 v21, v7, v8
    v_cvt_pk_bf16_f32 v11, v44, v45
    v_lshlrev_b32 v7, 16, v11
    v_and_b32 v8, 0xffff0000, v11
    v_add_f32 v7, v7, v28
    v_add_f32 v8, v8, v28
    v_cvt_pk_bf16_f32 v11, v7, v8
    v_lshlrev_b32 v7, 16, v11
    v_and_b32 v8, 0xffff0000, v11
    v_lshlrev_b32 v11, 16, v22
    v_and_b32 v22, 0xffff0000, v22
    v_mul_f32 v7, v7, v11
    v_mul_f32 v8, v8, v22
    v_cvt_pk_bf16_f32 v22, v7, v8
    v_cvt_pk_bf16_f32 v11, v46, v47
    v_lshlrev_b32 v7, 16, v11
    v_and_b32 v8, 0xffff0000, v11
    v_add_f32 v7, v7, v28
    v_add_f32 v8, v8, v28
    v_cvt_pk_bf16_f32 v11, v7, v8
    v_lshlrev_b32 v7, 16, v11
    v_and_b32 v8, 0xffff0000, v11
    v_lshlrev_b32 v11, 16, v23
    v_and_b32 v23, 0xffff0000, v23
    v_mul_f32 v7, v7, v11
    v_mul_f32 v8, v8, v23
    v_cvt_pk_bf16_f32 v23, v7, v8
    buffer_store_dwordx4 v[20:23], v3, s[16:19], s43 offen sc1
    v_add_f32 v72, v72, v80
    v_add_f32 v73, v73, v81
    v_add_f32 v74, v74, v82
    v_add_f32 v75, v75, v83
    v_add_f32 v76, v76, v84
    v_add_f32 v77, v77, v85
    v_add_f32 v78, v78, v86
    v_add_f32 v79, v79, v87
    v_add_f32 v72, v72, v88
    v_add_f32 v73, v73, v89
    v_add_f32 v74, v74, v90
    v_add_f32 v75, v75, v91
    v_add_f32 v76, v76, v92
    v_add_f32 v77, v77, v93
    v_add_f32 v78, v78, v94
    v_add_f32 v79, v79, v95
    v_add_f32 v72, v72, v96
    v_add_f32 v73, v73, v97
    v_add_f32 v74, v74, v98
    v_add_f32 v75, v75, v99
    v_add_f32 v76, v76, v100
    v_add_f32 v77, v77, v101
    v_add_f32 v78, v78, v102
    v_add_f32 v79, v79, v103
    v_lshlrev_b32 v29, 16, v29
    v_cvt_pk_bf16_f32 v11, v72, v73
    v_lshlrev_b32 v7, 16, v11
    v_and_b32 v8, 0xffff0000, v11
    v_add_f32 v7, v7, v29
    v_add_f32 v8, v8, v29
    v_cvt_pk_bf16_f32 v11, v7, v8
    v_lshlrev_b32 v7, 16, v11
    v_and_b32 v8, 0xffff0000, v11
    v_lshlrev_b32 v11, 16, v24
    v_and_b32 v24, 0xffff0000, v24
    v_mul_f32 v7, v7, v11
    v_mul_f32 v8, v8, v24
    v_cvt_pk_bf16_f32 v24, v7, v8
    v_cvt_pk_bf16_f32 v11, v74, v75
    v_lshlrev_b32 v7, 16, v11
    v_and_b32 v8, 0xffff0000, v11
    v_add_f32 v7, v7, v29
    v_add_f32 v8, v8, v29
    v_cvt_pk_bf16_f32 v11, v7, v8
    v_lshlrev_b32 v7, 16, v11
    v_and_b32 v8, 0xffff0000, v11
    v_lshlrev_b32 v11, 16, v25
    v_and_b32 v25, 0xffff0000, v25
    v_mul_f32 v7, v7, v11
    v_mul_f32 v8, v8, v25
    v_cvt_pk_bf16_f32 v25, v7, v8
    v_cvt_pk_bf16_f32 v11, v76, v77
    v_lshlrev_b32 v7, 16, v11
    v_and_b32 v8, 0xffff0000, v11
    v_add_f32 v7, v7, v29
    v_add_f32 v8, v8, v29
    v_cvt_pk_bf16_f32 v11, v7, v8
    v_lshlrev_b32 v7, 16, v11
    v_and_b32 v8, 0xffff0000, v11
    v_lshlrev_b32 v11, 16, v26
    v_and_b32 v26, 0xffff0000, v26
    v_mul_f32 v7, v7, v11
    v_mul_f32 v8, v8, v26
    v_cvt_pk_bf16_f32 v26, v7, v8
    v_cvt_pk_bf16_f32 v11, v78, v79
    v_lshlrev_b32 v7, 16, v11
    v_and_b32 v8, 0xffff0000, v11
    v_add_f32 v7, v7, v29
    v_add_f32 v8, v8, v29
    v_cvt_pk_bf16_f32 v11, v7, v8
    v_lshlrev_b32 v7, 16, v11
    v_and_b32 v8, 0xffff0000, v11
    v_lshlrev_b32 v11, 16, v27
    v_and_b32 v27, 0xffff0000, v27
    v_mul_f32 v7, v7, v11
    v_mul_f32 v8, v8, v27
    v_cvt_pk_bf16_f32 v27, v7, v8
    buffer_store_dwordx4 v[24:27], v4, s[16:19], s43 offen sc1
    s_branch k2_end
k2_kv:
    s_sub_u32 s20, s2, 224
    v_lshrrev_b32 v2, 3, v1
    v_and_b32 v3, 7, v1
    v_lshlrev_b32 v5, 11, v2
    v_lshl_add_u32 v5, v3, 4, v5
    v_mul_u32_u24 v6, 192, v2
    v_lshl_add_u32 v6, v3, 4, v6
    s_lshl_b32 s40, s23, 14
    v_add_u32 v6, s40, v6
    v_mul_u32_u24 v7, 896, v2
    v_lshl_add_u32 v7, v3, 3, v7
    v_lshlrev_b32 v8, 6, v2
    v_lshl_add_u32 v8, v3, 3, v8
    v_add_u32 v8, s40, v8
    v_add_u32 v8, 12288, v8
    v_cmp_eq_u32 s[44:45], 7, v3
    s_lshl_b32 s41, s23, 19
    s_lshl_b32 s42, s20, 7
    s_add_u32 s41, s41, s42
    s_add_u32 s41, s41, 4194304
    s_mul_i32 s42, s23, 229376
    s_mul_i32 s43, s20, 56
    s_add_u32 s42, s42, s43
    s_add_u32 s42, s42, 8388608
    v_bfe_u32 v136, v1, 4, 1
    v_lshrrev_b32 v137, 5, v1
    v_bfe_u32 v138, v1, 2, 2
    v_and_b32 v139, 3, v1
    v_lshl_add_u32 v138, v137, 3, v138
    v_mul_u32_u24 v11, 192, v138
    v_lshl_add_u32 v139, v136, 2, v139
    v_lshl_add_u32 v11, v139, 3, v11
    v_add_u32 v11, s40, v11
    v_bfe_u32 v136, v1, 4, 1
    v_lshrrev_b32 v137, 5, v1
    v_bfe_u32 v138, v1, 2, 2
    v_and_b32 v139, 3, v1
    v_lshl_add_u32 v138, v137, 3, v138
    v_mul_u32_u24 v10, 64, v138
    v_lshl_add_u32 v139, v136, 2, v139
    v_lshl_add_u32 v10, v139, 3, v10
    v_add_u32 v10, s40, v10
    v_add_u32 v10, 12288, v10
    v_mov_b32 v40, 0
    v_mov_b32 v41, 0
    v_mov_b32 v42, 0
    v_mov_b32 v43, 0
    v_mov_b32 v44, 0
    v_mov_b32 v45, 0
    v_mov_b32 v46, 0
    v_mov_b32 v47, 0
    v_mov_b32 v48, 0
    v_mov_b32 v49, 0
    v_mov_b32 v50, 0
    v_mov_b32 v51, 0
    v_mov_b32 v52, 0
    v_mov_b32 v53, 0
    v_mov_b32 v54, 0
    v_mov_b32 v55, 0
    v_mov_b32 v56, 0
    v_mov_b32 v57, 0
    v_mov_b32 v58, 0
    v_mov_b32 v59, 0
    v_mov_b32 v60, 0
    v_mov_b32 v61, 0
    v_mov_b32 v62, 0
    v_mov_b32 v63, 0
    v_mov_b32 v64, 0
    v_mov_b32 v65, 0
    v_mov_b32 v66, 0
    v_mov_b32 v67, 0
    v_mov_b32 v68, 0
    v_mov_b32 v69, 0
    v_mov_b32 v70, 0
    v_mov_b32 v71, 0
    v_mov_b32 v172, 0x00003f80
    s_add_u32 s46, s41, 0
    buffer_load_dwordx4 v[72:75], v5, s[16:19], s46 offen
    s_add_u32 s46, s41, 16384
    buffer_load_dwordx4 v[76:79], v5, s[16:19], s46 offen
    s_add_u32 s46, s41, 32768
    buffer_load_dwordx4 v[80:83], v5, s[16:19], s46 offen
    s_add_u32 s46, s41, 49152
    buffer_load_dwordx4 v[84:87], v5, s[16:19], s46 offen
    s_add_u32 s46, s41, 65536
    buffer_load_dwordx4 v[88:91], v5, s[16:19], s46 offen
    s_add_u32 s46, s41, 81920
    buffer_load_dwordx4 v[92:95], v5, s[16:19], s46 offen
    s_add_u32 s46, s41, 98304
    buffer_load_dwordx4 v[96:99], v5, s[16:19], s46 offen
    s_add_u32 s46, s41, 114688
    buffer_load_dwordx4 v[100:103], v5, s[16:19], s46 offen
    s_add_u32 s46, s42, 0
    buffer_load_dwordx2 v[120:121], v7, s[16:19], s46 offen
    s_add_u32 s46, s42, 7168
    buffer_load_dwordx2 v[122:123], v7, s[16:19], s46 offen
    s_add_u32 s46, s42, 14336
    buffer_load_dwordx2 v[124:125], v7, s[16:19], s46 offen
    s_add_u32 s46, s42, 21504
    buffer_load_dwordx2 v[126:127], v7, s[16:19], s46 offen
    s_add_u32 s46, s42, 28672
    buffer_load_dwordx2 v[128:129], v7, s[16:19], s46 offen
    s_add_u32 s46, s42, 35840
    buffer_load_dwordx2 v[130:131], v7, s[16:19], s46 offen
    s_add_u32 s46, s42, 43008
    buffer_load_dwordx2 v[132:133], v7, s[16:19], s46 offen
    s_add_u32 s46, s42, 50176
    buffer_load_dwordx2 v[134:135], v7, s[16:19], s46 offen
    s_waitcnt vmcnt(0)
    ds_write_b128 v6, v[72:75] offset:0
    ds_write_b128 v6, v[76:79] offset:1536
    ds_write_b128 v6, v[80:83] offset:3072
    ds_write_b128 v6, v[84:87] offset:4608
    ds_write_b128 v6, v[88:91] offset:6144
    ds_write_b128 v6, v[92:95] offset:7680
    ds_write_b128 v6, v[96:99] offset:9216
    ds_write_b128 v6, v[100:103] offset:10752
    v_cndmask_b32 v120, v120, v172, s[44:45]
    v_cndmask_b32 v121, v121, 0, s[44:45]
    ds_write_b64 v8, v[120:121] offset:0
    v_cndmask_b32 v122, v122, v172, s[44:45]
    v_cndmask_b32 v123, v123, 0, s[44:45]
    ds_write_b64 v8, v[122:123] offset:512
    v_cndmask_b32 v124, v124, v172, s[44:45]
    v_cndmask_b32 v125, v125, 0, s[44:45]
    ds_write_b64 v8, v[124:125] offset:1024
    v_cndmask_b32 v126, v126, v172, s[44:45]
    v_cndmask_b32 v127, v127, 0, s[44:45]
    ds_write_b64 v8, v[126:127] offset:1536
    v_cndmask_b32 v128, v128, v172, s[44:45]
    v_cndmask_b32 v129, v129, 0, s[44:45]
    ds_write_b64 v8, v[128:129] offset:2048
    v_cndmask_b32 v130, v130, v172, s[44:45]
    v_cndmask_b32 v131, v131, 0, s[44:45]
    ds_write_b64 v8, v[130:131] offset:2560
    v_cndmask_b32 v132, v132, v172, s[44:45]
    v_cndmask_b32 v133, v133, 0, s[44:45]
    ds_write_b64 v8, v[132:133] offset:3072
    v_cndmask_b32 v134, v134, v172, s[44:45]
    v_cndmask_b32 v135, v135, 0, s[44:45]
    ds_write_b64 v8, v[134:135] offset:3584
    s_waitcnt lgkmcnt(0)
    s_add_u32 s46, s41, 131072
    buffer_load_dwordx4 v[72:75], v5, s[16:19], s46 offen
    s_add_u32 s46, s41, 147456
    buffer_load_dwordx4 v[76:79], v5, s[16:19], s46 offen
    s_add_u32 s46, s41, 163840
    buffer_load_dwordx4 v[80:83], v5, s[16:19], s46 offen
    s_add_u32 s46, s41, 180224
    buffer_load_dwordx4 v[84:87], v5, s[16:19], s46 offen
    s_add_u32 s46, s41, 196608
    buffer_load_dwordx4 v[88:91], v5, s[16:19], s46 offen
    s_add_u32 s46, s41, 212992
    buffer_load_dwordx4 v[92:95], v5, s[16:19], s46 offen
    s_add_u32 s46, s41, 229376
    buffer_load_dwordx4 v[96:99], v5, s[16:19], s46 offen
    s_add_u32 s46, s41, 245760
    buffer_load_dwordx4 v[100:103], v5, s[16:19], s46 offen
    s_add_u32 s46, s42, 57344
    buffer_load_dwordx2 v[120:121], v7, s[16:19], s46 offen
    s_add_u32 s46, s42, 64512
    buffer_load_dwordx2 v[122:123], v7, s[16:19], s46 offen
    s_add_u32 s46, s42, 71680
    buffer_load_dwordx2 v[124:125], v7, s[16:19], s46 offen
    s_add_u32 s46, s42, 78848
    buffer_load_dwordx2 v[126:127], v7, s[16:19], s46 offen
    s_add_u32 s46, s42, 86016
    buffer_load_dwordx2 v[128:129], v7, s[16:19], s46 offen
    s_add_u32 s46, s42, 93184
    buffer_load_dwordx2 v[130:131], v7, s[16:19], s46 offen
    s_add_u32 s46, s42, 100352
    buffer_load_dwordx2 v[132:133], v7, s[16:19], s46 offen
    s_add_u32 s46, s42, 107520
    buffer_load_dwordx2 v[134:135], v7, s[16:19], s46 offen
    ds_read_b64_tr_b16 v[104:105], v10 offset:0
    ds_read_b64_tr_b16 v[108:109], v11 offset:0
    ds_read_b64_tr_b16 v[112:113], v11 offset:64
    ds_read_b64_tr_b16 v[106:107], v10 offset:256
    ds_read_b64_tr_b16 v[110:111], v11 offset:768
    ds_read_b64_tr_b16 v[114:115], v11 offset:832
    s_waitcnt lgkmcnt(0)
    v_mfma_f32_32x32x16_bf16 v[40:55], v[104:107], v[108:111], v[40:55]
    v_mfma_f32_32x32x16_bf16 v[56:71], v[104:107], v[112:115], v[56:71]
    ds_read_b64_tr_b16 v[104:105], v10 offset:1024
    ds_read_b64_tr_b16 v[108:109], v11 offset:3072
    ds_read_b64_tr_b16 v[112:113], v11 offset:3136
    ds_read_b64_tr_b16 v[106:107], v10 offset:1280
    ds_read_b64_tr_b16 v[110:111], v11 offset:3840
    ds_read_b64_tr_b16 v[114:115], v11 offset:3904
    s_waitcnt lgkmcnt(0)
    v_mfma_f32_32x32x16_bf16 v[40:55], v[104:107], v[108:111], v[40:55]
    v_mfma_f32_32x32x16_bf16 v[56:71], v[104:107], v[112:115], v[56:71]
    ds_read_b64_tr_b16 v[104:105], v10 offset:2048
    ds_read_b64_tr_b16 v[108:109], v11 offset:6144
    ds_read_b64_tr_b16 v[112:113], v11 offset:6208
    ds_read_b64_tr_b16 v[106:107], v10 offset:2304
    ds_read_b64_tr_b16 v[110:111], v11 offset:6912
    ds_read_b64_tr_b16 v[114:115], v11 offset:6976
    s_waitcnt lgkmcnt(0)
    v_mfma_f32_32x32x16_bf16 v[40:55], v[104:107], v[108:111], v[40:55]
    v_mfma_f32_32x32x16_bf16 v[56:71], v[104:107], v[112:115], v[56:71]
    ds_read_b64_tr_b16 v[104:105], v10 offset:3072
    ds_read_b64_tr_b16 v[108:109], v11 offset:9216
    ds_read_b64_tr_b16 v[112:113], v11 offset:9280
    ds_read_b64_tr_b16 v[106:107], v10 offset:3328
    ds_read_b64_tr_b16 v[110:111], v11 offset:9984
    ds_read_b64_tr_b16 v[114:115], v11 offset:10048
    s_waitcnt lgkmcnt(0)
    v_mfma_f32_32x32x16_bf16 v[40:55], v[104:107], v[108:111], v[40:55]
    v_mfma_f32_32x32x16_bf16 v[56:71], v[104:107], v[112:115], v[56:71]
    s_waitcnt vmcnt(0)
    ds_write_b128 v6, v[72:75] offset:0
    ds_write_b128 v6, v[76:79] offset:1536
    ds_write_b128 v6, v[80:83] offset:3072
    ds_write_b128 v6, v[84:87] offset:4608
    ds_write_b128 v6, v[88:91] offset:6144
    ds_write_b128 v6, v[92:95] offset:7680
    ds_write_b128 v6, v[96:99] offset:9216
    ds_write_b128 v6, v[100:103] offset:10752
    v_cndmask_b32 v120, v120, v172, s[44:45]
    v_cndmask_b32 v121, v121, 0, s[44:45]
    ds_write_b64 v8, v[120:121] offset:0
    v_cndmask_b32 v122, v122, v172, s[44:45]
    v_cndmask_b32 v123, v123, 0, s[44:45]
    ds_write_b64 v8, v[122:123] offset:512
    v_cndmask_b32 v124, v124, v172, s[44:45]
    v_cndmask_b32 v125, v125, 0, s[44:45]
    ds_write_b64 v8, v[124:125] offset:1024
    v_cndmask_b32 v126, v126, v172, s[44:45]
    v_cndmask_b32 v127, v127, 0, s[44:45]
    ds_write_b64 v8, v[126:127] offset:1536
    v_cndmask_b32 v128, v128, v172, s[44:45]
    v_cndmask_b32 v129, v129, 0, s[44:45]
    ds_write_b64 v8, v[128:129] offset:2048
    v_cndmask_b32 v130, v130, v172, s[44:45]
    v_cndmask_b32 v131, v131, 0, s[44:45]
    ds_write_b64 v8, v[130:131] offset:2560
    v_cndmask_b32 v132, v132, v172, s[44:45]
    v_cndmask_b32 v133, v133, 0, s[44:45]
    ds_write_b64 v8, v[132:133] offset:3072
    v_cndmask_b32 v134, v134, v172, s[44:45]
    v_cndmask_b32 v135, v135, 0, s[44:45]
    ds_write_b64 v8, v[134:135] offset:3584
    s_waitcnt lgkmcnt(0)
    s_add_u32 s46, s41, 262144
    buffer_load_dwordx4 v[72:75], v5, s[16:19], s46 offen
    s_add_u32 s46, s41, 278528
    buffer_load_dwordx4 v[76:79], v5, s[16:19], s46 offen
    s_add_u32 s46, s41, 294912
    buffer_load_dwordx4 v[80:83], v5, s[16:19], s46 offen
    s_add_u32 s46, s41, 311296
    buffer_load_dwordx4 v[84:87], v5, s[16:19], s46 offen
    s_add_u32 s46, s41, 327680
    buffer_load_dwordx4 v[88:91], v5, s[16:19], s46 offen
    s_add_u32 s46, s41, 344064
    buffer_load_dwordx4 v[92:95], v5, s[16:19], s46 offen
    s_add_u32 s46, s41, 360448
    buffer_load_dwordx4 v[96:99], v5, s[16:19], s46 offen
    s_add_u32 s46, s41, 376832
    buffer_load_dwordx4 v[100:103], v5, s[16:19], s46 offen
    s_add_u32 s46, s42, 114688
    buffer_load_dwordx2 v[120:121], v7, s[16:19], s46 offen
    s_add_u32 s46, s42, 121856
    buffer_load_dwordx2 v[122:123], v7, s[16:19], s46 offen
    s_add_u32 s46, s42, 129024
    buffer_load_dwordx2 v[124:125], v7, s[16:19], s46 offen
    s_add_u32 s46, s42, 136192
    buffer_load_dwordx2 v[126:127], v7, s[16:19], s46 offen
    s_add_u32 s46, s42, 143360
    buffer_load_dwordx2 v[128:129], v7, s[16:19], s46 offen
    s_add_u32 s46, s42, 150528
    buffer_load_dwordx2 v[130:131], v7, s[16:19], s46 offen
    s_add_u32 s46, s42, 157696
    buffer_load_dwordx2 v[132:133], v7, s[16:19], s46 offen
    s_add_u32 s46, s42, 164864
    buffer_load_dwordx2 v[134:135], v7, s[16:19], s46 offen
    ds_read_b64_tr_b16 v[104:105], v10 offset:0
    ds_read_b64_tr_b16 v[108:109], v11 offset:0
    ds_read_b64_tr_b16 v[112:113], v11 offset:64
    ds_read_b64_tr_b16 v[106:107], v10 offset:256
    ds_read_b64_tr_b16 v[110:111], v11 offset:768
    ds_read_b64_tr_b16 v[114:115], v11 offset:832
    s_waitcnt lgkmcnt(0)
    v_mfma_f32_32x32x16_bf16 v[40:55], v[104:107], v[108:111], v[40:55]
    v_mfma_f32_32x32x16_bf16 v[56:71], v[104:107], v[112:115], v[56:71]
    ds_read_b64_tr_b16 v[104:105], v10 offset:1024
    ds_read_b64_tr_b16 v[108:109], v11 offset:3072
    ds_read_b64_tr_b16 v[112:113], v11 offset:3136
    ds_read_b64_tr_b16 v[106:107], v10 offset:1280
    ds_read_b64_tr_b16 v[110:111], v11 offset:3840
    ds_read_b64_tr_b16 v[114:115], v11 offset:3904
    s_waitcnt lgkmcnt(0)
    v_mfma_f32_32x32x16_bf16 v[40:55], v[104:107], v[108:111], v[40:55]
    v_mfma_f32_32x32x16_bf16 v[56:71], v[104:107], v[112:115], v[56:71]
    ds_read_b64_tr_b16 v[104:105], v10 offset:2048
    ds_read_b64_tr_b16 v[108:109], v11 offset:6144
    ds_read_b64_tr_b16 v[112:113], v11 offset:6208
    ds_read_b64_tr_b16 v[106:107], v10 offset:2304
    ds_read_b64_tr_b16 v[110:111], v11 offset:6912
    ds_read_b64_tr_b16 v[114:115], v11 offset:6976
    s_waitcnt lgkmcnt(0)
    v_mfma_f32_32x32x16_bf16 v[40:55], v[104:107], v[108:111], v[40:55]
    v_mfma_f32_32x32x16_bf16 v[56:71], v[104:107], v[112:115], v[56:71]
    ds_read_b64_tr_b16 v[104:105], v10 offset:3072
    ds_read_b64_tr_b16 v[108:109], v11 offset:9216
    ds_read_b64_tr_b16 v[112:113], v11 offset:9280
    ds_read_b64_tr_b16 v[106:107], v10 offset:3328
    ds_read_b64_tr_b16 v[110:111], v11 offset:9984
    ds_read_b64_tr_b16 v[114:115], v11 offset:10048
    s_waitcnt lgkmcnt(0)
    v_mfma_f32_32x32x16_bf16 v[40:55], v[104:107], v[108:111], v[40:55]
    v_mfma_f32_32x32x16_bf16 v[56:71], v[104:107], v[112:115], v[56:71]
    s_waitcnt vmcnt(0)
    ds_write_b128 v6, v[72:75] offset:0
    ds_write_b128 v6, v[76:79] offset:1536
    ds_write_b128 v6, v[80:83] offset:3072
    ds_write_b128 v6, v[84:87] offset:4608
    ds_write_b128 v6, v[88:91] offset:6144
    ds_write_b128 v6, v[92:95] offset:7680
    ds_write_b128 v6, v[96:99] offset:9216
    ds_write_b128 v6, v[100:103] offset:10752
    v_cndmask_b32 v120, v120, v172, s[44:45]
    v_cndmask_b32 v121, v121, 0, s[44:45]
    ds_write_b64 v8, v[120:121] offset:0
    v_cndmask_b32 v122, v122, v172, s[44:45]
    v_cndmask_b32 v123, v123, 0, s[44:45]
    ds_write_b64 v8, v[122:123] offset:512
    v_cndmask_b32 v124, v124, v172, s[44:45]
    v_cndmask_b32 v125, v125, 0, s[44:45]
    ds_write_b64 v8, v[124:125] offset:1024
    v_cndmask_b32 v126, v126, v172, s[44:45]
    v_cndmask_b32 v127, v127, 0, s[44:45]
    ds_write_b64 v8, v[126:127] offset:1536
    v_cndmask_b32 v128, v128, v172, s[44:45]
    v_cndmask_b32 v129, v129, 0, s[44:45]
    ds_write_b64 v8, v[128:129] offset:2048
    v_cndmask_b32 v130, v130, v172, s[44:45]
    v_cndmask_b32 v131, v131, 0, s[44:45]
    ds_write_b64 v8, v[130:131] offset:2560
    v_cndmask_b32 v132, v132, v172, s[44:45]
    v_cndmask_b32 v133, v133, 0, s[44:45]
    ds_write_b64 v8, v[132:133] offset:3072
    v_cndmask_b32 v134, v134, v172, s[44:45]
    v_cndmask_b32 v135, v135, 0, s[44:45]
    ds_write_b64 v8, v[134:135] offset:3584
    s_waitcnt lgkmcnt(0)
    s_add_u32 s46, s41, 393216
    buffer_load_dwordx4 v[72:75], v5, s[16:19], s46 offen
    s_add_u32 s46, s41, 409600
    buffer_load_dwordx4 v[76:79], v5, s[16:19], s46 offen
    s_add_u32 s46, s41, 425984
    buffer_load_dwordx4 v[80:83], v5, s[16:19], s46 offen
    s_add_u32 s46, s41, 442368
    buffer_load_dwordx4 v[84:87], v5, s[16:19], s46 offen
    s_add_u32 s46, s41, 458752
    buffer_load_dwordx4 v[88:91], v5, s[16:19], s46 offen
    s_add_u32 s46, s41, 475136
    buffer_load_dwordx4 v[92:95], v5, s[16:19], s46 offen
    s_add_u32 s46, s41, 491520
    buffer_load_dwordx4 v[96:99], v5, s[16:19], s46 offen
    s_add_u32 s46, s41, 507904
    buffer_load_dwordx4 v[100:103], v5, s[16:19], s46 offen
    s_add_u32 s46, s42, 172032
    buffer_load_dwordx2 v[120:121], v7, s[16:19], s46 offen
    s_add_u32 s46, s42, 179200
    buffer_load_dwordx2 v[122:123], v7, s[16:19], s46 offen
    s_add_u32 s46, s42, 186368
    buffer_load_dwordx2 v[124:125], v7, s[16:19], s46 offen
    s_add_u32 s46, s42, 193536
    buffer_load_dwordx2 v[126:127], v7, s[16:19], s46 offen
    s_add_u32 s46, s42, 200704
    buffer_load_dwordx2 v[128:129], v7, s[16:19], s46 offen
    s_add_u32 s46, s42, 207872
    buffer_load_dwordx2 v[130:131], v7, s[16:19], s46 offen
    s_add_u32 s46, s42, 215040
    buffer_load_dwordx2 v[132:133], v7, s[16:19], s46 offen
    s_add_u32 s46, s42, 222208
    buffer_load_dwordx2 v[134:135], v7, s[16:19], s46 offen
    ds_read_b64_tr_b16 v[104:105], v10 offset:0
    ds_read_b64_tr_b16 v[108:109], v11 offset:0
    ds_read_b64_tr_b16 v[112:113], v11 offset:64
    ds_read_b64_tr_b16 v[106:107], v10 offset:256
    ds_read_b64_tr_b16 v[110:111], v11 offset:768
    ds_read_b64_tr_b16 v[114:115], v11 offset:832
    s_waitcnt lgkmcnt(0)
    v_mfma_f32_32x32x16_bf16 v[40:55], v[104:107], v[108:111], v[40:55]
    v_mfma_f32_32x32x16_bf16 v[56:71], v[104:107], v[112:115], v[56:71]
    ds_read_b64_tr_b16 v[104:105], v10 offset:1024
    ds_read_b64_tr_b16 v[108:109], v11 offset:3072
    ds_read_b64_tr_b16 v[112:113], v11 offset:3136
    ds_read_b64_tr_b16 v[106:107], v10 offset:1280
    ds_read_b64_tr_b16 v[110:111], v11 offset:3840
    ds_read_b64_tr_b16 v[114:115], v11 offset:3904
    s_waitcnt lgkmcnt(0)
    v_mfma_f32_32x32x16_bf16 v[40:55], v[104:107], v[108:111], v[40:55]
    v_mfma_f32_32x32x16_bf16 v[56:71], v[104:107], v[112:115], v[56:71]
    ds_read_b64_tr_b16 v[104:105], v10 offset:2048
    ds_read_b64_tr_b16 v[108:109], v11 offset:6144
    ds_read_b64_tr_b16 v[112:113], v11 offset:6208
    ds_read_b64_tr_b16 v[106:107], v10 offset:2304
    ds_read_b64_tr_b16 v[110:111], v11 offset:6912
    ds_read_b64_tr_b16 v[114:115], v11 offset:6976
    s_waitcnt lgkmcnt(0)
    v_mfma_f32_32x32x16_bf16 v[40:55], v[104:107], v[108:111], v[40:55]
    v_mfma_f32_32x32x16_bf16 v[56:71], v[104:107], v[112:115], v[56:71]
    ds_read_b64_tr_b16 v[104:105], v10 offset:3072
    ds_read_b64_tr_b16 v[108:109], v11 offset:9216
    ds_read_b64_tr_b16 v[112:113], v11 offset:9280
    ds_read_b64_tr_b16 v[106:107], v10 offset:3328
    ds_read_b64_tr_b16 v[110:111], v11 offset:9984
    ds_read_b64_tr_b16 v[114:115], v11 offset:10048
    s_waitcnt lgkmcnt(0)
    v_mfma_f32_32x32x16_bf16 v[40:55], v[104:107], v[108:111], v[40:55]
    v_mfma_f32_32x32x16_bf16 v[56:71], v[104:107], v[112:115], v[56:71]
    s_waitcnt vmcnt(0)
    ds_write_b128 v6, v[72:75] offset:0
    ds_write_b128 v6, v[76:79] offset:1536
    ds_write_b128 v6, v[80:83] offset:3072
    ds_write_b128 v6, v[84:87] offset:4608
    ds_write_b128 v6, v[88:91] offset:6144
    ds_write_b128 v6, v[92:95] offset:7680
    ds_write_b128 v6, v[96:99] offset:9216
    ds_write_b128 v6, v[100:103] offset:10752
    v_cndmask_b32 v120, v120, v172, s[44:45]
    v_cndmask_b32 v121, v121, 0, s[44:45]
    ds_write_b64 v8, v[120:121] offset:0
    v_cndmask_b32 v122, v122, v172, s[44:45]
    v_cndmask_b32 v123, v123, 0, s[44:45]
    ds_write_b64 v8, v[122:123] offset:512
    v_cndmask_b32 v124, v124, v172, s[44:45]
    v_cndmask_b32 v125, v125, 0, s[44:45]
    ds_write_b64 v8, v[124:125] offset:1024
    v_cndmask_b32 v126, v126, v172, s[44:45]
    v_cndmask_b32 v127, v127, 0, s[44:45]
    ds_write_b64 v8, v[126:127] offset:1536
    v_cndmask_b32 v128, v128, v172, s[44:45]
    v_cndmask_b32 v129, v129, 0, s[44:45]
    ds_write_b64 v8, v[128:129] offset:2048
    v_cndmask_b32 v130, v130, v172, s[44:45]
    v_cndmask_b32 v131, v131, 0, s[44:45]
    ds_write_b64 v8, v[130:131] offset:2560
    v_cndmask_b32 v132, v132, v172, s[44:45]
    v_cndmask_b32 v133, v133, 0, s[44:45]
    ds_write_b64 v8, v[132:133] offset:3072
    v_cndmask_b32 v134, v134, v172, s[44:45]
    v_cndmask_b32 v135, v135, 0, s[44:45]
    ds_write_b64 v8, v[134:135] offset:3584
    s_waitcnt lgkmcnt(0)
    ds_read_b64_tr_b16 v[104:105], v10 offset:0
    ds_read_b64_tr_b16 v[108:109], v11 offset:0
    ds_read_b64_tr_b16 v[112:113], v11 offset:64
    ds_read_b64_tr_b16 v[106:107], v10 offset:256
    ds_read_b64_tr_b16 v[110:111], v11 offset:768
    ds_read_b64_tr_b16 v[114:115], v11 offset:832
    s_waitcnt lgkmcnt(0)
    v_mfma_f32_32x32x16_bf16 v[40:55], v[104:107], v[108:111], v[40:55]
    v_mfma_f32_32x32x16_bf16 v[56:71], v[104:107], v[112:115], v[56:71]
    ds_read_b64_tr_b16 v[104:105], v10 offset:1024
    ds_read_b64_tr_b16 v[108:109], v11 offset:3072
    ds_read_b64_tr_b16 v[112:113], v11 offset:3136
    ds_read_b64_tr_b16 v[106:107], v10 offset:1280
    ds_read_b64_tr_b16 v[110:111], v11 offset:3840
    ds_read_b64_tr_b16 v[114:115], v11 offset:3904
    s_waitcnt lgkmcnt(0)
    v_mfma_f32_32x32x16_bf16 v[40:55], v[104:107], v[108:111], v[40:55]
    v_mfma_f32_32x32x16_bf16 v[56:71], v[104:107], v[112:115], v[56:71]
    ds_read_b64_tr_b16 v[104:105], v10 offset:2048
    ds_read_b64_tr_b16 v[108:109], v11 offset:6144
    ds_read_b64_tr_b16 v[112:113], v11 offset:6208
    ds_read_b64_tr_b16 v[106:107], v10 offset:2304
    ds_read_b64_tr_b16 v[110:111], v11 offset:6912
    ds_read_b64_tr_b16 v[114:115], v11 offset:6976
    s_waitcnt lgkmcnt(0)
    v_mfma_f32_32x32x16_bf16 v[40:55], v[104:107], v[108:111], v[40:55]
    v_mfma_f32_32x32x16_bf16 v[56:71], v[104:107], v[112:115], v[56:71]
    ds_read_b64_tr_b16 v[104:105], v10 offset:3072
    ds_read_b64_tr_b16 v[108:109], v11 offset:9216
    ds_read_b64_tr_b16 v[112:113], v11 offset:9280
    ds_read_b64_tr_b16 v[106:107], v10 offset:3328
    ds_read_b64_tr_b16 v[110:111], v11 offset:9984
    ds_read_b64_tr_b16 v[114:115], v11 offset:10048
    s_waitcnt lgkmcnt(0)
    v_mfma_f32_32x32x16_bf16 v[40:55], v[104:107], v[108:111], v[40:55]
    v_mfma_f32_32x32x16_bf16 v[56:71], v[104:107], v[112:115], v[56:71]
    s_nop 15
    s_barrier
    v_and_b32 v2, 31, v1
    v_lshrrev_b32 v3, 5, v1
    v_lshlrev_b32 v5, 2, v2
    v_lshl_add_u32 v5, v3, 10, v5
    s_lshl_b32 s40, s23, 13
    v_add_u32 v5, s40, v5
    ds_write_b32 v5, v40 offset:0
    ds_write_b32 v5, v41 offset:256
    ds_write_b32 v5, v42 offset:512
    ds_write_b32 v5, v43 offset:768
    ds_write_b32 v5, v44 offset:2048
    ds_write_b32 v5, v45 offset:2304
    ds_write_b32 v5, v46 offset:2560
    ds_write_b32 v5, v47 offset:2816
    ds_write_b32 v5, v48 offset:4096
    ds_write_b32 v5, v49 offset:4352
    ds_write_b32 v5, v50 offset:4608
    ds_write_b32 v5, v51 offset:4864
    ds_write_b32 v5, v52 offset:6144
    ds_write_b32 v5, v53 offset:6400
    ds_write_b32 v5, v54 offset:6656
    ds_write_b32 v5, v55 offset:6912
    ds_write_b32 v5, v56 offset:128
    ds_write_b32 v5, v57 offset:384
    ds_write_b32 v5, v58 offset:640
    ds_write_b32 v5, v59 offset:896
    ds_write_b32 v5, v60 offset:2176
    ds_write_b32 v5, v61 offset:2432
    ds_write_b32 v5, v62 offset:2688
    ds_write_b32 v5, v63 offset:2944
    ds_write_b32 v5, v64 offset:4224
    ds_write_b32 v5, v65 offset:4480
    ds_write_b32 v5, v66 offset:4736
    ds_write_b32 v5, v67 offset:4992
    ds_write_b32 v5, v68 offset:6272
    ds_write_b32 v5, v69 offset:6528
    ds_write_b32 v5, v70 offset:6784
    ds_write_b32 v5, v71 offset:7040
    s_waitcnt lgkmcnt(0)
    s_barrier
    v_lshlrev_b32 v5, 4, v0
    ds_read_b128 v[136:139], v5 offset:0
    ds_read_b128 v[140:143], v5 offset:8192
    ds_read_b128 v[144:147], v5 offset:16384
    ds_read_b128 v[148:151], v5 offset:24576
    ds_read_b128 v[152:155], v5 offset:32768
    ds_read_b128 v[156:159], v5 offset:40960
    ds_read_b128 v[160:163], v5 offset:49152
    ds_read_b128 v[164:167], v5 offset:57344
    s_waitcnt lgkmcnt(0)
    v_add_f32 v136, v136, v140
    v_add_f32 v137, v137, v141
    v_add_f32 v138, v138, v142
    v_add_f32 v139, v139, v143
    v_add_f32 v136, v136, v144
    v_add_f32 v137, v137, v145
    v_add_f32 v138, v138, v146
    v_add_f32 v139, v139, v147
    v_add_f32 v136, v136, v148
    v_add_f32 v137, v137, v149
    v_add_f32 v138, v138, v150
    v_add_f32 v139, v139, v151
    v_add_f32 v136, v136, v152
    v_add_f32 v137, v137, v153
    v_add_f32 v138, v138, v154
    v_add_f32 v139, v139, v155
    v_add_f32 v136, v136, v156
    v_add_f32 v137, v137, v157
    v_add_f32 v138, v138, v158
    v_add_f32 v139, v139, v159
    v_add_f32 v136, v136, v160
    v_add_f32 v137, v137, v161
    v_add_f32 v138, v138, v162
    v_add_f32 v139, v139, v163
    v_add_f32 v136, v136, v164
    v_add_f32 v137, v137, v165
    v_add_f32 v138, v138, v166
    v_add_f32 v139, v139, v167
    v_cvt_pk_bf16_f32 v136, v136, v137
    v_cvt_pk_bf16_f32 v137, v138, v139
    v_bfe_u32 v6, v0, 2, 2
    v_bfe_u32 v7, v0, 1, 1
    v_and_b32 v8, 1, v0
    v_lshrrev_b32 v9, 4, v0
    v_lshl_add_u32 v9, v7, 5, v9
    v_lshlrev_b32 v5, 4, v9
    v_lshl_add_u32 v5, v6, 10, v5
    v_lshl_add_u32 v5, v8, 3, v5
    s_lshl_b32 s40, s20, 12
    s_add_u32 s40, s40, 21368832
    buffer_store_dwordx2 v[136:137], v5, s[16:19], s40 offen sc1
k2_end:
k2_end_x:
    s_endpgm
.p2align 8
.globl k3_out_kernel
.type k3_out_kernel,@function
k3_out_kernel:
    s_cmp_ge_u32 s2, 224
    s_cbranch_scc1 k3_end_x
    s_load_dwordx2 s[24:25], s[0:1], 0
    s_load_dwordx2 s[26:27], s[0:1], 24
    s_load_dwordx4 s[28:31], s[0:1], 64
    s_load_dwordx2 s[32:33], s[0:1], 88
    v_and_b32 v1, 63, v0
    v_lshrrev_b32 v2, 6, v0
    s_nop 0
    v_readfirstlane_b32 s23, v2
    s_and_b32 s20, s2, 7
    s_lshl_b32 s20, s20, 2
    s_lshr_b32 s21, s2, 3
    s_and_b32 s34, s21, 3
    s_add_u32 s20, s20, s34
    s_lshr_b32 s21, s2, 5
    v_lshrrev_b32 v2, 3, v1
    v_lshrrev_b32 v3, 4, v1
    v_and_b32 v4, 7, v1
    v_and_b32 v5, 31, v1
    v_lshrrev_b32 v6, 5, v1
    v_lshlrev_b32 v7, 4, v1
    s_lshl_b32 s41, s20, 17
    s_lshl_b32 s42, s23, 13
    s_add_u32 s41, s41, s42
    s_add_u32 s41, s41, 0
    s_add_u32 s40, s42, 21368832
    s_waitcnt lgkmcnt(0)
    s_mov_b32 s16, s32
    s_and_b32 s17, s33, 0xffff
    s_mov_b32 s18, 268435456
    s_mov_b32 s19, 0x00020000
    s_add_u32 s46, s40, 0
    buffer_load_dwordx4 v[64:67], v7, s[16:19], s46 offen
    s_add_u32 s46, s40, 1024
    buffer_load_dwordx4 v[68:71], v7, s[16:19], s46 offen
    s_add_u32 s46, s40, 2048
    buffer_load_dwordx4 v[72:75], v7, s[16:19], s46 offen
    s_add_u32 s46, s40, 3072
    buffer_load_dwordx4 v[76:79], v7, s[16:19], s46 offen
    s_add_u32 s46, s41, 0
    buffer_load_dwordx4 v[80:83], v7, s[16:19], s46 offen
    s_add_u32 s46, s41, 1024
    buffer_load_dwordx4 v[84:87], v7, s[16:19], s46 offen
    s_add_u32 s46, s41, 2048
    buffer_load_dwordx4 v[88:91], v7, s[16:19], s46 offen
    s_add_u32 s46, s41, 3072
    buffer_load_dwordx4 v[92:95], v7, s[16:19], s46 offen
    s_add_u32 s46, s41, 65536
    buffer_load_dwordx4 v[96:99], v7, s[16:19], s46 offen
    s_add_u32 s46, s41, 66560
    buffer_load_dwordx4 v[100:103], v7, s[16:19], s46 offen
    s_add_u32 s46, s41, 67584
    buffer_load_dwordx4 v[104:107], v7, s[16:19], s46 offen
    s_add_u32 s46, s41, 68608
    buffer_load_dwordx4 v[108:111], v7, s[16:19], s46 offen
    s_add_u32 s46, s40, 4096
    buffer_load_dwordx4 v[112:115], v7, s[16:19], s46 offen
    s_add_u32 s46, s40, 5120
    buffer_load_dwordx4 v[116:119], v7, s[16:19], s46 offen
    s_add_u32 s46, s40, 6144
    buffer_load_dwordx4 v[120:123], v7, s[16:19], s46 offen
    s_add_u32 s46, s40, 7168
    buffer_load_dwordx4 v[124:127], v7, s[16:19], s46 offen
    s_add_u32 s46, s41, 4096
    buffer_load_dwordx4 v[128:131], v7, s[16:19], s46 offen
    s_add_u32 s46, s41, 5120
    buffer_load_dwordx4 v[132:135], v7, s[16:19], s46 offen
    s_add_u32 s46, s41, 6144
    buffer_load_dwordx4 v[136:139], v7, s[16:19], s46 offen
    s_add_u32 s46, s41, 7168
    buffer_load_dwordx4 v[140:143], v7, s[16:19], s46 offen
    s_add_u32 s46, s41, 69632
    buffer_load_dwordx4 v[144:147], v7, s[16:19], s46 offen
    s_add_u32 s46, s41, 70656
    buffer_load_dwordx4 v[148:151], v7, s[16:19], s46 offen
    s_add_u32 s46, s41, 71680
    buffer_load_dwordx4 v[152:155], v7, s[16:19], s46 offen
    s_add_u32 s46, s41, 72704
    buffer_load_dwordx4 v[156:159], v7, s[16:19], s46 offen
    s_mov_b32 s4, s24
    s_and_b32 s5, s25, 0xffff
    s_mov_b32 s6, 1835008
    s_mov_b32 s7, 0x00020000
    s_mov_b32 s8, s26
    s_and_b32 s9, s27, 0xffff
    s_mov_b32 s10, 401408
    s_mov_b32 s11, 0x00020000
    s_mov_b32 s12, s28
    s_and_b32 s13, s29, 0xffff
    s_mov_b32 s14, 802816
    s_mov_b32 s15, 0x00020000
    s_mov_b32 s48, s30
    s_and_b32 s49, s31, 0xffff
    s_mov_b32 s50, 1835008
    s_mov_b32 s51, 0x00020000
    v_and_b32 v8, 1, v3
    v_lshlrev_b32 v8, 2, v8
    v_xor_b32 v8, v8, v4
    s_lshl_b32 s34, s23, 3
    v_add_u32 v9, s34, v2
    v_mul_u32_u24 v12, 896, v9
    v_lshl_add_u32 v12, v8, 4, v12
    s_lshl_b32 s34, s21, 7
    v_add_u32 v12, s34, v12
    s_lshl_b32 s34, s23, 2
    v_add_u32 v8, s34, v3
    v_and_b32 v8, 7, v8
    v_xor_b32 v8, v8, v4
    v_mul_u32_u24 v13, 1792, v9
    v_lshl_add_u32 v13, v8, 4, v13
    s_mul_i32 s34, s20, 114688
    s_add_u32 s34, s34, 17567744
    v_add_u32 v13, s34, v13
    s_lshl_b32 s47, s23, 10
    s_add_u32 m0, s47, 91136
    s_mov_b32 s36, 0
    buffer_load_dwordx4 v12, s[8:11], s36 offen lds
    s_add_u32 m0, s47, 99328
    s_mov_b32 s36, 57344
    buffer_load_dwordx4 v12, s[8:11], s36 offen lds
    s_add_u32 m0, s47, 107520
    s_mov_b32 s36, 114688
    buffer_load_dwordx4 v12, s[8:11], s36 offen lds
    v_mul_u32_u24 v10, 912, v5
    v_lshl_add_u32 v10, v6, 3, v10
    s_mul_i32 s43, s23, 112
    v_add_u32 v10, s43, v10
    s_waitcnt vmcnt(15)
    v_mfma_f32_32x32x16_bf16 v[20:35], v[64:67], v[80:83], 0
    v_mfma_f32_32x32x16_bf16 v[20:35], v[68:71], v[84:87], v[20:35]
    v_mfma_f32_32x32x16_bf16 v[20:35], v[72:75], v[88:91], v[20:35]
    v_mfma_f32_32x32x16_bf16 v[20:35], v[76:79], v[92:95], v[20:35]
    v_mfma_f32_32x32x16_bf16 v[36:51], v[64:67], v[96:99], 0
    v_mfma_f32_32x32x16_bf16 v[36:51], v[68:71], v[100:103], v[36:51]
    v_mfma_f32_32x32x16_bf16 v[36:51], v[72:75], v[104:107], v[36:51]
    v_mfma_f32_32x32x16_bf16 v[36:51], v[76:79], v[108:111], v[36:51]
    s_nop 11
    v_mov_b32 v7, v32
    v_mov_b32 v8, v32
    s_nop 1
    v_permlane32_swap_b32 v7, v8
    s_nop 1
    v_cvt_pk_bf16_f32 v9, v8, v8
    v_lshlrev_b32 v9, 16, v9
    v_add_f32 v9, 897988541, v9
    v_cvt_pk_bf16_f32 v9, v9, v9
    v_lshlrev_b32 v9, 16, v9
    v_rcp_f32 v9, v9
    v_cvt_pk_bf16_f32 v7, v20, v21
    v_lshlrev_b32 v20, 16, v7
    v_and_b32 v21, 0xffff0000, v7
    v_cvt_pk_bf16_f32 v7, v22, v23
    v_lshlrev_b32 v22, 16, v7
    v_and_b32 v23, 0xffff0000, v7
    v_cvt_pk_bf16_f32 v7, v24, v25
    v_lshlrev_b32 v24, 16, v7
    v_and_b32 v25, 0xffff0000, v7
    v_cvt_pk_bf16_f32 v7, v26, v27
    v_lshlrev_b32 v26, 16, v7
    v_and_b32 v27, 0xffff0000, v7
    v_cvt_pk_bf16_f32 v7, v28, v29
    v_lshlrev_b32 v28, 16, v7
    v_and_b32 v29, 0xffff0000, v7
    v_cvt_pk_bf16_f32 v7, v30, v31
    v_lshlrev_b32 v30, 16, v7
    v_and_b32 v31, 0xffff0000, v7
    v_cvt_pk_bf16_f32 v7, v32, v33
    v_lshlrev_b32 v32, 16, v7
    v_and_b32 v33, 0xffff0000, v7
    v_cvt_pk_bf16_f32 v7, v34, v35
    v_lshlrev_b32 v34, 16, v7
    v_and_b32 v35, 0xffff0000, v7
    v_mul_f32 v20, v20, v9
    v_mul_f32 v21, v21, v9
    v_mul_f32 v22, v22, v9
    v_mul_f32 v23, v23, v9
    v_mul_f32 v24, v24, v9
    v_mul_f32 v25, v25, v9
    v_mul_f32 v26, v26, v9
    v_mul_f32 v27, v27, v9
    v_mul_f32 v28, v28, v9
    v_mul_f32 v29, v29, v9
    v_mul_f32 v30, v30, v9
    v_mul_f32 v31, v31, v9
    v_mul_f32 v32, v32, v9
    v_mul_f32 v33, v33, v9
    v_mul_f32 v34, v34, v9
    v_mul_f32 v35, v35, v9
    v_cvt_pk_bf16_f32 v20, v20, v21
    v_cvt_pk_bf16_f32 v21, v22, v23
    v_cvt_pk_bf16_f32 v22, v24, v25
    v_cvt_pk_bf16_f32 v23, v26, v27
    v_cvt_pk_bf16_f32 v24, v28, v29
    v_cvt_pk_bf16_f32 v25, v30, v31
    v_cvt_pk_bf16_f32 v26, v32, v33
    v_cvt_pk_bf16_f32 v27, v34, v35
    ds_write_b64 v10, v[20:21] offset:0
    ds_write_b64 v10, v[22:23] offset:16
    ds_write_b64 v10, v[24:25] offset:32
    s_mov_b64 exec, 0xffffffff
    ds_write_b64 v10, v[26:27] offset:48
    s_mov_b64 exec, -1
    v_mov_b32 v7, v48
    v_mov_b32 v8, v48
    s_nop 1
    v_permlane32_swap_b32 v7, v8
    s_nop 1
    v_cvt_pk_bf16_f32 v9, v8, v8
    v_lshlrev_b32 v9, 16, v9
    v_add_f32 v9, 897988541, v9
    v_cvt_pk_bf16_f32 v9, v9, v9
    v_lshlrev_b32 v9, 16, v9
    v_rcp_f32 v9, v9
    v_cvt_pk_bf16_f32 v7, v36, v37
    v_lshlrev_b32 v36, 16, v7
    v_and_b32 v37, 0xffff0000, v7
    v_cvt_pk_bf16_f32 v7, v38, v39
    v_lshlrev_b32 v38, 16, v7
    v_and_b32 v39, 0xffff0000, v7
    v_cvt_pk_bf16_f32 v7, v40, v41
    v_lshlrev_b32 v40, 16, v7
    v_and_b32 v41, 0xffff0000, v7
    v_cvt_pk_bf16_f32 v7, v42, v43
    v_lshlrev_b32 v42, 16, v7
    v_and_b32 v43, 0xffff0000, v7
    v_cvt_pk_bf16_f32 v7, v44, v45
    v_lshlrev_b32 v44, 16, v7
    v_and_b32 v45, 0xffff0000, v7
    v_cvt_pk_bf16_f32 v7, v46, v47
    v_lshlrev_b32 v46, 16, v7
    v_and_b32 v47, 0xffff0000, v7
    v_cvt_pk_bf16_f32 v7, v48, v49
    v_lshlrev_b32 v48, 16, v7
    v_and_b32 v49, 0xffff0000, v7
    v_cvt_pk_bf16_f32 v7, v50, v51
    v_lshlrev_b32 v50, 16, v7
    v_and_b32 v51, 0xffff0000, v7
    v_mul_f32 v36, v36, v9
    v_mul_f32 v37, v37, v9
    v_mul_f32 v38, v38, v9
    v_mul_f32 v39, v39, v9
    v_mul_f32 v40, v40, v9
    v_mul_f32 v41, v41, v9
    v_mul_f32 v42, v42, v9
    v_mul_f32 v43, v43, v9
    v_mul_f32 v44, v44, v9
    v_mul_f32 v45, v45, v9
    v_mul_f32 v46, v46, v9
    v_mul_f32 v47, v47, v9
    v_mul_f32 v48, v48, v9
    v_mul_f32 v49, v49, v9
    v_mul_f32 v50, v50, v9
    v_mul_f32 v51, v51, v9
    v_cvt_pk_bf16_f32 v36, v36, v37
    v_cvt_pk_bf16_f32 v37, v38, v39
    v_cvt_pk_bf16_f32 v38, v40, v41
    v_cvt_pk_bf16_f32 v39, v42, v43
    v_cvt_pk_bf16_f32 v40, v44, v45
    v_cvt_pk_bf16_f32 v41, v46, v47
    v_cvt_pk_bf16_f32 v42, v48, v49
    v_cvt_pk_bf16_f32 v43, v50, v51
    ds_write_b64 v10, v[36:37] offset:29184
    ds_write_b64 v10, v[38:39] offset:29200
    ds_write_b64 v10, v[40:41] offset:29216
    s_mov_b64 exec, 0xffffffff
    ds_write_b64 v10, v[42:43] offset:29232
    s_mov_b64 exec, -1
    s_waitcnt vmcnt(3)
    v_mfma_f32_32x32x16_bf16 v[20:35], v[112:115], v[128:131], 0
    v_mfma_f32_32x32x16_bf16 v[20:35], v[116:119], v[132:135], v[20:35]
    v_mfma_f32_32x32x16_bf16 v[20:35], v[120:123], v[136:139], v[20:35]
    v_mfma_f32_32x32x16_bf16 v[20:35], v[124:127], v[140:143], v[20:35]
    v_mfma_f32_32x32x16_bf16 v[36:51], v[112:115], v[144:147], 0
    v_mfma_f32_32x32x16_bf16 v[36:51], v[116:119], v[148:151], v[36:51]
    v_mfma_f32_32x32x16_bf16 v[36:51], v[120:123], v[152:155], v[36:51]
    v_mfma_f32_32x32x16_bf16 v[36:51], v[124:127], v[156:159], v[36:51]
    s_nop 11
    v_mov_b32 v7, v32
    v_mov_b32 v8, v32
    s_nop 1
    v_permlane32_swap_b32 v7, v8
    s_nop 1
    v_cvt_pk_bf16_f32 v9, v8, v8
    v_lshlrev_b32 v9, 16, v9
    v_add_f32 v9, 897988541, v9
    v_cvt_pk_bf16_f32 v9, v9, v9
    v_lshlrev_b32 v9, 16, v9
    v_rcp_f32 v9, v9
    v_cvt_pk_bf16_f32 v7, v20, v21
    v_lshlrev_b32 v20, 16, v7
    v_and_b32 v21, 0xffff0000, v7
    v_cvt_pk_bf16_f32 v7, v22, v23
    v_lshlrev_b32 v22, 16, v7
    v_and_b32 v23, 0xffff0000, v7
    v_cvt_pk_bf16_f32 v7, v24, v25
    v_lshlrev_b32 v24, 16, v7
    v_and_b32 v25, 0xffff0000, v7
    v_cvt_pk_bf16_f32 v7, v26, v27
    v_lshlrev_b32 v26, 16, v7
    v_and_b32 v27, 0xffff0000, v7
    v_cvt_pk_bf16_f32 v7, v28, v29
    v_lshlrev_b32 v28, 16, v7
    v_and_b32 v29, 0xffff0000, v7
    v_cvt_pk_bf16_f32 v7, v30, v31
    v_lshlrev_b32 v30, 16, v7
    v_and_b32 v31, 0xffff0000, v7
    v_cvt_pk_bf16_f32 v7, v32, v33
    v_lshlrev_b32 v32, 16, v7
    v_and_b32 v33, 0xffff0000, v7
    v_cvt_pk_bf16_f32 v7, v34, v35
    v_lshlrev_b32 v34, 16, v7
    v_and_b32 v35, 0xffff0000, v7
    v_mul_f32 v20, v20, v9
    v_mul_f32 v21, v21, v9
    v_mul_f32 v22, v22, v9
    v_mul_f32 v23, v23, v9
    v_mul_f32 v24, v24, v9
    v_mul_f32 v25, v25, v9
    v_mul_f32 v26, v26, v9
    v_mul_f32 v27, v27, v9
    v_mul_f32 v28, v28, v9
    v_mul_f32 v29, v29, v9
    v_mul_f32 v30, v30, v9
    v_mul_f32 v31, v31, v9
    v_mul_f32 v32, v32, v9
    v_mul_f32 v33, v33, v9
    v_mul_f32 v34, v34, v9
    v_mul_f32 v35, v35, v9
    v_cvt_pk_bf16_f32 v20, v20, v21
    v_cvt_pk_bf16_f32 v21, v22, v23
    v_cvt_pk_bf16_f32 v22, v24, v25
    v_cvt_pk_bf16_f32 v23, v26, v27
    v_cvt_pk_bf16_f32 v24, v28, v29
    v_cvt_pk_bf16_f32 v25, v30, v31
    v_cvt_pk_bf16_f32 v26, v32, v33
    v_cvt_pk_bf16_f32 v27, v34, v35
    ds_write_b64 v10, v[20:21] offset:56
    ds_write_b64 v10, v[22:23] offset:72
    ds_write_b64 v10, v[24:25] offset:88
    s_mov_b64 exec, 0xffffffff
    ds_write_b64 v10, v[26:27] offset:104
    s_mov_b64 exec, -1
    v_mov_b32 v7, v48
    v_mov_b32 v8, v48
    s_nop 1
    v_permlane32_swap_b32 v7, v8
    s_nop 1
    v_cvt_pk_bf16_f32 v9, v8, v8
    v_lshlrev_b32 v9, 16, v9
    v_add_f32 v9, 897988541, v9
    v_cvt_pk_bf16_f32 v9, v9, v9
    v_lshlrev_b32 v9, 16, v9
    v_rcp_f32 v9, v9
    v_cvt_pk_bf16_f32 v7, v36, v37
    v_lshlrev_b32 v36, 16, v7
    v_and_b32 v37, 0xffff0000, v7
    v_cvt_pk_bf16_f32 v7, v38, v39
    v_lshlrev_b32 v38, 16, v7
    v_and_b32 v39, 0xffff0000, v7
    v_cvt_pk_bf16_f32 v7, v40, v41
    v_lshlrev_b32 v40, 16, v7
    v_and_b32 v41, 0xffff0000, v7
    v_cvt_pk_bf16_f32 v7, v42, v43
    v_lshlrev_b32 v42, 16, v7
    v_and_b32 v43, 0xffff0000, v7
    v_cvt_pk_bf16_f32 v7, v44, v45
    v_lshlrev_b32 v44, 16, v7
    v_and_b32 v45, 0xffff0000, v7
    v_cvt_pk_bf16_f32 v7, v46, v47
    v_lshlrev_b32 v46, 16, v7
    v_and_b32 v47, 0xffff0000, v7
    v_cvt_pk_bf16_f32 v7, v48, v49
    v_lshlrev_b32 v48, 16, v7
    v_and_b32 v49, 0xffff0000, v7
    v_cvt_pk_bf16_f32 v7, v50, v51
    v_lshlrev_b32 v50, 16, v7
    v_and_b32 v51, 0xffff0000, v7
    v_mul_f32 v36, v36, v9
    v_mul_f32 v37, v37, v9
    v_mul_f32 v38, v38, v9
    v_mul_f32 v39, v39, v9
    v_mul_f32 v40, v40, v9
    v_mul_f32 v41, v41, v9
    v_mul_f32 v42, v42, v9
    v_mul_f32 v43, v43, v9
    v_mul_f32 v44, v44, v9
    v_mul_f32 v45, v45, v9
    v_mul_f32 v46, v46, v9
    v_mul_f32 v47, v47, v9
    v_mul_f32 v48, v48, v9
    v_mul_f32 v49, v49, v9
    v_mul_f32 v50, v50, v9
    v_mul_f32 v51, v51, v9
    v_cvt_pk_bf16_f32 v36, v36, v37
    v_cvt_pk_bf16_f32 v37, v38, v39
    v_cvt_pk_bf16_f32 v38, v40, v41
    v_cvt_pk_bf16_f32 v39, v42, v43
    v_cvt_pk_bf16_f32 v40, v44, v45
    v_cvt_pk_bf16_f32 v41, v46, v47
    v_cvt_pk_bf16_f32 v42, v48, v49
    v_cvt_pk_bf16_f32 v43, v50, v51
    ds_write_b64 v10, v[36:37] offset:29240
    ds_write_b64 v10, v[38:39] offset:29256
    ds_write_b64 v10, v[40:41] offset:29272
    s_mov_b64 exec, 0xffffffff
    ds_write_b64 v10, v[42:43] offset:29288
    s_mov_b64 exec, -1
    v_bfe_u32 v2, v1, 4, 1
    v_lshrrev_b32 v3, 5, v1
    v_bfe_u32 v4, v1, 2, 2
    v_and_b32 v5, 3, v1
    v_lshl_add_u32 v5, v2, 2, v5
    v_lshrrev_b32 v6, 1, v4
    v_lshl_add_u32 v4, v3, 3, v4
    v_lshlrev_b32 v4, 7, v4
    v_lshl_add_u32 v4, v5, 3, v4
    s_lshr_b32 s40, s23, 1
    s_lshl_b32 s41, s40, 11
    s_add_u32 s41, s41, 91136
    v_add_u32 v4, s41, v4
    v_lshl_add_u32 v14, v6, 6, v4
    v_xor_b32 v6, 1, v6
    v_lshl_add_u32 v15, v6, 6, v4
    v_and_b32 v6, 31, v1
    v_lshrrev_b32 v7, 5, v1
    s_and_b32 s41, s23, 1
    s_lshl_b32 s41, s41, 5
    v_add_u32 v6, s41, v6
    s_lshl_b32 s42, s40, 5
    v_mul_u32_u24 v16, 912, v6
    v_lshl_add_u32 v16, v7, 4, v16
    v_add_u32 v16, s42, v16
    s_lshl_b32 s42, s40, 1
    v_add_u32 v7, s42, v7
    v_bfe_u32 v8, v6, 1, 3
    v_xor_b32 v7, v7, v8
    v_lshlrev_b32 v17, 7, v6
    v_lshl_add_u32 v17, v7, 4, v17
    v_add_u32 v17, 58368, v17
    v_mov_b32 v20, 0
    v_mov_b32 v21, 0
    v_mov_b32 v22, 0
    v_mov_b32 v23, 0
    v_mov_b32 v24, 0
    v_mov_b32 v25, 0
    v_mov_b32 v26, 0
    v_mov_b32 v27, 0
    v_mov_b32 v28, 0
    v_mov_b32 v29, 0
    v_mov_b32 v30, 0
    v_mov_b32 v31, 0
    v_mov_b32 v32, 0
    v_mov_b32 v33, 0
    v_mov_b32 v34, 0
    v_mov_b32 v35, 0
    v_mov_b32 v36, 0
    v_mov_b32 v37, 0
    v_mov_b32 v38, 0
    v_mov_b32 v39, 0
    v_mov_b32 v40, 0
    v_mov_b32 v41, 0
    v_mov_b32 v42, 0
    v_mov_b32 v43, 0
    v_mov_b32 v44, 0
    v_mov_b32 v45, 0
    v_mov_b32 v46, 0
    v_mov_b32 v47, 0
    v_mov_b32 v48, 0
    v_mov_b32 v49, 0
    v_mov_b32 v50, 0
    v_mov_b32 v51, 0
    v_lshrrev_b32 v6, 3, v0
    v_and_b32 v7, 7, v0
    s_lshl_b32 s41, s20, 6
    v_add_u32 v8, s41, v6
    v_mul_u32_u24 v11, 896, v8
    v_lshl_add_u32 v11, v7, 4, v11
    s_lshl_b32 s52, s21, 7
    buffer_load_dwordx4 v[64:67], v11, s[4:7], s52 offen
    s_waitcnt lgkmcnt(0)
    s_barrier
    s_add_u32 m0, s47, 115712
    s_mov_b32 s36, 172032
    buffer_load_dwordx4 v12, s[8:11], s36 offen lds
    s_waitcnt vmcnt(4)
    s_barrier
    ds_read_b64_tr_b16 v[52:53], v14 offset:0
    ds_read_b64_tr_b16 v[54:55], v14 offset:512
    ds_read_b64_tr_b16 v[56:57], v15 offset:0
    ds_read_b64_tr_b16 v[58:59], v15 offset:512
    ds_read_b128 v[60:63], v16 offset:0
    s_waitcnt lgkmcnt(0)
    v_mfma_f32_32x32x16_bf16 v[20:35], v[52:55], v[60:63], v[20:35]
    v_mfma_f32_32x32x16_bf16 v[36:51], v[56:59], v[60:63], v[36:51]
    s_waitcnt vmcnt(3)
    s_barrier
    s_add_u32 m0, s47, 91136
    s_mov_b32 s36, 229376
    buffer_load_dwordx4 v12, s[8:11], s36 offen lds
    ds_read_b64_tr_b16 v[52:53], v14 offset:8192
    ds_read_b64_tr_b16 v[54:55], v14 offset:8704
    ds_read_b64_tr_b16 v[56:57], v15 offset:8192
    ds_read_b64_tr_b16 v[58:59], v15 offset:8704
    ds_read_b128 v[60:63], v16 offset:128
    s_waitcnt lgkmcnt(0)
    v_mfma_f32_32x32x16_bf16 v[20:35], v[52:55], v[60:63], v[20:35]
    v_mfma_f32_32x32x16_bf16 v[36:51], v[56:59], v[60:63], v[36:51]
    s_waitcnt vmcnt(3)
    s_barrier
    s_add_u32 m0, s47, 99328
    s_mov_b32 s36, 286720
    buffer_load_dwordx4 v12, s[8:11], s36 offen lds
    ds_read_b64_tr_b16 v[52:53], v14 offset:16384
    ds_read_b64_tr_b16 v[54:55], v14 offset:16896
    ds_read_b64_tr_b16 v[56:57], v15 offset:16384
    ds_read_b64_tr_b16 v[58:59], v15 offset:16896
    ds_read_b128 v[60:63], v16 offset:256
    s_waitcnt lgkmcnt(0)
    v_mfma_f32_32x32x16_bf16 v[20:35], v[52:55], v[60:63], v[20:35]
    v_mfma_f32_32x32x16_bf16 v[36:51], v[56:59], v[60:63], v[36:51]
    s_waitcnt vmcnt(2)
    s_barrier
    s_add_u32 m0, s47, 107520
    s_mov_b32 s36, 344064
    buffer_load_dwordx4 v12, s[8:11], s36 offen lds
    ds_read_b64_tr_b16 v[52:53], v14 offset:24576
    ds_read_b64_tr_b16 v[54:55], v14 offset:25088
    ds_read_b64_tr_b16 v[56:57], v15 offset:24576
    ds_read_b64_tr_b16 v[58:59], v15 offset:25088
    ds_read_b128 v[60:63], v16 offset:384
    s_waitcnt lgkmcnt(0)
    v_mfma_f32_32x32x16_bf16 v[20:35], v[52:55], v[60:63], v[20:35]
    v_mfma_f32_32x32x16_bf16 v[36:51], v[56:59], v[60:63], v[36:51]
    s_waitcnt vmcnt(2)
    s_barrier
    s_add_u32 m0, s47, 115712
    s_mov_b32 s36, 0
    buffer_load_dwordx4 v12, s[12:15], s36 offen lds
    s_add_u32 m0, s47, 82944
    s_mov_b32 s36, 0
    buffer_load_dwordx4 v13, s[16:19], s36 offen lds
    ds_read_b64_tr_b16 v[52:53], v14 offset:0
    ds_read_b64_tr_b16 v[54:55], v14 offset:512
    ds_read_b64_tr_b16 v[56:57], v15 offset:0
    ds_read_b64_tr_b16 v[58:59], v15 offset:512
    ds_read_b128 v[60:63], v16 offset:512
    s_waitcnt lgkmcnt(0)
    v_mfma_f32_32x32x16_bf16 v[20:35], v[52:55], v[60:63], v[20:35]
    v_mfma_f32_32x32x16_bf16 v[36:51], v[56:59], v[60:63], v[36:51]
    s_waitcnt vmcnt(3)
    s_barrier
    s_add_u32 m0, s47, 91136
    s_mov_b32 s36, 57344
    buffer_load_dwordx4 v12, s[12:15], s36 offen lds
    s_add_u32 m0, s47, 58368
    s_mov_b32 s36, 128
    buffer_load_dwordx4 v13, s[16:19], s36 offen lds
    ds_read_b64_tr_b16 v[52:53], v14 offset:8192
    ds_read_b64_tr_b16 v[54:55], v14 offset:8704
    ds_read_b64_tr_b16 v[56:57], v15 offset:8192
    ds_read_b64_tr_b16 v[58:59], v15 offset:8704
    ds_read_b128 v[60:63], v16 offset:640
    s_waitcnt lgkmcnt(0)
    v_mfma_f32_32x32x16_bf16 v[20:35], v[52:55], v[60:63], v[20:35]
    v_mfma_f32_32x32x16_bf16 v[36:51], v[56:59], v[60:63], v[36:51]
    s_waitcnt vmcnt(4)
    s_barrier
    s_add_u32 m0, s47, 99328
    s_mov_b32 s36, 114688
    buffer_load_dwordx4 v12, s[12:15], s36 offen lds
    s_add_u32 m0, s47, 66560
    s_mov_b32 s36, 256
    buffer_load_dwordx4 v13, s[16:19], s36 offen lds
    ds_read_b64_tr_b16 v[52:53], v14 offset:16384
    ds_read_b64_tr_b16 v[54:55], v14 offset:16896
    ds_read_b64_tr_b16 v[56:57], v15 offset:16384
    ds_read_b64_tr_b16 v[58:59], v15 offset:16896
    ds_read_b128 v[60:63], v16 offset:768
    s_waitcnt lgkmcnt(0)
    v_mfma_f32_32x32x16_bf16 v[20:35], v[52:55], v[60:63], v[20:35]
    v_mfma_f32_32x32x16_bf16 v[36:51], v[56:59], v[60:63], v[36:51]
    s_waitcnt vmcnt(4)
    s_barrier
    s_add_u32 m0, s47, 107520
    s_mov_b32 s36, 172032
    buffer_load_dwordx4 v12, s[12:15], s36 offen lds
    s_add_u32 m0, s47, 74752
    s_mov_b32 s36, 384
    buffer_load_dwordx4 v13, s[16:19], s36 offen lds
    ds_read_b64_tr_b16 v[52:53], v14 offset:24576
    ds_read_b64_tr_b16 v[54:55], v14 offset:25088
    ds_read_b64_tr_b16 v[56:57], v15 offset:24576
    ds_read_b64_tr_b16 v[58:59], v15 offset:25088
    ds_read_b128 v[60:63], v17 offset:24576
    s_waitcnt lgkmcnt(0)
    v_mfma_f32_32x32x16_bf16 v[20:35], v[52:55], v[60:63], v[20:35]
    v_mfma_f32_32x32x16_bf16 v[36:51], v[56:59], v[60:63], v[36:51]
    s_waitcnt vmcnt(4)
    s_barrier
    s_add_u32 m0, s47, 115712
    s_mov_b32 s36, 229376
    buffer_load_dwordx4 v12, s[12:15], s36 offen lds
    s_add_u32 m0, s47, 82944
    s_mov_b32 s36, 512
    buffer_load_dwordx4 v13, s[16:19], s36 offen lds
    ds_read_b64_tr_b16 v[52:53], v14 offset:0
    ds_read_b64_tr_b16 v[54:55], v14 offset:512
    ds_read_b64_tr_b16 v[56:57], v15 offset:0
    ds_read_b64_tr_b16 v[58:59], v15 offset:512
    ds_read_b128 v[60:63], v17 offset:0
    s_waitcnt lgkmcnt(0)
    v_mfma_f32_32x32x16_bf16 v[20:35], v[52:55], v[60:63], v[20:35]
    v_mfma_f32_32x32x16_bf16 v[36:51], v[56:59], v[60:63], v[36:51]
    s_waitcnt vmcnt(4)
    s_barrier
    s_add_u32 m0, s47, 91136
    s_mov_b32 s36, 286720
    buffer_load_dwordx4 v12, s[12:15], s36 offen lds
    s_add_u32 m0, s47, 58368
    s_mov_b32 s36, 640
    buffer_load_dwordx4 v13, s[16:19], s36 offen lds
    ds_read_b64_tr_b16 v[52:53], v14 offset:8192
    ds_read_b64_tr_b16 v[54:55], v14 offset:8704
    ds_read_b64_tr_b16 v[56:57], v15 offset:8192
    ds_read_b64_tr_b16 v[58:59], v15 offset:8704
    ds_read_b128 v[60:63], v17 offset:8192
    s_waitcnt lgkmcnt(0)
    v_mfma_f32_32x32x16_bf16 v[20:35], v[52:55], v[60:63], v[20:35]
    v_mfma_f32_32x32x16_bf16 v[36:51], v[56:59], v[60:63], v[36:51]
    s_waitcnt vmcnt(4)
    s_barrier
    s_add_u32 m0, s47, 99328
    s_mov_b32 s36, 344064
    buffer_load_dwordx4 v12, s[12:15], s36 offen lds
    s_add_u32 m0, s47, 66560
    s_mov_b32 s36, 768
    buffer_load_dwordx4 v13, s[16:19], s36 offen lds
    ds_read_b64_tr_b16 v[52:53], v14 offset:16384
    ds_read_b64_tr_b16 v[54:55], v14 offset:16896
    ds_read_b64_tr_b16 v[56:57], v15 offset:16384
    ds_read_b64_tr_b16 v[58:59], v15 offset:16896
    ds_read_b128 v[60:63], v17 offset:16384
    s_waitcnt lgkmcnt(0)
    v_mfma_f32_32x32x16_bf16 v[20:35], v[52:55], v[60:63], v[20:35]
    v_mfma_f32_32x32x16_bf16 v[36:51], v[56:59], v[60:63], v[36:51]
    s_waitcnt vmcnt(4)
    s_barrier
    s_add_u32 m0, s47, 107520
    s_mov_b32 s36, 401408
    buffer_load_dwordx4 v12, s[12:15], s36 offen lds
    s_add_u32 m0, s47, 74752
    s_mov_b32 s36, 896
    buffer_load_dwordx4 v13, s[16:19], s36 offen lds
    ds_read_b64_tr_b16 v[52:53], v14 offset:24576
    ds_read_b64_tr_b16 v[54:55], v14 offset:25088
    ds_read_b64_tr_b16 v[56:57], v15 offset:24576
    ds_read_b64_tr_b16 v[58:59], v15 offset:25088
    ds_read_b128 v[60:63], v17 offset:24576
    s_waitcnt lgkmcnt(0)
    v_mfma_f32_32x32x16_bf16 v[20:35], v[52:55], v[60:63], v[20:35]
    v_mfma_f32_32x32x16_bf16 v[36:51], v[56:59], v[60:63], v[36:51]
    s_waitcnt vmcnt(4)
    s_barrier
    s_add_u32 m0, s47, 115712
    s_mov_b32 s36, 458752
    buffer_load_dwordx4 v12, s[12:15], s36 offen lds
    s_add_u32 m0, s47, 82944
    s_mov_b32 s36, 1024
    buffer_load_dwordx4 v13, s[16:19], s36 offen lds
    ds_read_b64_tr_b16 v[52:53], v14 offset:0
    ds_read_b64_tr_b16 v[54:55], v14 offset:512
    ds_read_b64_tr_b16 v[56:57], v15 offset:0
    ds_read_b64_tr_b16 v[58:59], v15 offset:512
    ds_read_b128 v[60:63], v17 offset:0
    s_waitcnt lgkmcnt(0)
    v_mfma_f32_32x32x16_bf16 v[20:35], v[52:55], v[60:63], v[20:35]
    v_mfma_f32_32x32x16_bf16 v[36:51], v[56:59], v[60:63], v[36:51]
    s_waitcnt vmcnt(4)
    s_barrier
    s_add_u32 m0, s47, 91136
    s_mov_b32 s36, 516096
    buffer_load_dwordx4 v12, s[12:15], s36 offen lds
    s_add_u32 m0, s47, 58368
    s_mov_b32 s36, 1152
    buffer_load_dwordx4 v13, s[16:19], s36 offen lds
    ds_read_b64_tr_b16 v[52:53], v14 offset:8192
    ds_read_b64_tr_b16 v[54:55], v14 offset:8704
    ds_read_b64_tr_b16 v[56:57], v15 offset:8192
    ds_read_b64_tr_b16 v[58:59], v15 offset:8704
    ds_read_b128 v[60:63], v17 offset:8192
    s_waitcnt lgkmcnt(0)
    v_mfma_f32_32x32x16_bf16 v[20:35], v[52:55], v[60:63], v[20:35]
    v_mfma_f32_32x32x16_bf16 v[36:51], v[56:59], v[60:63], v[36:51]
    s_waitcnt vmcnt(4)
    s_barrier
    s_add_u32 m0, s47, 99328
    s_mov_b32 s36, 573440
    buffer_load_dwordx4 v12, s[12:15], s36 offen lds
    s_add_u32 m0, s47, 66560
    s_mov_b32 s36, 1280
    buffer_load_dwordx4 v13, s[16:19], s36 offen lds
    ds_read_b64_tr_b16 v[52:53], v14 offset:16384
    ds_read_b64_tr_b16 v[54:55], v14 offset:16896
    ds_read_b64_tr_b16 v[56:57], v15 offset:16384
    ds_read_b64_tr_b16 v[58:59], v15 offset:16896
    ds_read_b128 v[60:63], v17 offset:16384
    s_waitcnt lgkmcnt(0)
    v_mfma_f32_32x32x16_bf16 v[20:35], v[52:55], v[60:63], v[20:35]
    v_mfma_f32_32x32x16_bf16 v[36:51], v[56:59], v[60:63], v[36:51]
    s_waitcnt vmcnt(4)
    s_barrier
    s_add_u32 m0, s47, 107520
    s_mov_b32 s36, 630784
    buffer_load_dwordx4 v12, s[12:15], s36 offen lds
    s_add_u32 m0, s47, 74752
    s_mov_b32 s36, 1408
    buffer_load_dwordx4 v13, s[16:19], s36 offen lds
    ds_read_b64_tr_b16 v[52:53], v14 offset:24576
    ds_read_b64_tr_b16 v[54:55], v14 offset:25088
    ds_read_b64_tr_b16 v[56:57], v15 offset:24576
    ds_read_b64_tr_b16 v[58:59], v15 offset:25088
    ds_read_b128 v[60:63], v17 offset:24576
    s_waitcnt lgkmcnt(0)
    v_mfma_f32_32x32x16_bf16 v[20:35], v[52:55], v[60:63], v[20:35]
    v_mfma_f32_32x32x16_bf16 v[36:51], v[56:59], v[60:63], v[36:51]
    s_waitcnt vmcnt(4)
    s_barrier
    s_add_u32 m0, s47, 115712
    s_mov_b32 s36, 688128
    buffer_load_dwordx4 v12, s[12:15], s36 offen lds
    s_add_u32 m0, s47, 82944
    s_mov_b32 s36, 1536
    buffer_load_dwordx4 v13, s[16:19], s36 offen lds
    ds_read_b64_tr_b16 v[52:53], v14 offset:0
    ds_read_b64_tr_b16 v[54:55], v14 offset:512
    ds_read_b64_tr_b16 v[56:57], v15 offset:0
    ds_read_b64_tr_b16 v[58:59], v15 offset:512
    ds_read_b128 v[60:63], v17 offset:0
    s_waitcnt lgkmcnt(0)
    v_mfma_f32_32x32x16_bf16 v[20:35], v[52:55], v[60:63], v[20:35]
    v_mfma_f32_32x32x16_bf16 v[36:51], v[56:59], v[60:63], v[36:51]
    s_waitcnt vmcnt(4)
    s_barrier
    s_add_u32 m0, s47, 91136
    s_mov_b32 s36, 745472
    buffer_load_dwordx4 v12, s[12:15], s36 offen lds
    s_add_u32 m0, s47, 58368
    s_mov_b32 s36, 1664
    buffer_load_dwordx4 v13, s[16:19], s36 offen lds
    ds_read_b64_tr_b16 v[52:53], v14 offset:8192
    ds_read_b64_tr_b16 v[54:55], v14 offset:8704
    ds_read_b64_tr_b16 v[56:57], v15 offset:8192
    ds_read_b64_tr_b16 v[58:59], v15 offset:8704
    ds_read_b128 v[60:63], v17 offset:8192
    s_waitcnt lgkmcnt(0)
    v_mfma_f32_32x32x16_bf16 v[20:35], v[52:55], v[60:63], v[20:35]
    v_mfma_f32_32x32x16_bf16 v[36:51], v[56:59], v[60:63], v[36:51]
    s_waitcnt vmcnt(4)
    s_barrier
    ds_read_b64_tr_b16 v[52:53], v14 offset:16384
    ds_read_b64_tr_b16 v[54:55], v14 offset:16896
    ds_read_b64_tr_b16 v[56:57], v15 offset:16384
    ds_read_b64_tr_b16 v[58:59], v15 offset:16896
    ds_read_b128 v[60:63], v17 offset:16384
    s_waitcnt lgkmcnt(0)
    v_mfma_f32_32x32x16_bf16 v[20:35], v[52:55], v[60:63], v[20:35]
    v_mfma_f32_32x32x16_bf16 v[36:51], v[56:59], v[60:63], v[36:51]
    s_waitcnt vmcnt(2)
    s_barrier
    ds_read_b64_tr_b16 v[52:53], v14 offset:24576
    ds_read_b64_tr_b16 v[54:55], v14 offset:25088
    ds_read_b64_tr_b16 v[56:57], v15 offset:24576
    ds_read_b64_tr_b16 v[58:59], v15 offset:25088
    ds_read_b128 v[60:63], v17 offset:24576
    s_waitcnt lgkmcnt(0)
    v_mfma_f32_32x32x16_bf16 v[20:35], v[52:55], v[60:63], v[20:35]
    v_mfma_f32_32x32x16_bf16 v[36:51], v[56:59], v[60:63], v[36:51]
    s_waitcnt vmcnt(0)
    s_barrier
    ds_read_b64_tr_b16 v[52:53], v14 offset:0
    ds_read_b64_tr_b16 v[54:55], v14 offset:512
    ds_read_b64_tr_b16 v[56:57], v15 offset:0
    ds_read_b64_tr_b16 v[58:59], v15 offset:512
    ds_read_b128 v[60:63], v17 offset:0
    s_waitcnt lgkmcnt(0)
    v_mfma_f32_32x32x16_bf16 v[20:35], v[52:55], v[60:63], v[20:35]
    v_mfma_f32_32x32x16_bf16 v[36:51], v[56:59], v[60:63], v[36:51]
    s_nop 7
    s_barrier
    v_and_b32 v4, 31, v1
    v_mul_u32_u24 v2, 272, v4
    v_lshrrev_b32 v4, 5, v1
    v_lshl_add_u32 v2, v4, 4, v2
    s_mul_i32 s41, s40, 17408
    s_and_b32 s42, s23, 1
    s_mul_i32 s42, s42, 8704
    s_add_u32 s41, s41, s42
    v_add_u32 v2, s41, v2
    ds_write_b128 v2, v[20:23] offset:0
    ds_write_b128 v2, v[24:27] offset:32
    ds_write_b128 v2, v[28:31] offset:64
    ds_write_b128 v2, v[32:35] offset:96
    ds_write_b128 v2, v[36:39] offset:128
    ds_write_b128 v2, v[40:43] offset:160
    ds_write_b128 v2, v[44:47] offset:192
    ds_write_b128 v2, v[48:51] offset:224
    v_mul_u32_u24 v3, 272, v6
    v_lshl_add_u32 v3, v7, 5, v3
    s_waitcnt lgkmcnt(0)
    s_barrier
    ds_read_b128 v[72:75], v3 offset:0
    ds_read_b128 v[76:79], v3 offset:16
    ds_read_b128 v[80:83], v3 offset:17408
    ds_read_b128 v[84:87], v3 offset:17424
    ds_read_b128 v[88:91], v3 offset:34816
    ds_read_b128 v[92:95], v3 offset:34832
    ds_read_b128 v[96:99], v3 offset:52224
    ds_read_b128 v[100:103], v3 offset:52240
    s_waitcnt vmcnt(0) lgkmcnt(0)
    v_add_f32 v72, v72, v80
    v_add_f32 v73, v73, v81
    v_add_f32 v74, v74, v82
    v_add_f32 v75, v75, v83
    v_add_f32 v76, v76, v84
    v_add_f32 v77, v77, v85
    v_add_f32 v78, v78, v86
    v_add_f32 v79, v79, v87
    v_add_f32 v72, v72, v88
    v_add_f32 v73, v73, v89
    v_add_f32 v74, v74, v90
    v_add_f32 v75, v75, v91
    v_add_f32 v76, v76, v92
    v_add_f32 v77, v77, v93
    v_add_f32 v78, v78, v94
    v_add_f32 v79, v79, v95
    v_add_f32 v72, v72, v96
    v_add_f32 v73, v73, v97
    v_add_f32 v74, v74, v98
    v_add_f32 v75, v75, v99
    v_add_f32 v76, v76, v100
    v_add_f32 v77, v77, v101
    v_add_f32 v78, v78, v102
    v_add_f32 v79, v79, v103
    v_lshlrev_b32 v8, 16, v64
    v_and_b32 v64, 0xffff0000, v64
    v_add_f32 v72, v72, v8
    v_add_f32 v73, v73, v64
    v_cvt_pk_bf16_f32 v64, v72, v73
    v_lshlrev_b32 v8, 16, v65
    v_and_b32 v65, 0xffff0000, v65
    v_add_f32 v74, v74, v8
    v_add_f32 v75, v75, v65
    v_cvt_pk_bf16_f32 v65, v74, v75
    v_lshlrev_b32 v8, 16, v66
    v_and_b32 v66, 0xffff0000, v66
    v_add_f32 v76, v76, v8
    v_add_f32 v77, v77, v66
    v_cvt_pk_bf16_f32 v66, v76, v77
    v_lshlrev_b32 v8, 16, v67
    v_and_b32 v67, 0xffff0000, v67
    v_add_f32 v78, v78, v8
    v_add_f32 v79, v79, v67
    v_cvt_pk_bf16_f32 v67, v78, v79
    buffer_store_dwordx4 v[64:67], v11, s[48:51], s52 offen
k3_end:
k3_end_x:
    s_endpgm
.section .rodata,"a"
.p2align 6
.amdhsa_kernel k1_proj_kernel
  .amdhsa_next_free_vgpr 240
  .amdhsa_next_free_sgpr 102
  .amdhsa_accum_offset 240
  .amdhsa_group_segment_fixed_size 0
  .amdhsa_kernarg_size 96
  .amdhsa_user_sgpr_count 2
  .amdhsa_user_sgpr_kernarg_segment_ptr 1
  .amdhsa_system_sgpr_workgroup_id_x 1
.end_amdhsa_kernel

.p2align 6
.amdhsa_kernel k2_mix_kernel
  .amdhsa_next_free_vgpr 176
  .amdhsa_next_free_sgpr 102
  .amdhsa_accum_offset 176
  .amdhsa_group_segment_fixed_size 0
  .amdhsa_kernarg_size 96
  .amdhsa_user_sgpr_count 2
  .amdhsa_user_sgpr_kernarg_segment_ptr 1
  .amdhsa_system_sgpr_workgroup_id_x 1
.end_amdhsa_kernel

.p2align 6
.amdhsa_kernel k3_out_kernel
  .amdhsa_next_free_vgpr 160
  .amdhsa_next_free_sgpr 102
  .amdhsa_accum_offset 160
  .amdhsa_group_segment_fixed_size 0
  .amdhsa_kernarg_size 96
  .amdhsa_user_sgpr_count 2
  .amdhsa_user_sgpr_kernarg_segment_ptr 1
  .amdhsa_system_sgpr_workgroup_id_x 1
.end_amdhsa_kernel
```
